```python
import torch

def _softmax(x, axis=-1):
    return torch.softmax(x, dim=axis)
def _gelu(x):
    return torch.nn.functional.gelu(x, approximate="tanh")
def _silu(x):
    return torch.nn.functional.silu(x)
def _sigmoid(x):
    return torch.sigmoid(x)
def _layernorm(x, axis=-1, eps=1e-5):
    m = x.mean(dim=axis, keepdim=True)
    v = x.var(dim=axis, keepdim=True, unbiased=False)
    return (x - m) / torch.sqrt(v + eps)
def _scatter_add(tgt, idx, src, axis=0):
    return tgt.clone().index_add_(axis, idx, src)
def _segment_sum(src, seg, n):
    out = torch.zeros((n,) + src.shape[1:], dtype=src.dtype)
    return out.index_add_(0, seg, src)
def _pad(x, pw):
    flat = tuple(v for pair in reversed(pw) for v in pair)
    return torch.nn.functional.pad(x, flat)

kernel_name = 'gated_mix__ssm_conv_s5__ssm_conv_s4__prompt'

def setup_inputs():

    _w = (lambda a: (lambda t: t.to(torch.bfloat16) if t.is_floating_point() else t)(torch.as_tensor(a)))
    def _A_setup():
        B, S, D = 1, 2048, 640
        P = D
        Lambda_re = -0.5 * (lambda _x: torch.exp(torch.as_tensor(_x)))((lambda *s: torch.randn(*s, dtype=torch.bfloat16) * 0.2)(P))
        Lambda_im = (lambda *s: torch.randn(*s, dtype=torch.bfloat16) * 0.4)(P) * 1.0
        B_re = (lambda *s: torch.randn(*s, dtype=torch.bfloat16) * 0.2)(P, D) * (D ** -0.5)
        B_im = (lambda *s: torch.randn(*s, dtype=torch.bfloat16) * 0.2)(P, D) * (D ** -0.5)
        C_re = (lambda *s: torch.randn(*s, dtype=torch.bfloat16) * 0.2)(D, P) * (P ** -0.5)
        C_im = (lambda *s: torch.randn(*s, dtype=torch.bfloat16) * 0.2)(D, P) * (P ** -0.5)
        log_dt = (lambda *s: torch.randn(*s, dtype=torch.bfloat16) * 0.2)(P) * 0.3 - 2.0
        Dskip = (lambda *s: torch.randn(*s, dtype=torch.bfloat16) * 0.05)(D)
        return {
            "x": _w((lambda *s: torch.randn(*s, dtype=torch.bfloat16) * 0.05)(B, S, D)),
            "Lambda_re": _w(Lambda_re),
            "Lambda_im": _w(Lambda_im),
            "B_re": _w(B_re),
            "B_im": _w(B_im),
            "C_re": _w(C_re),
            "C_im": _w(C_im),
            "log_dt": _w(log_dt),
            "Dskip": _w(Dskip),
        }
    _A_in = _A_setup()

    def _B_setup():
        B, L, D, N = 1, 2048, 640, 128
        A_re = -(lambda _x: torch.exp(torch.as_tensor(_x)))((lambda *s: torch.randn(*s, dtype=torch.bfloat16) * 3.2)(D, N))
        A_im = torch.pi * (lambda *s: torch.randn(*s, dtype=torch.bfloat16) * 0.05)(D, N)
        B_re = (lambda *s: torch.randn(*s, dtype=torch.bfloat16) * 0.1)(D, N)
        B_im = (lambda *s: torch.randn(*s, dtype=torch.bfloat16) * 0.1)(D, N)
        C_re = (lambda *s: torch.randn(*s, dtype=torch.bfloat16) * 0.1)(D, N)
        C_im = (lambda *s: torch.randn(*s, dtype=torch.bfloat16) * 0.1)(D, N)
        log_dt = (lambda *s: torch.randn(*s, dtype=torch.bfloat16) * 0.05)(D) * 0.5 - 4.0
        Dskip = (lambda *s: torch.randn(*s, dtype=torch.bfloat16) * 0.05)(D)
        return {
            "u": _w((lambda *s: torch.randn(*s, dtype=torch.bfloat16) * 0.05)(B, L, D)),
            "A_re": _w(A_re),
            "A_im": _w(A_im),
            "B_re": _w(B_re),
            "B_im": _w(B_im),
            "C_re": _w(C_re),
            "C_im": _w(C_im),
            "log_dt": _w(log_dt),
            "Dskip": _w(Dskip),
        }
    _B_in = _B_setup()

    return {
        "A_x": _A_in["x"],
        "A_Lambda_re": _A_in["Lambda_re"],
        "A_Lambda_im": _A_in["Lambda_im"],
        "A_B_re": _A_in["B_re"],
        "A_B_im": _A_in["B_im"],
        "A_C_re": _A_in["C_re"],
        "A_C_im": _A_in["C_im"],
        "A_log_dt": _A_in["log_dt"],
        "A_Dskip": _A_in["Dskip"],
        "B_u": _B_in["u"],
        "B_A_re": _B_in["A_re"],
        "B_A_im": _B_in["A_im"],
        "B_B_re": _B_in["B_re"],
        "B_B_im": _B_in["B_im"],
        "B_C_re": _B_in["C_re"],
        "B_C_im": _B_in["C_im"],
        "B_log_dt": _B_in["log_dt"],
        "B_Dskip": _B_in["Dskip"],
        "gate_w": _w((lambda *s: torch.randn(*s, dtype=torch.bfloat16) * 0.05)(640) * 16.0),
    }

def reference(A_x, A_Lambda_re, A_Lambda_im, A_B_re, A_B_im, A_C_re, A_C_im, A_log_dt, A_Dskip, B_u, B_A_re, B_A_im, B_B_re, B_B_im, B_C_re, B_C_im, B_log_dt, B_Dskip, gate_w):
    def _A_ref(x, Lambda_re, Lambda_im, B_re, B_im, C_re, C_im, log_dt, Dskip):
        Bsz, L, H = x.shape
        Lam = Lambda_re + 1j * Lambda_im
        Bmat = B_re + 1j * B_im
        Cmat = C_re + 1j * C_im
        dt = torch.exp(log_dt)
        Lam_bar = torch.exp(dt * Lam)
        B_bar = ((Lam_bar - 1.0) / Lam)[:, None] * Bmat
        Bu = torch.einsum("bld,pd->blp", x + 0j, B_bar)
        h = torch.zeros_like(Bu[:, 0, :])
        hs = []
        for t in range(L):
            h = Lam_bar[None, :] * h + Bu[:, t, :]
            hs.append(h)
        hseq = torch.stack(hs, 1)
        y = 2.0 * torch.einsum("blp,dp->bld", hseq, Cmat).real + x * Dskip[None, None, :]
        return y

    def _B_ref(u, A_re, A_im, B_re, B_im, C_re, C_im, log_dt, Dskip):
        Bsz, L, D = u.shape
        dt = torch.exp(log_dt)[:, None]
        A = A_re + 1j * A_im
        Bc = B_re + 1j * B_im
        Cc = C_re + 1j * C_im
        logdA = dt * A
        dB = dt * Bc
        l = (lambda x, dt: x.to(dt))(torch.arange(L), A_re.dtype)
        P = torch.exp(logdA[:, :, None] * l[None, None, :])
        K = torch.einsum("dn,dnl,dn->dl", Cc, P, dB).real
        L2 = 2 * L
        Kp = _pad(K, ((0, 0), (0, L)))
        up = (lambda x, *d: x.permute(*d))(u, 0, 2, 1)
        up = _pad(up, ((0, 0), (0, 0), (0, L)))
        Kf = (lambda x, axes=(-2,-1): torch.fft.rfft2(x.float(), dim=axes))(Kp[:, None, :], axes=(-2, -1))
        Uf = (lambda x, axes=(-2,-1): torch.fft.rfft2(x.float(), dim=axes))(up[:, :, None, :], axes=(-2, -1))
        Yf = Uf * Kf[None, :, :, :]
        y = (lambda x, s, axes=(-2,-1): torch.fft.irfft2(x, s=s, dim=axes).to(torch.bfloat16))(Yf, (1, L2), axes=(-2, -1))[:, :, 0, :L]
        y = (lambda x, *d: x.permute(*d))(y, 0, 2, 1) + u * Dskip[None, None, :]
        return y

    x = A_x
    g = _sigmoid((x * gate_w).sum(-1, keepdims=True))
    a = _A_ref(x, A_Lambda_re, A_Lambda_im, A_B_re, A_B_im, A_C_re, A_C_im, A_log_dt, A_Dskip)
    b = _B_ref(x, B_A_re, B_A_im, B_B_re, B_B_im, B_C_re, B_C_im, B_log_dt, B_Dskip)
    return g * a + (1 - g) * b
```

```asm
; @launch grid=(256,1,1) block=(768,1,1) lds=163072
.amdgcn_target "amdgcn-amd-amdhsa--gfx950"
.text
.globl gated_mix__ssm_conv_s5__ssm_conv_s4__prompt_kernel
.p2align 8
.type gated_mix__ssm_conv_s5__ssm_conv_s4__prompt_kernel,@function
gated_mix__ssm_conv_s5__ssm_conv_s4__prompt_kernel:
    s_cmp_ge_u32 s2, 256
    s_cbranch_scc1 gated_mix__ssm_conv_s5__ssm_conv_s4__prompt_kernel_end
    v_lshrrev_b32 v1, 6, v0
    s_nop 0
    v_readfirstlane_b32 s4, v1
    s_nop 1
    v_and_b32 v1, 63, v0
    s_mov_b32 s98, 0x20000
    s_cmp_lg_u32 s4, 8
    s_cbranch_scc1 gated_mix__ssm_conv_s5__ssm_conv_s4__prompt_kernel_zs1
    v_mov_b32 v2, 0
    v_lshlrev_b32 v3, 2, v1
    v_add_u32 v3, 160256, v3
    ds_write_b32 v3, v2
    s_waitcnt lgkmcnt(0)
gated_mix__ssm_conv_s5__ssm_conv_s4__prompt_kernel_zs1:
    s_barrier
    s_cmp_ge_u32 s2, 160
    s_cbranch_scc1 gated_mix__ssm_conv_s5__ssm_conv_s4__prompt_kernel_bb2
    s_cmp_lt_u32 s4, 4
    s_cbranch_scc1 gated_mix__ssm_conv_s5__ssm_conv_s4__prompt_kernel_aa7
    s_cmp_ge_u32 s4, 8
    s_cbranch_scc1 gated_mix__ssm_conv_s5__ssm_conv_s4__prompt_kernel_aa7
    s_sub_u32 s3, s4, 4
    s_lshr_b32 s6, s3, 1
    s_lshl_b32 s5, s2, 1
    s_add_u32 s5, s5, s6
    s_and_b32 s7, s3, 1
    s_mov_b32 s63, 27136
    s_branch gated_mix__ssm_conv_s5__ssm_conv_s4__prompt_kernel_brole3
gated_mix__ssm_conv_s5__ssm_conv_s4__prompt_kernel_aa7:
    s_load_dwordx16 s[8:23], s[0:1], 0
    s_load_dwordx4 s[28:31], s[0:1], 160
    s_and_b32 s68, s2, 7
    s_lshr_b32 s69, s2, 3
    s_mul_i32 s70, s69, 52
    s_lshr_b32 s70, s70, 8
    s_mul_i32 s71, s70, 5
    s_sub_u32 s71, s69, s71
    s_lshr_b32 s5, s68, 1
    s_lshl_b32 s5, s5, 2
    s_add_u32 s5, s5, s70
    s_and_b32 s6, s68, 1
    s_mul_i32 s6, s6, 5
    s_add_u32 s6, s6, s71
    s_sub_u32 s7, s4, 8
    s_cmp_ge_u32 s4, 8
    s_cbranch_scc1 gated_mix__ssm_conv_s5__ssm_conv_s4__prompt_kernel_ap4
    s_setprio 2
    v_and_b32 v2, 15, v1
    v_lshrrev_b32 v3, 4, v1
    v_mov_b32 v4, 160256
    s_lshl_b32 s74, s6, 2
    s_add_u32 s74, s74, s4
    s_lshl_b32 s74, s74, 4
    s_lshl_b32 s75, s4, 12
    v_add_u32 v76, s74, v2
    v_lshlrev_b32 v76, 1, v76
    s_waitcnt lgkmcnt(0)
    s_mov_b32 s52, s10
    s_mov_b32 s53, s11
    s_mov_b32 s54, 1280
    s_mov_b32 s55, 0x20000
    s_mov_b32 s56, s12
    s_mov_b32 s57, s13
    s_mov_b32 s58, 1280
    s_mov_b32 s59, 0x20000
    s_mov_b32 s60, s22
    s_mov_b32 s61, s23
    s_mov_b32 s62, 1280
    s_mov_b32 s63, 0x20000
    s_mov_b32 s44, s30
    s_mov_b32 s45, s31
    s_mov_b32 s46, 14680064
    s_mov_b32 s47, 0x20000
    buffer_load_ushort v104, v76, s[52:55], 0 offen
    buffer_load_ushort v105, v76, s[56:59], 0 offen
    buffer_load_ushort v106, v76, s[60:63], 0 offen
    v_lshrrev_b32 v76, 2, v2
    v_and_b32 v77, 1, v2
    v_lshl_add_u32 v78, v76, 1, v77
    v_lshlrev_b32 v79, 4, v78
    v_lshrrev_b32 v80, 1, v2
    v_and_b32 v80, 1, v80
    v_add_u32 v79, v79, v80
    v_xor_b32 v78, v78, v3
    v_lshlrev_b32 v78, 4, v78
    v_lshl_add_u32 v72, v79, 7, v78
    v_add_u32 v72, 45568, v72
    v_xor_b32 v73, 64, v72
    v_lshrrev_b32 v78, 1, v2
    v_xor_b32 v78, v78, v3
    v_lshlrev_b32 v78, 4, v78
    v_lshl_add_u32 v74, v2, 7, v78
    v_add_u32 v74, s75, v74
    v_add_u32 v74, 111104, v74
    v_xor_b32 v75, 64, v74
    v_mov_b32 v8, 0
    v_mov_b32 v40, 0
    v_mov_b32 v9, 0
    v_mov_b32 v41, 0
    v_mov_b32 v10, 0
    v_mov_b32 v42, 0
    v_mov_b32 v11, 0
    v_mov_b32 v43, 0
    v_mov_b32 v12, 0
    v_mov_b32 v44, 0
    v_mov_b32 v13, 0
    v_mov_b32 v45, 0
    v_mov_b32 v14, 0
    v_mov_b32 v46, 0
    v_mov_b32 v15, 0
    v_mov_b32 v47, 0
    v_mov_b32 v16, 0
    v_mov_b32 v48, 0
    v_mov_b32 v17, 0
    v_mov_b32 v49, 0
    v_mov_b32 v18, 0
    v_mov_b32 v50, 0
    v_mov_b32 v19, 0
    v_mov_b32 v51, 0
    v_mov_b32 v20, 0
    v_mov_b32 v52, 0
    v_mov_b32 v21, 0
    v_mov_b32 v53, 0
    v_mov_b32 v22, 0
    v_mov_b32 v54, 0
    v_mov_b32 v23, 0
    v_mov_b32 v55, 0
    v_mov_b32 v24, 0
    v_mov_b32 v56, 0
    v_mov_b32 v25, 0
    v_mov_b32 v57, 0
    v_mov_b32 v26, 0
    v_mov_b32 v58, 0
    v_mov_b32 v27, 0
    v_mov_b32 v59, 0
    v_mov_b32 v28, 0
    v_mov_b32 v60, 0
    v_mov_b32 v29, 0
    v_mov_b32 v61, 0
    v_mov_b32 v30, 0
    v_mov_b32 v62, 0
    v_mov_b32 v31, 0
    v_mov_b32 v63, 0
    v_mov_b32 v32, 0
    v_mov_b32 v64, 0
    v_mov_b32 v33, 0
    v_mov_b32 v65, 0
    v_mov_b32 v34, 0
    v_mov_b32 v66, 0
    v_mov_b32 v35, 0
    v_mov_b32 v67, 0
    v_mov_b32 v36, 0
    v_mov_b32 v68, 0
    v_mov_b32 v37, 0
    v_mov_b32 v69, 0
    v_mov_b32 v38, 0
    v_mov_b32 v70, 0
    v_mov_b32 v39, 0
    v_mov_b32 v71, 0
    s_waitcnt vmcnt(0)
    v_lshlrev_b32 v104, 16, v104
    v_lshlrev_b32 v105, 16, v105
    v_lshlrev_b32 v106, 16, v106
    v_mul_f32 v106, 0x3fb8aa3b, v106
    v_exp_f32 v106, v106
    s_nop 0
    v_cvt_pk_bf16_f32 v106, v106, v106
    v_lshlrev_b32 v106, 16, v106
    v_mul_f32 v100, v106, v104
    v_mul_f32 v101, v106, v105
    v_mul_f32 v100, 0x3fb8aa3b, v100
    v_mul_f32 v101, 0x3e22f983, v101
    v_exp_f32 v76, v100
    v_fract_f32 v77, v101
    v_cos_f32 v82, v77
    v_sin_f32 v83, v77
    s_nop 0
    v_mul_f32 v82, v82, v76
    v_mul_f32 v83, v83, v76
    v_add_f32 v78, -1.0, v82
    v_mul_f32 v79, v104, v104
    v_fmac_f32 v79, v105, v105
    v_rcp_f32 v79, v79
    v_mul_f32 v98, v78, v104
    v_fmac_f32 v98, v83, v105
    v_mul_f32 v99, v83, v104
    v_fma_f32 v99, -v78, v105, v99
    v_add_f32 v79, v79, v79
    v_mul_f32 v98, v98, v79
    v_mul_f32 v99, v99, v79
    v_mul_f32 v76, 0x41800000, v100
    v_mul_f32 v77, 0x41800000, v101
    v_exp_f32 v76, v76
    v_fract_f32 v77, v77
    v_cos_f32 v84, v77
    v_sin_f32 v85, v77
    s_nop 0
    v_mul_f32 v84, v84, v76
    v_mul_f32 v85, v85, v76
    v_mul_f32 v76, 0x42000000, v100
    v_mul_f32 v77, 0x42000000, v101
    v_exp_f32 v76, v76
    v_fract_f32 v77, v77
    v_cos_f32 v86, v77
    v_sin_f32 v87, v77
    s_nop 0
    v_mul_f32 v86, v86, v76
    v_mul_f32 v87, v87, v76
    v_cvt_f32_u32 v78, v3
    v_mul_f32 v78, 0x42000000, v78
    v_mul_f32 v76, v78, v100
    v_mul_f32 v77, v78, v101
    v_exp_f32 v76, v76
    v_fract_f32 v77, v77
    v_cos_f32 v88, v77
    v_sin_f32 v89, v77
    s_nop 0
    v_mul_f32 v88, v88, v76
    v_mul_f32 v89, v89, v76
gated_mix__ssm_conv_s5__ssm_conv_s4__prompt_kernel_sp8:
    ds_read_b128 v[104:107], v4 offset:0
    s_waitcnt lgkmcnt(0)
    v_min_u32 v104, v104, v105
    v_min_u32 v106, v106, v107
    v_min_u32 v104, v104, v106
    s_nop 0
    v_readfirstlane_b32 s68, v104
    s_nop 1
    s_cmp_ge_u32 s68, 1
    s_cbranch_scc1 gated_mix__ssm_conv_s5__ssm_conv_s4__prompt_kernel_spd9
    s_cmp_eq_u32 s98, 0
    s_cbranch_scc1 gated_mix__ssm_conv_s5__ssm_conv_s4__prompt_kernel_spd9
    s_sub_u32 s98, s98, 1
    s_sleep 1
    s_branch gated_mix__ssm_conv_s5__ssm_conv_s4__prompt_kernel_sp8
gated_mix__ssm_conv_s5__ssm_conv_s4__prompt_kernel_spd9:
    s_lshl_b32 s68, s4, 2
    s_add_u32 s68, s68, 160256
    s_mov_b32 s69, 162560
    v_lshl_add_u32 v79, v1, 2, s69
    v_mov_b32 v80, s68
    v_cmp_eq_u32 vcc, 0, v1
    s_nop 1
    v_cndmask_b32 v79, v79, v80, vcc
    v_mov_b32 v80, 0
    v_and_b32 v104, 3, v1
    v_lshlrev_b32 v104, 2, v104
    v_add_u32 v104, 160256, v104
    ds_read_b128 v[140:143], v74 offset:0
    ds_read_b128 v[144:147], v74 offset:2048
    ds_read_b128 v[148:151], v75 offset:0
    ds_read_b128 v[152:155], v75 offset:2048
    ds_read_b128 v[108:111], v72 offset:0
    ds_read_b128 v[112:115], v72 offset:256
    ds_read_b128 v[116:119], v72 offset:512
    ds_read_b128 v[120:123], v72 offset:768
    ds_read_b128 v[124:127], v72 offset:1024
    ds_read_b128 v[128:131], v72 offset:1280
    ds_read_b128 v[132:135], v72 offset:1536
    ds_read_b128 v[136:139], v72 offset:1792
    s_waitcnt lgkmcnt(7)
    v_mfma_f32_16x16x32_bf16 v[8:11], v[108:111], v[140:143], v[8:11]
    v_add_u32 v80, 1, v80
    v_mfma_f32_16x16x32_bf16 v[40:43], v[108:111], v[144:147], v[40:43]
    ds_read_b128 v[108:111], v73 offset:0
    s_waitcnt lgkmcnt(7)
    v_mfma_f32_16x16x32_bf16 v[12:15], v[112:115], v[140:143], v[12:15]
    ds_write_b32 v79, v80 offset:32
    v_mfma_f32_16x16x32_bf16 v[44:47], v[112:115], v[144:147], v[44:47]
    ds_read_b128 v[112:115], v73 offset:256
    s_waitcnt lgkmcnt(8)
    v_mfma_f32_16x16x32_bf16 v[16:19], v[116:119], v[140:143], v[16:19]
    s_sub_i32 s23, s5, 1
    v_sub_u32 v78, s23, v3
    v_mfma_f32_16x16x32_bf16 v[48:51], v[116:119], v[144:147], v[48:51]
    ds_read_b128 v[116:119], v73 offset:512
    s_waitcnt lgkmcnt(8)
    v_mfma_f32_16x16x32_bf16 v[20:23], v[120:123], v[140:143], v[20:23]
    v_max_i32 v78, 0, v78
    v_cvt_f32_i32 v78, v78
    v_mfma_f32_16x16x32_bf16 v[52:55], v[120:123], v[144:147], v[52:55]
    ds_read_b128 v[120:123], v73 offset:768
    s_waitcnt lgkmcnt(8)
    v_mfma_f32_16x16x32_bf16 v[24:27], v[124:127], v[140:143], v[24:27]
    v_mul_f32 v78, 0x43000000, v78
    v_mul_f32 v76, v78, v100
    v_mfma_f32_16x16x32_bf16 v[56:59], v[124:127], v[144:147], v[56:59]
    ds_read_b128 v[124:127], v73 offset:1024
    s_waitcnt lgkmcnt(8)
    v_mfma_f32_16x16x32_bf16 v[28:31], v[128:131], v[140:143], v[28:31]
    v_mul_f32 v77, v78, v101
    v_exp_f32 v76, v76
    v_mfma_f32_16x16x32_bf16 v[60:63], v[128:131], v[144:147], v[60:63]
    ds_read_b128 v[128:131], v73 offset:1280
    s_waitcnt lgkmcnt(8)
    v_mfma_f32_16x16x32_bf16 v[32:35], v[132:135], v[140:143], v[32:35]
    ds_read_b32 v105, v104
    v_mfma_f32_16x16x32_bf16 v[64:67], v[132:135], v[144:147], v[64:67]
    ds_read_b128 v[132:135], v73 offset:1536
    s_waitcnt lgkmcnt(9)
    v_mfma_f32_16x16x32_bf16 v[36:39], v[136:139], v[140:143], v[36:39]
    v_fract_f32 v77, v77
    v_cos_f32 v90, v77
    v_mfma_f32_16x16x32_bf16 v[68:71], v[136:139], v[144:147], v[68:71]
    ds_read_b128 v[136:139], v73 offset:1792
    s_waitcnt lgkmcnt(9)
    v_mfma_f32_16x16x32_bf16 v[8:11], v[108:111], v[148:151], v[8:11]
    s_waitcnt lgkmcnt(2)
    v_cmp_le_u32 vcc, 2, v105
    v_mfma_f32_16x16x32_bf16 v[40:43], v[108:111], v[152:155], v[40:43]
    s_cmp_eq_u64 vcc, -1
    s_cbranch_scc0 gated_mix__ssm_conv_s5__ssm_conv_s4__prompt_kernel_fs11
gated_mix__ssm_conv_s5__ssm_conv_s4__prompt_kernel_ok10:
    ds_read_b128 v[108:111], v72 offset:16384
    v_mfma_f32_16x16x32_bf16 v[12:15], v[112:115], v[148:151], v[12:15]
    ds_read_b128 v[156:159], v74 offset:16384
    v_mfma_f32_16x16x32_bf16 v[44:47], v[112:115], v[152:155], v[44:47]
    ds_read_b128 v[112:115], v72 offset:16640
    v_mfma_f32_16x16x32_bf16 v[16:19], v[116:119], v[148:151], v[16:19]
    ds_read_b128 v[160:163], v74 offset:18432
    v_mfma_f32_16x16x32_bf16 v[48:51], v[116:119], v[152:155], v[48:51]
    ds_read_b128 v[116:119], v72 offset:16896
    v_mfma_f32_16x16x32_bf16 v[20:23], v[120:123], v[148:151], v[20:23]
    s_waitcnt lgkmcnt(5)
    ds_write_b32 v79, v80 offset:16
    v_mfma_f32_16x16x32_bf16 v[52:55], v[120:123], v[152:155], v[52:55]
    ds_read_b128 v[120:123], v72 offset:17152
    v_mfma_f32_16x16x32_bf16 v[24:27], v[124:127], v[148:151], v[24:27]
    ds_read_b128 v[140:143], v75 offset:16384
    v_mfma_f32_16x16x32_bf16 v[56:59], v[124:127], v[152:155], v[56:59]
    ds_read_b128 v[124:127], v72 offset:17408
    v_mfma_f32_16x16x32_bf16 v[28:31], v[128:131], v[148:151], v[28:31]
    ds_read_b128 v[144:147], v75 offset:18432
    v_mfma_f32_16x16x32_bf16 v[60:63], v[128:131], v[152:155], v[60:63]
    ds_read_b128 v[128:131], v72 offset:17664
    v_mfma_f32_16x16x32_bf16 v[32:35], v[132:135], v[148:151], v[32:35]
    v_sin_f32 v91, v77
    s_nop 0
    v_mfma_f32_16x16x32_bf16 v[64:67], v[132:135], v[152:155], v[64:67]
    ds_read_b128 v[132:135], v72 offset:17920
    v_mfma_f32_16x16x32_bf16 v[36:39], v[136:139], v[148:151], v[36:39]
    v_mul_f32 v90, v90, v76
    v_mul_f32 v91, v91, v76
    v_mfma_f32_16x16x32_bf16 v[68:71], v[136:139], v[152:155], v[68:71]
    ds_read_b128 v[136:139], v72 offset:18176
    s_waitcnt lgkmcnt(9)
    v_mfma_f32_16x16x32_bf16 v[8:11], v[108:111], v[156:159], v[8:11]
    v_add_u32 v80, 1, v80
    v_mfma_f32_16x16x32_bf16 v[40:43], v[108:111], v[160:163], v[40:43]
    ds_read_b128 v[108:111], v73 offset:16384
    v_mfma_f32_16x16x32_bf16 v[12:15], v[112:115], v[156:159], v[12:15]
    s_waitcnt lgkmcnt(4)
    ds_write_b32 v79, v80 offset:32
    v_mfma_f32_16x16x32_bf16 v[44:47], v[112:115], v[160:163], v[44:47]
    ds_read_b128 v[112:115], v73 offset:16640
    v_mfma_f32_16x16x32_bf16 v[16:19], v[116:119], v[156:159], v[16:19]
    s_sub_i32 s23, s5, 5
    v_sub_u32 v78, s23, v3
    v_mfma_f32_16x16x32_bf16 v[48:51], v[116:119], v[160:163], v[48:51]
    ds_read_b128 v[116:119], v73 offset:16896
    v_mfma_f32_16x16x32_bf16 v[20:23], v[120:123], v[156:159], v[20:23]
    v_max_i32 v78, 0, v78
    v_cvt_f32_i32 v78, v78
    v_mfma_f32_16x16x32_bf16 v[52:55], v[120:123], v[160:163], v[52:55]
    ds_read_b128 v[120:123], v73 offset:17152
    v_mfma_f32_16x16x32_bf16 v[24:27], v[124:127], v[156:159], v[24:27]
    v_mul_f32 v78, 0x43000000, v78
    v_mul_f32 v76, v78, v100
    v_mfma_f32_16x16x32_bf16 v[56:59], v[124:127], v[160:163], v[56:59]
    ds_read_b128 v[124:127], v73 offset:17408
    s_waitcnt lgkmcnt(8)
    v_mfma_f32_16x16x32_bf16 v[28:31], v[128:131], v[156:159], v[28:31]
    v_mul_f32 v77, v78, v101
    v_exp_f32 v76, v76
    v_mfma_f32_16x16x32_bf16 v[60:63], v[128:131], v[160:163], v[60:63]
    ds_read_b128 v[128:131], v73 offset:17664
    s_waitcnt lgkmcnt(8)
    v_mfma_f32_16x16x32_bf16 v[32:35], v[132:135], v[156:159], v[32:35]
    ds_read_b32 v105, v104
    v_mfma_f32_16x16x32_bf16 v[64:67], v[132:135], v[160:163], v[64:67]
    ds_read_b128 v[132:135], v73 offset:17920
    s_waitcnt lgkmcnt(9)
    v_mfma_f32_16x16x32_bf16 v[36:39], v[136:139], v[156:159], v[36:39]
    v_fract_f32 v77, v77
    v_cos_f32 v92, v77
    v_mfma_f32_16x16x32_bf16 v[68:71], v[136:139], v[160:163], v[68:71]
    ds_read_b128 v[136:139], v73 offset:18176
    s_waitcnt lgkmcnt(9)
    v_mfma_f32_16x16x32_bf16 v[8:11], v[108:111], v[140:143], v[8:11]
    s_waitcnt lgkmcnt(2)
    v_cmp_le_u32 vcc, 3, v105
    v_mfma_f32_16x16x32_bf16 v[40:43], v[108:111], v[144:147], v[40:43]
    s_cmp_eq_u64 vcc, -1
    s_cbranch_scc0 gated_mix__ssm_conv_s5__ssm_conv_s4__prompt_kernel_fs13
gated_mix__ssm_conv_s5__ssm_conv_s4__prompt_kernel_ok12:
    ds_read_b128 v[108:111], v72 offset:32768
    v_mfma_f32_16x16x32_bf16 v[12:15], v[112:115], v[140:143], v[12:15]
    ds_read_b128 v[148:151], v74 offset:32768
    v_mfma_f32_16x16x32_bf16 v[44:47], v[112:115], v[144:147], v[44:47]
    ds_read_b128 v[112:115], v72 offset:33024
    v_mfma_f32_16x16x32_bf16 v[16:19], v[116:119], v[140:143], v[16:19]
    ds_read_b128 v[152:155], v74 offset:34816
    v_mfma_f32_16x16x32_bf16 v[48:51], v[116:119], v[144:147], v[48:51]
    ds_read_b128 v[116:119], v72 offset:33280
    v_mfma_f32_16x16x32_bf16 v[20:23], v[120:123], v[140:143], v[20:23]
    s_waitcnt lgkmcnt(5)
    ds_write_b32 v79, v80 offset:16
    v_mfma_f32_16x16x32_bf16 v[52:55], v[120:123], v[144:147], v[52:55]
    ds_read_b128 v[120:123], v72 offset:33536
    v_mfma_f32_16x16x32_bf16 v[24:27], v[124:127], v[140:143], v[24:27]
    ds_read_b128 v[156:159], v75 offset:32768
    v_mfma_f32_16x16x32_bf16 v[56:59], v[124:127], v[144:147], v[56:59]
    ds_read_b128 v[124:127], v72 offset:33792
    v_mfma_f32_16x16x32_bf16 v[28:31], v[128:131], v[140:143], v[28:31]
    ds_read_b128 v[160:163], v75 offset:34816
    v_mfma_f32_16x16x32_bf16 v[60:63], v[128:131], v[144:147], v[60:63]
    ds_read_b128 v[128:131], v72 offset:34048
    v_mfma_f32_16x16x32_bf16 v[32:35], v[132:135], v[140:143], v[32:35]
    v_sin_f32 v93, v77
    s_nop 0
    v_mfma_f32_16x16x32_bf16 v[64:67], v[132:135], v[144:147], v[64:67]
    ds_read_b128 v[132:135], v72 offset:34304
    v_mfma_f32_16x16x32_bf16 v[36:39], v[136:139], v[140:143], v[36:39]
    v_mul_f32 v92, v92, v76
    v_mul_f32 v93, v93, v76
    v_mfma_f32_16x16x32_bf16 v[68:71], v[136:139], v[144:147], v[68:71]
    ds_read_b128 v[136:139], v72 offset:34560
    s_waitcnt lgkmcnt(9)
    v_mfma_f32_16x16x32_bf16 v[8:11], v[108:111], v[148:151], v[8:11]
    v_add_u32 v80, 1, v80
    v_mfma_f32_16x16x32_bf16 v[40:43], v[108:111], v[152:155], v[40:43]
    ds_read_b128 v[108:111], v73 offset:32768
    v_mfma_f32_16x16x32_bf16 v[12:15], v[112:115], v[148:151], v[12:15]
    s_waitcnt lgkmcnt(4)
    ds_write_b32 v79, v80 offset:32
    v_mfma_f32_16x16x32_bf16 v[44:47], v[112:115], v[152:155], v[44:47]
    ds_read_b128 v[112:115], v73 offset:33024
    v_mfma_f32_16x16x32_bf16 v[16:19], v[116:119], v[148:151], v[16:19]
    s_sub_i32 s23, s5, 9
    v_sub_u32 v78, s23, v3
    v_mfma_f32_16x16x32_bf16 v[48:51], v[116:119], v[152:155], v[48:51]
    ds_read_b128 v[116:119], v73 offset:33280
    v_mfma_f32_16x16x32_bf16 v[20:23], v[120:123], v[148:151], v[20:23]
    v_max_i32 v78, 0, v78
    v_cvt_f32_i32 v78, v78
    v_mfma_f32_16x16x32_bf16 v[52:55], v[120:123], v[152:155], v[52:55]
    ds_read_b128 v[120:123], v73 offset:33536
    v_mfma_f32_16x16x32_bf16 v[24:27], v[124:127], v[148:151], v[24:27]
    v_mul_f32 v78, 0x43000000, v78
    v_mul_f32 v76, v78, v100
    v_mfma_f32_16x16x32_bf16 v[56:59], v[124:127], v[152:155], v[56:59]
    ds_read_b128 v[124:127], v73 offset:33792
    s_waitcnt lgkmcnt(8)
    v_mfma_f32_16x16x32_bf16 v[28:31], v[128:131], v[148:151], v[28:31]
    v_mul_f32 v77, v78, v101
    v_exp_f32 v76, v76
    v_mfma_f32_16x16x32_bf16 v[60:63], v[128:131], v[152:155], v[60:63]
    ds_read_b128 v[128:131], v73 offset:34048
    s_waitcnt lgkmcnt(8)
    v_mfma_f32_16x16x32_bf16 v[32:35], v[132:135], v[148:151], v[32:35]
    ds_read_b32 v105, v104
    v_mfma_f32_16x16x32_bf16 v[64:67], v[132:135], v[152:155], v[64:67]
    ds_read_b128 v[132:135], v73 offset:34304
    s_waitcnt lgkmcnt(9)
    v_mfma_f32_16x16x32_bf16 v[36:39], v[136:139], v[148:151], v[36:39]
    v_fract_f32 v77, v77
    v_cos_f32 v94, v77
    v_mfma_f32_16x16x32_bf16 v[68:71], v[136:139], v[152:155], v[68:71]
    ds_read_b128 v[136:139], v73 offset:34560
    s_waitcnt lgkmcnt(9)
    v_mfma_f32_16x16x32_bf16 v[8:11], v[108:111], v[156:159], v[8:11]
    s_waitcnt lgkmcnt(2)
    v_cmp_le_u32 vcc, 4, v105
    v_mfma_f32_16x16x32_bf16 v[40:43], v[108:111], v[160:163], v[40:43]
    s_cmp_eq_u64 vcc, -1
    s_cbranch_scc0 gated_mix__ssm_conv_s5__ssm_conv_s4__prompt_kernel_fs15
gated_mix__ssm_conv_s5__ssm_conv_s4__prompt_kernel_ok14:
    ds_read_b128 v[108:111], v72 offset:49152
    v_mfma_f32_16x16x32_bf16 v[12:15], v[112:115], v[156:159], v[12:15]
    ds_read_b128 v[140:143], v74 offset:0
    v_mfma_f32_16x16x32_bf16 v[44:47], v[112:115], v[160:163], v[44:47]
    ds_read_b128 v[112:115], v72 offset:49408
    v_mfma_f32_16x16x32_bf16 v[16:19], v[116:119], v[156:159], v[16:19]
    ds_read_b128 v[144:147], v74 offset:2048
    v_mfma_f32_16x16x32_bf16 v[48:51], v[116:119], v[160:163], v[48:51]
    ds_read_b128 v[116:119], v72 offset:49664
    v_mfma_f32_16x16x32_bf16 v[20:23], v[120:123], v[156:159], v[20:23]
    s_waitcnt lgkmcnt(5)
    ds_write_b32 v79, v80 offset:16
    v_mfma_f32_16x16x32_bf16 v[52:55], v[120:123], v[160:163], v[52:55]
    ds_read_b128 v[120:123], v72 offset:49920
    v_mfma_f32_16x16x32_bf16 v[24:27], v[124:127], v[156:159], v[24:27]
    ds_read_b128 v[148:151], v75 offset:0
    v_mfma_f32_16x16x32_bf16 v[56:59], v[124:127], v[160:163], v[56:59]
    ds_read_b128 v[124:127], v72 offset:50176
    v_mfma_f32_16x16x32_bf16 v[28:31], v[128:131], v[156:159], v[28:31]
    ds_read_b128 v[152:155], v75 offset:2048
    v_mfma_f32_16x16x32_bf16 v[60:63], v[128:131], v[160:163], v[60:63]
    ds_read_b128 v[128:131], v72 offset:50432
    v_mfma_f32_16x16x32_bf16 v[32:35], v[132:135], v[156:159], v[32:35]
    v_sin_f32 v95, v77
    s_nop 0
    v_mfma_f32_16x16x32_bf16 v[64:67], v[132:135], v[160:163], v[64:67]
    ds_read_b128 v[132:135], v72 offset:50688
    v_mfma_f32_16x16x32_bf16 v[36:39], v[136:139], v[156:159], v[36:39]
    v_mul_f32 v94, v94, v76
    v_mul_f32 v95, v95, v76
    v_mfma_f32_16x16x32_bf16 v[68:71], v[136:139], v[160:163], v[68:71]
    ds_read_b128 v[136:139], v72 offset:50944
    s_waitcnt lgkmcnt(9)
    v_mfma_f32_16x16x32_bf16 v[8:11], v[108:111], v[140:143], v[8:11]
    v_add_u32 v80, 1, v80
    v_mfma_f32_16x16x32_bf16 v[40:43], v[108:111], v[144:147], v[40:43]
    ds_read_b128 v[108:111], v73 offset:49152
    v_mfma_f32_16x16x32_bf16 v[12:15], v[112:115], v[140:143], v[12:15]
    s_waitcnt lgkmcnt(4)
    ds_write_b32 v79, v80 offset:32
    v_mfma_f32_16x16x32_bf16 v[44:47], v[112:115], v[144:147], v[44:47]
    ds_read_b128 v[112:115], v73 offset:49408
    v_mfma_f32_16x16x32_bf16 v[16:19], v[116:119], v[140:143], v[16:19]
    s_sub_i32 s23, s5, 13
    v_sub_u32 v78, s23, v3
    v_mfma_f32_16x16x32_bf16 v[48:51], v[116:119], v[144:147], v[48:51]
    ds_read_b128 v[116:119], v73 offset:49664
    v_mfma_f32_16x16x32_bf16 v[20:23], v[120:123], v[140:143], v[20:23]
    v_max_i32 v78, 0, v78
    v_cvt_f32_i32 v78, v78
    v_mfma_f32_16x16x32_bf16 v[52:55], v[120:123], v[144:147], v[52:55]
    ds_read_b128 v[120:123], v73 offset:49920
    v_mfma_f32_16x16x32_bf16 v[24:27], v[124:127], v[140:143], v[24:27]
    v_mul_f32 v78, 0x43000000, v78
    v_mul_f32 v76, v78, v100
    v_mfma_f32_16x16x32_bf16 v[56:59], v[124:127], v[144:147], v[56:59]
    ds_read_b128 v[124:127], v73 offset:50176
    s_waitcnt lgkmcnt(8)
    v_mfma_f32_16x16x32_bf16 v[28:31], v[128:131], v[140:143], v[28:31]
    v_mul_f32 v77, v78, v101
    v_exp_f32 v76, v76
    v_mfma_f32_16x16x32_bf16 v[60:63], v[128:131], v[144:147], v[60:63]
    ds_read_b128 v[128:131], v73 offset:50432
    s_waitcnt lgkmcnt(8)
    v_mfma_f32_16x16x32_bf16 v[32:35], v[132:135], v[140:143], v[32:35]
    ds_read_b32 v105, v104
    v_mfma_f32_16x16x32_bf16 v[64:67], v[132:135], v[144:147], v[64:67]
    ds_read_b128 v[132:135], v73 offset:50688
    s_waitcnt lgkmcnt(9)
    v_mfma_f32_16x16x32_bf16 v[36:39], v[136:139], v[140:143], v[36:39]
    v_fract_f32 v77, v77
    v_cos_f32 v96, v77
    v_mfma_f32_16x16x32_bf16 v[68:71], v[136:139], v[144:147], v[68:71]
    ds_read_b128 v[136:139], v73 offset:50944
    s_waitcnt lgkmcnt(9)
    v_mfma_f32_16x16x32_bf16 v[8:11], v[108:111], v[148:151], v[8:11]
    s_waitcnt lgkmcnt(2)
    v_cmp_le_u32 vcc, 5, v105
    v_mfma_f32_16x16x32_bf16 v[40:43], v[108:111], v[152:155], v[40:43]
    s_cmp_eq_u64 vcc, -1
    s_cbranch_scc0 gated_mix__ssm_conv_s5__ssm_conv_s4__prompt_kernel_fs17
gated_mix__ssm_conv_s5__ssm_conv_s4__prompt_kernel_ok16:
    ds_read_b128 v[108:111], v72 offset:0
    v_mfma_f32_16x16x32_bf16 v[12:15], v[112:115], v[148:151], v[12:15]
    ds_read_b128 v[156:159], v74 offset:16384
    v_mfma_f32_16x16x32_bf16 v[44:47], v[112:115], v[152:155], v[44:47]
    ds_read_b128 v[112:115], v72 offset:256
    v_mfma_f32_16x16x32_bf16 v[16:19], v[116:119], v[148:151], v[16:19]
    ds_read_b128 v[160:163], v74 offset:18432
    v_mfma_f32_16x16x32_bf16 v[48:51], v[116:119], v[152:155], v[48:51]
    ds_read_b128 v[116:119], v72 offset:512
    v_mfma_f32_16x16x32_bf16 v[20:23], v[120:123], v[148:151], v[20:23]
    s_waitcnt lgkmcnt(5)
    ds_write_b32 v79, v80 offset:16
    v_mfma_f32_16x16x32_bf16 v[52:55], v[120:123], v[152:155], v[52:55]
    ds_read_b128 v[120:123], v72 offset:768
    v_mfma_f32_16x16x32_bf16 v[24:27], v[124:127], v[148:151], v[24:27]
    ds_read_b128 v[140:143], v75 offset:16384
    v_mfma_f32_16x16x32_bf16 v[56:59], v[124:127], v[152:155], v[56:59]
    ds_read_b128 v[124:127], v72 offset:1024
    v_mfma_f32_16x16x32_bf16 v[28:31], v[128:131], v[148:151], v[28:31]
    ds_read_b128 v[144:147], v75 offset:18432
    v_mfma_f32_16x16x32_bf16 v[60:63], v[128:131], v[152:155], v[60:63]
    ds_read_b128 v[128:131], v72 offset:1280
    v_mfma_f32_16x16x32_bf16 v[32:35], v[132:135], v[148:151], v[32:35]
    v_sin_f32 v97, v77
    s_nop 0
    v_mfma_f32_16x16x32_bf16 v[64:67], v[132:135], v[152:155], v[64:67]
    ds_read_b128 v[132:135], v72 offset:1536
    v_mfma_f32_16x16x32_bf16 v[36:39], v[136:139], v[148:151], v[36:39]
    v_mul_f32 v96, v96, v76
    v_mul_f32 v97, v97, v76
    v_mfma_f32_16x16x32_bf16 v[68:71], v[136:139], v[152:155], v[68:71]
    ds_read_b128 v[136:139], v72 offset:1792
    s_waitcnt lgkmcnt(9)
    v_mfma_f32_16x16x32_bf16 v[8:11], v[108:111], v[156:159], v[8:11]
    v_add_u32 v80, 1, v80
    v_mfma_f32_16x16x32_bf16 v[40:43], v[108:111], v[160:163], v[40:43]
    ds_read_b128 v[108:111], v73 offset:0
    v_mfma_f32_16x16x32_bf16 v[12:15], v[112:115], v[156:159], v[12:15]
    s_waitcnt lgkmcnt(4)
    ds_write_b32 v79, v80 offset:32
    v_mfma_f32_16x16x32_bf16 v[44:47], v[112:115], v[160:163], v[44:47]
    ds_read_b128 v[112:115], v73 offset:256
    v_mfma_f32_16x16x32_bf16 v[16:19], v[116:119], v[156:159], v[16:19]
    v_mfma_f32_16x16x32_bf16 v[48:51], v[116:119], v[160:163], v[48:51]
    ds_read_b128 v[116:119], v73 offset:512
    v_mfma_f32_16x16x32_bf16 v[20:23], v[120:123], v[156:159], v[20:23]
    v_mfma_f32_16x16x32_bf16 v[52:55], v[120:123], v[160:163], v[52:55]
    ds_read_b128 v[120:123], v73 offset:768
    v_mfma_f32_16x16x32_bf16 v[24:27], v[124:127], v[156:159], v[24:27]
    v_mfma_f32_16x16x32_bf16 v[56:59], v[124:127], v[160:163], v[56:59]
    ds_read_b128 v[124:127], v73 offset:1024
    s_waitcnt lgkmcnt(8)
    v_mfma_f32_16x16x32_bf16 v[28:31], v[128:131], v[156:159], v[28:31]
    v_mfma_f32_16x16x32_bf16 v[60:63], v[128:131], v[160:163], v[60:63]
    ds_read_b128 v[128:131], v73 offset:1280
    s_waitcnt lgkmcnt(8)
    v_mfma_f32_16x16x32_bf16 v[32:35], v[132:135], v[156:159], v[32:35]
    ds_read_b32 v105, v104
    v_mfma_f32_16x16x32_bf16 v[64:67], v[132:135], v[160:163], v[64:67]
    ds_read_b128 v[132:135], v73 offset:1536
    s_waitcnt lgkmcnt(9)
    v_mfma_f32_16x16x32_bf16 v[36:39], v[136:139], v[156:159], v[36:39]
    v_mfma_f32_16x16x32_bf16 v[68:71], v[136:139], v[160:163], v[68:71]
    ds_read_b128 v[136:139], v73 offset:1792
    s_waitcnt lgkmcnt(9)
    v_mfma_f32_16x16x32_bf16 v[8:11], v[108:111], v[140:143], v[8:11]
    s_waitcnt lgkmcnt(2)
    v_cmp_le_u32 vcc, 6, v105
    v_mfma_f32_16x16x32_bf16 v[40:43], v[108:111], v[144:147], v[40:43]
    s_cmp_eq_u64 vcc, -1
    s_cbranch_scc0 gated_mix__ssm_conv_s5__ssm_conv_s4__prompt_kernel_fs19
gated_mix__ssm_conv_s5__ssm_conv_s4__prompt_kernel_ok18:
    ds_read_b128 v[108:111], v72 offset:16384
    v_mfma_f32_16x16x32_bf16 v[12:15], v[112:115], v[140:143], v[12:15]
    ds_read_b128 v[148:151], v74 offset:32768
    v_mfma_f32_16x16x32_bf16 v[44:47], v[112:115], v[144:147], v[44:47]
    ds_read_b128 v[112:115], v72 offset:16640
    v_mfma_f32_16x16x32_bf16 v[16:19], v[116:119], v[140:143], v[16:19]
    ds_read_b128 v[152:155], v74 offset:34816
    v_mfma_f32_16x16x32_bf16 v[48:51], v[116:119], v[144:147], v[48:51]
    ds_read_b128 v[116:119], v72 offset:16896
    v_mfma_f32_16x16x32_bf16 v[20:23], v[120:123], v[140:143], v[20:23]
    s_waitcnt lgkmcnt(5)
    ds_write_b32 v79, v80 offset:16
    v_mfma_f32_16x16x32_bf16 v[52:55], v[120:123], v[144:147], v[52:55]
    ds_read_b128 v[120:123], v72 offset:17152
    v_mfma_f32_16x16x32_bf16 v[24:27], v[124:127], v[140:143], v[24:27]
    ds_read_b128 v[156:159], v75 offset:32768
    v_mfma_f32_16x16x32_bf16 v[56:59], v[124:127], v[144:147], v[56:59]
    ds_read_b128 v[124:127], v72 offset:17408
    v_mfma_f32_16x16x32_bf16 v[28:31], v[128:131], v[140:143], v[28:31]
    ds_read_b128 v[160:163], v75 offset:34816
    v_mfma_f32_16x16x32_bf16 v[60:63], v[128:131], v[144:147], v[60:63]
    ds_read_b128 v[128:131], v72 offset:17664
    v_mfma_f32_16x16x32_bf16 v[32:35], v[132:135], v[140:143], v[32:35]
    v_mfma_f32_16x16x32_bf16 v[64:67], v[132:135], v[144:147], v[64:67]
    ds_read_b128 v[132:135], v72 offset:17920
    v_mfma_f32_16x16x32_bf16 v[36:39], v[136:139], v[140:143], v[36:39]
    v_mfma_f32_16x16x32_bf16 v[68:71], v[136:139], v[144:147], v[68:71]
    ds_read_b128 v[136:139], v72 offset:18176
    s_waitcnt lgkmcnt(9)
    v_mfma_f32_16x16x32_bf16 v[8:11], v[108:111], v[148:151], v[8:11]
    v_add_u32 v80, 1, v80
    v_mfma_f32_16x16x32_bf16 v[40:43], v[108:111], v[152:155], v[40:43]
    ds_read_b128 v[108:111], v73 offset:16384
    v_mfma_f32_16x16x32_bf16 v[12:15], v[112:115], v[148:151], v[12:15]
    s_waitcnt lgkmcnt(4)
    ds_write_b32 v79, v80 offset:32
    v_mfma_f32_16x16x32_bf16 v[44:47], v[112:115], v[152:155], v[44:47]
    ds_read_b128 v[112:115], v73 offset:16640
    v_mfma_f32_16x16x32_bf16 v[16:19], v[116:119], v[148:151], v[16:19]
    v_mfma_f32_16x16x32_bf16 v[48:51], v[116:119], v[152:155], v[48:51]
    ds_read_b128 v[116:119], v73 offset:16896
    v_mfma_f32_16x16x32_bf16 v[20:23], v[120:123], v[148:151], v[20:23]
    v_mfma_f32_16x16x32_bf16 v[52:55], v[120:123], v[152:155], v[52:55]
    ds_read_b128 v[120:123], v73 offset:17152
    v_mfma_f32_16x16x32_bf16 v[24:27], v[124:127], v[148:151], v[24:27]
    v_mfma_f32_16x16x32_bf16 v[56:59], v[124:127], v[152:155], v[56:59]
    ds_read_b128 v[124:127], v73 offset:17408
    s_waitcnt lgkmcnt(8)
    v_mfma_f32_16x16x32_bf16 v[28:31], v[128:131], v[148:151], v[28:31]
    v_mfma_f32_16x16x32_bf16 v[60:63], v[128:131], v[152:155], v[60:63]
    ds_read_b128 v[128:131], v73 offset:17664
    s_waitcnt lgkmcnt(8)
    v_mfma_f32_16x16x32_bf16 v[32:35], v[132:135], v[148:151], v[32:35]
    ds_read_b32 v105, v104
    v_mfma_f32_16x16x32_bf16 v[64:67], v[132:135], v[152:155], v[64:67]
    ds_read_b128 v[132:135], v73 offset:17920
    s_waitcnt lgkmcnt(9)
    v_mfma_f32_16x16x32_bf16 v[36:39], v[136:139], v[148:151], v[36:39]
    v_mfma_f32_16x16x32_bf16 v[68:71], v[136:139], v[152:155], v[68:71]
    ds_read_b128 v[136:139], v73 offset:18176
    s_waitcnt lgkmcnt(9)
    v_mfma_f32_16x16x32_bf16 v[8:11], v[108:111], v[156:159], v[8:11]
    s_waitcnt lgkmcnt(2)
    v_cmp_le_u32 vcc, 7, v105
    v_mfma_f32_16x16x32_bf16 v[40:43], v[108:111], v[160:163], v[40:43]
    s_cmp_eq_u64 vcc, -1
    s_cbranch_scc0 gated_mix__ssm_conv_s5__ssm_conv_s4__prompt_kernel_fs21
gated_mix__ssm_conv_s5__ssm_conv_s4__prompt_kernel_ok20:
    ds_read_b128 v[108:111], v72 offset:32768
    v_mfma_f32_16x16x32_bf16 v[12:15], v[112:115], v[156:159], v[12:15]
    ds_read_b128 v[140:143], v74 offset:0
    v_mfma_f32_16x16x32_bf16 v[44:47], v[112:115], v[160:163], v[44:47]
    ds_read_b128 v[112:115], v72 offset:33024
    v_mfma_f32_16x16x32_bf16 v[16:19], v[116:119], v[156:159], v[16:19]
    ds_read_b128 v[144:147], v74 offset:2048
    v_mfma_f32_16x16x32_bf16 v[48:51], v[116:119], v[160:163], v[48:51]
    ds_read_b128 v[116:119], v72 offset:33280
    v_mfma_f32_16x16x32_bf16 v[20:23], v[120:123], v[156:159], v[20:23]
    s_waitcnt lgkmcnt(5)
    ds_write_b32 v79, v80 offset:16
    v_mfma_f32_16x16x32_bf16 v[52:55], v[120:123], v[160:163], v[52:55]
    ds_read_b128 v[120:123], v72 offset:33536
    v_mfma_f32_16x16x32_bf16 v[24:27], v[124:127], v[156:159], v[24:27]
    ds_read_b128 v[148:151], v75 offset:0
    v_mfma_f32_16x16x32_bf16 v[56:59], v[124:127], v[160:163], v[56:59]
    ds_read_b128 v[124:127], v72 offset:33792
    v_mfma_f32_16x16x32_bf16 v[28:31], v[128:131], v[156:159], v[28:31]
    ds_read_b128 v[152:155], v75 offset:2048
    v_mfma_f32_16x16x32_bf16 v[60:63], v[128:131], v[160:163], v[60:63]
    ds_read_b128 v[128:131], v72 offset:34048
    v_mfma_f32_16x16x32_bf16 v[32:35], v[132:135], v[156:159], v[32:35]
    v_mfma_f32_16x16x32_bf16 v[64:67], v[132:135], v[160:163], v[64:67]
    ds_read_b128 v[132:135], v72 offset:34304
    v_mfma_f32_16x16x32_bf16 v[36:39], v[136:139], v[156:159], v[36:39]
    v_mfma_f32_16x16x32_bf16 v[68:71], v[136:139], v[160:163], v[68:71]
    ds_read_b128 v[136:139], v72 offset:34560
    s_waitcnt lgkmcnt(9)
    v_mfma_f32_16x16x32_bf16 v[8:11], v[108:111], v[140:143], v[8:11]
    v_add_u32 v80, 1, v80
    v_mfma_f32_16x16x32_bf16 v[40:43], v[108:111], v[144:147], v[40:43]
    ds_read_b128 v[108:111], v73 offset:32768
    v_mfma_f32_16x16x32_bf16 v[12:15], v[112:115], v[140:143], v[12:15]
    s_waitcnt lgkmcnt(4)
    ds_write_b32 v79, v80 offset:32
    v_mfma_f32_16x16x32_bf16 v[44:47], v[112:115], v[144:147], v[44:47]
    ds_read_b128 v[112:115], v73 offset:33024
    v_mfma_f32_16x16x32_bf16 v[16:19], v[116:119], v[140:143], v[16:19]
    v_mfma_f32_16x16x32_bf16 v[48:51], v[116:119], v[144:147], v[48:51]
    ds_read_b128 v[116:119], v73 offset:33280
    v_mfma_f32_16x16x32_bf16 v[20:23], v[120:123], v[140:143], v[20:23]
    v_mfma_f32_16x16x32_bf16 v[52:55], v[120:123], v[144:147], v[52:55]
    ds_read_b128 v[120:123], v73 offset:33536
    v_mfma_f32_16x16x32_bf16 v[24:27], v[124:127], v[140:143], v[24:27]
    v_mfma_f32_16x16x32_bf16 v[56:59], v[124:127], v[144:147], v[56:59]
    ds_read_b128 v[124:127], v73 offset:33792
    s_waitcnt lgkmcnt(8)
    v_mfma_f32_16x16x32_bf16 v[28:31], v[128:131], v[140:143], v[28:31]
    v_mfma_f32_16x16x32_bf16 v[60:63], v[128:131], v[144:147], v[60:63]
    ds_read_b128 v[128:131], v73 offset:34048
    s_waitcnt lgkmcnt(8)
    v_mfma_f32_16x16x32_bf16 v[32:35], v[132:135], v[140:143], v[32:35]
    ds_read_b32 v105, v104
    v_mfma_f32_16x16x32_bf16 v[64:67], v[132:135], v[144:147], v[64:67]
    ds_read_b128 v[132:135], v73 offset:34304
    s_waitcnt lgkmcnt(9)
    v_mfma_f32_16x16x32_bf16 v[36:39], v[136:139], v[140:143], v[36:39]
    v_mfma_f32_16x16x32_bf16 v[68:71], v[136:139], v[144:147], v[68:71]
    ds_read_b128 v[136:139], v73 offset:34560
    s_waitcnt lgkmcnt(9)
    v_mfma_f32_16x16x32_bf16 v[8:11], v[108:111], v[148:151], v[8:11]
    s_waitcnt lgkmcnt(2)
    v_cmp_le_u32 vcc, 8, v105
    v_mfma_f32_16x16x32_bf16 v[40:43], v[108:111], v[152:155], v[40:43]
    s_cmp_eq_u64 vcc, -1
    s_cbranch_scc0 gated_mix__ssm_conv_s5__ssm_conv_s4__prompt_kernel_fs23
gated_mix__ssm_conv_s5__ssm_conv_s4__prompt_kernel_ok22:
    ds_read_b128 v[108:111], v72 offset:49152
    v_mfma_f32_16x16x32_bf16 v[12:15], v[112:115], v[148:151], v[12:15]
    ds_read_b128 v[156:159], v74 offset:16384
    v_mfma_f32_16x16x32_bf16 v[44:47], v[112:115], v[152:155], v[44:47]
    ds_read_b128 v[112:115], v72 offset:49408
    v_mfma_f32_16x16x32_bf16 v[16:19], v[116:119], v[148:151], v[16:19]
    ds_read_b128 v[160:163], v74 offset:18432
    v_mfma_f32_16x16x32_bf16 v[48:51], v[116:119], v[152:155], v[48:51]
    ds_read_b128 v[116:119], v72 offset:49664
    v_mfma_f32_16x16x32_bf16 v[20:23], v[120:123], v[148:151], v[20:23]
    v_mfma_f32_16x16x32_bf16 v[52:55], v[120:123], v[152:155], v[52:55]
    ds_read_b128 v[120:123], v72 offset:49920
    v_mfma_f32_16x16x32_bf16 v[24:27], v[124:127], v[148:151], v[24:27]
    ds_read_b128 v[140:143], v75 offset:16384
    v_mfma_f32_16x16x32_bf16 v[56:59], v[124:127], v[152:155], v[56:59]
    ds_read_b128 v[124:127], v72 offset:50176
    v_mfma_f32_16x16x32_bf16 v[28:31], v[128:131], v[148:151], v[28:31]
    ds_read_b128 v[144:147], v75 offset:18432
    v_mfma_f32_16x16x32_bf16 v[60:63], v[128:131], v[152:155], v[60:63]
    ds_read_b128 v[128:131], v72 offset:50432
    s_waitcnt lgkmcnt(11)
    v_mfma_f32_16x16x32_bf16 v[32:35], v[132:135], v[148:151], v[32:35]
    v_mfma_f32_16x16x32_bf16 v[64:67], v[132:135], v[152:155], v[64:67]
    ds_read_b128 v[132:135], v72 offset:50688
    s_waitcnt lgkmcnt(11)
    v_mfma_f32_16x16x32_bf16 v[36:39], v[136:139], v[148:151], v[36:39]
    v_mfma_f32_16x16x32_bf16 v[68:71], v[136:139], v[152:155], v[68:71]
    ds_read_b128 v[136:139], v72 offset:50944
    s_waitcnt lgkmcnt(8)
    v_mfma_f32_16x16x32_bf16 v[8:11], v[108:111], v[156:159], v[8:11]
    v_add_u32 v80, 1, v80
    v_mfma_f32_16x16x32_bf16 v[40:43], v[108:111], v[160:163], v[40:43]
    ds_read_b128 v[108:111], v73 offset:49152
    v_mfma_f32_16x16x32_bf16 v[12:15], v[112:115], v[156:159], v[12:15]
    v_mfma_f32_16x16x32_bf16 v[44:47], v[112:115], v[160:163], v[44:47]
    ds_read_b128 v[112:115], v73 offset:49408
    s_waitcnt lgkmcnt(9)
    v_mfma_f32_16x16x32_bf16 v[16:19], v[116:119], v[156:159], v[16:19]
    v_mfma_f32_16x16x32_bf16 v[48:51], v[116:119], v[160:163], v[48:51]
    ds_read_b128 v[116:119], v73 offset:49664
    s_waitcnt lgkmcnt(9)
    v_mfma_f32_16x16x32_bf16 v[20:23], v[120:123], v[156:159], v[20:23]
    v_mfma_f32_16x16x32_bf16 v[52:55], v[120:123], v[160:163], v[52:55]
    ds_read_b128 v[120:123], v73 offset:49920
    s_waitcnt lgkmcnt(8)
    v_mfma_f32_16x16x32_bf16 v[24:27], v[124:127], v[156:159], v[24:27]
    v_mfma_f32_16x16x32_bf16 v[56:59], v[124:127], v[160:163], v[56:59]
    ds_read_b128 v[124:127], v73 offset:50176
    s_waitcnt lgkmcnt(7)
    v_mfma_f32_16x16x32_bf16 v[28:31], v[128:131], v[156:159], v[28:31]
    v_mfma_f32_16x16x32_bf16 v[60:63], v[128:131], v[160:163], v[60:63]
    ds_read_b128 v[128:131], v73 offset:50432
    s_waitcnt lgkmcnt(7)
    v_mfma_f32_16x16x32_bf16 v[32:35], v[132:135], v[156:159], v[32:35]
    ds_read_b32 v105, v104
    v_mfma_f32_16x16x32_bf16 v[64:67], v[132:135], v[160:163], v[64:67]
    ds_read_b128 v[132:135], v73 offset:50688
    s_waitcnt lgkmcnt(8)
    v_mfma_f32_16x16x32_bf16 v[36:39], v[136:139], v[156:159], v[36:39]
    v_mfma_f32_16x16x32_bf16 v[68:71], v[136:139], v[160:163], v[68:71]
    ds_read_b128 v[136:139], v73 offset:50944
    s_waitcnt lgkmcnt(8)
    v_mfma_f32_16x16x32_bf16 v[8:11], v[108:111], v[140:143], v[8:11]
    s_waitcnt lgkmcnt(2)
    v_cmp_le_u32 vcc, 9, v105
    v_mfma_f32_16x16x32_bf16 v[40:43], v[108:111], v[144:147], v[40:43]
    s_cmp_eq_u64 vcc, -1
    s_cbranch_scc0 gated_mix__ssm_conv_s5__ssm_conv_s4__prompt_kernel_fs25
gated_mix__ssm_conv_s5__ssm_conv_s4__prompt_kernel_ok24:
    ds_read_b128 v[108:111], v72 offset:0
    v_mfma_f32_16x16x32_bf16 v[12:15], v[112:115], v[140:143], v[12:15]
    ds_read_b128 v[148:151], v74 offset:32768
    v_mfma_f32_16x16x32_bf16 v[44:47], v[112:115], v[144:147], v[44:47]
    ds_read_b128 v[112:115], v72 offset:256
    v_mfma_f32_16x16x32_bf16 v[16:19], v[116:119], v[140:143], v[16:19]
    ds_read_b128 v[152:155], v74 offset:34816
    v_mfma_f32_16x16x32_bf16 v[48:51], v[116:119], v[144:147], v[48:51]
    ds_read_b128 v[116:119], v72 offset:512
    v_mfma_f32_16x16x32_bf16 v[20:23], v[120:123], v[140:143], v[20:23]
    v_mfma_f32_16x16x32_bf16 v[52:55], v[120:123], v[144:147], v[52:55]
    ds_read_b128 v[120:123], v72 offset:768
    v_mfma_f32_16x16x32_bf16 v[24:27], v[124:127], v[140:143], v[24:27]
    ds_read_b128 v[156:159], v75 offset:32768
    v_mfma_f32_16x16x32_bf16 v[56:59], v[124:127], v[144:147], v[56:59]
    ds_read_b128 v[124:127], v72 offset:1024
    v_mfma_f32_16x16x32_bf16 v[28:31], v[128:131], v[140:143], v[28:31]
    ds_read_b128 v[160:163], v75 offset:34816
    v_mfma_f32_16x16x32_bf16 v[60:63], v[128:131], v[144:147], v[60:63]
    ds_read_b128 v[128:131], v72 offset:1280
    s_waitcnt lgkmcnt(11)
    v_mfma_f32_16x16x32_bf16 v[32:35], v[132:135], v[140:143], v[32:35]
    v_mfma_f32_16x16x32_bf16 v[64:67], v[132:135], v[144:147], v[64:67]
    ds_read_b128 v[132:135], v72 offset:1536
    s_waitcnt lgkmcnt(11)
    v_mfma_f32_16x16x32_bf16 v[36:39], v[136:139], v[140:143], v[36:39]
    v_mfma_f32_16x16x32_bf16 v[68:71], v[136:139], v[144:147], v[68:71]
    ds_read_b128 v[136:139], v72 offset:1792
    s_waitcnt lgkmcnt(8)
    v_mfma_f32_16x16x32_bf16 v[8:11], v[108:111], v[148:151], v[8:11]
    v_add_u32 v80, 1, v80
    v_mfma_f32_16x16x32_bf16 v[40:43], v[108:111], v[152:155], v[40:43]
    ds_read_b128 v[108:111], v73 offset:0
    v_mfma_f32_16x16x32_bf16 v[12:15], v[112:115], v[148:151], v[12:15]
    v_mfma_f32_16x16x32_bf16 v[44:47], v[112:115], v[152:155], v[44:47]
    ds_read_b128 v[112:115], v73 offset:256
    s_waitcnt lgkmcnt(9)
    v_mfma_f32_16x16x32_bf16 v[16:19], v[116:119], v[148:151], v[16:19]
    v_mfma_f32_16x16x32_bf16 v[48:51], v[116:119], v[152:155], v[48:51]
    ds_read_b128 v[116:119], v73 offset:512
    s_waitcnt lgkmcnt(9)
    v_mfma_f32_16x16x32_bf16 v[20:23], v[120:123], v[148:151], v[20:23]
    v_mfma_f32_16x16x32_bf16 v[52:55], v[120:123], v[152:155], v[52:55]
    ds_read_b128 v[120:123], v73 offset:768
    s_waitcnt lgkmcnt(8)
    v_mfma_f32_16x16x32_bf16 v[24:27], v[124:127], v[148:151], v[24:27]
    v_mfma_f32_16x16x32_bf16 v[56:59], v[124:127], v[152:155], v[56:59]
    ds_read_b128 v[124:127], v73 offset:1024
    s_waitcnt lgkmcnt(7)
    v_mfma_f32_16x16x32_bf16 v[28:31], v[128:131], v[148:151], v[28:31]
    v_mfma_f32_16x16x32_bf16 v[60:63], v[128:131], v[152:155], v[60:63]
    ds_read_b128 v[128:131], v73 offset:1280
    s_waitcnt lgkmcnt(7)
    v_mfma_f32_16x16x32_bf16 v[32:35], v[132:135], v[148:151], v[32:35]
    ds_read_b32 v105, v104
    v_mfma_f32_16x16x32_bf16 v[64:67], v[132:135], v[152:155], v[64:67]
    ds_read_b128 v[132:135], v73 offset:1536
    s_waitcnt lgkmcnt(8)
    v_mfma_f32_16x16x32_bf16 v[36:39], v[136:139], v[148:151], v[36:39]
    v_mfma_f32_16x16x32_bf16 v[68:71], v[136:139], v[152:155], v[68:71]
    ds_read_b128 v[136:139], v73 offset:1792
    s_waitcnt lgkmcnt(8)
    v_mfma_f32_16x16x32_bf16 v[8:11], v[108:111], v[156:159], v[8:11]
    s_waitcnt lgkmcnt(2)
    v_cmp_le_u32 vcc, 10, v105
    v_mfma_f32_16x16x32_bf16 v[40:43], v[108:111], v[160:163], v[40:43]
    s_cmp_eq_u64 vcc, -1
    s_cbranch_scc0 gated_mix__ssm_conv_s5__ssm_conv_s4__prompt_kernel_fs27
gated_mix__ssm_conv_s5__ssm_conv_s4__prompt_kernel_ok26:
    ds_read_b128 v[108:111], v72 offset:16384
    v_mfma_f32_16x16x32_bf16 v[12:15], v[112:115], v[156:159], v[12:15]
    ds_read_b128 v[140:143], v74 offset:0
    v_mfma_f32_16x16x32_bf16 v[44:47], v[112:115], v[160:163], v[44:47]
    ds_read_b128 v[112:115], v72 offset:16640
    v_mfma_f32_16x16x32_bf16 v[16:19], v[116:119], v[156:159], v[16:19]
    ds_read_b128 v[144:147], v74 offset:2048
    v_mfma_f32_16x16x32_bf16 v[48:51], v[116:119], v[160:163], v[48:51]
    ds_read_b128 v[116:119], v72 offset:16896
    v_mfma_f32_16x16x32_bf16 v[20:23], v[120:123], v[156:159], v[20:23]
    v_mfma_f32_16x16x32_bf16 v[52:55], v[120:123], v[160:163], v[52:55]
    ds_read_b128 v[120:123], v72 offset:17152
    v_mfma_f32_16x16x32_bf16 v[24:27], v[124:127], v[156:159], v[24:27]
    ds_read_b128 v[148:151], v75 offset:0
    v_mfma_f32_16x16x32_bf16 v[56:59], v[124:127], v[160:163], v[56:59]
    ds_read_b128 v[124:127], v72 offset:17408
    v_mfma_f32_16x16x32_bf16 v[28:31], v[128:131], v[156:159], v[28:31]
    ds_read_b128 v[152:155], v75 offset:2048
    v_mfma_f32_16x16x32_bf16 v[60:63], v[128:131], v[160:163], v[60:63]
    ds_read_b128 v[128:131], v72 offset:17664
    s_waitcnt lgkmcnt(11)
    v_mfma_f32_16x16x32_bf16 v[32:35], v[132:135], v[156:159], v[32:35]
    v_mfma_f32_16x16x32_bf16 v[64:67], v[132:135], v[160:163], v[64:67]
    ds_read_b128 v[132:135], v72 offset:17920
    s_waitcnt lgkmcnt(11)
    v_mfma_f32_16x16x32_bf16 v[36:39], v[136:139], v[156:159], v[36:39]
    v_mfma_f32_16x16x32_bf16 v[68:71], v[136:139], v[160:163], v[68:71]
    ds_read_b128 v[136:139], v72 offset:18176
    s_waitcnt lgkmcnt(8)
    v_mfma_f32_16x16x32_bf16 v[8:11], v[108:111], v[140:143], v[8:11]
    v_add_u32 v80, 1, v80
    v_mfma_f32_16x16x32_bf16 v[40:43], v[108:111], v[144:147], v[40:43]
    ds_read_b128 v[108:111], v73 offset:16384
    v_mfma_f32_16x16x32_bf16 v[12:15], v[112:115], v[140:143], v[12:15]
    v_mfma_f32_16x16x32_bf16 v[44:47], v[112:115], v[144:147], v[44:47]
    ds_read_b128 v[112:115], v73 offset:16640
    s_waitcnt lgkmcnt(9)
    v_mfma_f32_16x16x32_bf16 v[16:19], v[116:119], v[140:143], v[16:19]
    v_mfma_f32_16x16x32_bf16 v[48:51], v[116:119], v[144:147], v[48:51]
    ds_read_b128 v[116:119], v73 offset:16896
    s_waitcnt lgkmcnt(9)
    v_mfma_f32_16x16x32_bf16 v[20:23], v[120:123], v[140:143], v[20:23]
    v_mfma_f32_16x16x32_bf16 v[52:55], v[120:123], v[144:147], v[52:55]
    ds_read_b128 v[120:123], v73 offset:17152
    s_waitcnt lgkmcnt(8)
    v_mfma_f32_16x16x32_bf16 v[24:27], v[124:127], v[140:143], v[24:27]
    v_mfma_f32_16x16x32_bf16 v[56:59], v[124:127], v[144:147], v[56:59]
    ds_read_b128 v[124:127], v73 offset:17408
    s_waitcnt lgkmcnt(7)
    v_mfma_f32_16x16x32_bf16 v[28:31], v[128:131], v[140:143], v[28:31]
    v_mfma_f32_16x16x32_bf16 v[60:63], v[128:131], v[144:147], v[60:63]
    ds_read_b128 v[128:131], v73 offset:17664
    s_waitcnt lgkmcnt(7)
    v_mfma_f32_16x16x32_bf16 v[32:35], v[132:135], v[140:143], v[32:35]
    v_mfma_f32_16x16x32_bf16 v[64:67], v[132:135], v[144:147], v[64:67]
    ds_read_b128 v[132:135], v73 offset:17920
    s_waitcnt lgkmcnt(7)
    v_mfma_f32_16x16x32_bf16 v[36:39], v[136:139], v[140:143], v[36:39]
    v_mfma_f32_16x16x32_bf16 v[68:71], v[136:139], v[144:147], v[68:71]
    ds_read_b128 v[136:139], v73 offset:18176
    s_waitcnt lgkmcnt(7)
    v_mfma_f32_16x16x32_bf16 v[8:11], v[108:111], v[148:151], v[8:11]
    v_mfma_f32_16x16x32_bf16 v[40:43], v[108:111], v[152:155], v[40:43]
    s_waitcnt lgkmcnt(6)
    v_mfma_f32_16x16x32_bf16 v[12:15], v[112:115], v[148:151], v[12:15]
    v_mfma_f32_16x16x32_bf16 v[44:47], v[112:115], v[152:155], v[44:47]
    s_waitcnt lgkmcnt(5)
    v_mfma_f32_16x16x32_bf16 v[16:19], v[116:119], v[148:151], v[16:19]
    v_mfma_f32_16x16x32_bf16 v[48:51], v[116:119], v[152:155], v[48:51]
    s_waitcnt lgkmcnt(4)
    v_mfma_f32_16x16x32_bf16 v[20:23], v[120:123], v[148:151], v[20:23]
    v_mfma_f32_16x16x32_bf16 v[52:55], v[120:123], v[152:155], v[52:55]
    s_waitcnt lgkmcnt(3)
    v_mfma_f32_16x16x32_bf16 v[24:27], v[124:127], v[148:151], v[24:27]
    v_mfma_f32_16x16x32_bf16 v[56:59], v[124:127], v[152:155], v[56:59]
    s_waitcnt lgkmcnt(2)
    v_mfma_f32_16x16x32_bf16 v[28:31], v[128:131], v[148:151], v[28:31]
    v_mfma_f32_16x16x32_bf16 v[60:63], v[128:131], v[152:155], v[60:63]
    s_waitcnt lgkmcnt(1)
    v_mfma_f32_16x16x32_bf16 v[32:35], v[132:135], v[148:151], v[32:35]
    v_mfma_f32_16x16x32_bf16 v[64:67], v[132:135], v[152:155], v[64:67]
    s_waitcnt lgkmcnt(0)
    v_mfma_f32_16x16x32_bf16 v[36:39], v[136:139], v[148:151], v[36:39]
    v_mfma_f32_16x16x32_bf16 v[68:71], v[136:139], v[152:155], v[68:71]
    s_branch gated_mix__ssm_conv_s5__ssm_conv_s4__prompt_kernel_aft28
gated_mix__ssm_conv_s5__ssm_conv_s4__prompt_kernel_fs11:
    ds_read_b32 v105, v104
    s_waitcnt lgkmcnt(0)
    v_cmp_le_u32 vcc, 2, v105
    s_cmp_eq_u64 vcc, -1
    s_cbranch_scc1 gated_mix__ssm_conv_s5__ssm_conv_s4__prompt_kernel_ok10
    s_cmp_eq_u32 s98, 0
    s_cbranch_scc1 gated_mix__ssm_conv_s5__ssm_conv_s4__prompt_kernel_ok10
    s_sub_u32 s98, s98, 1
    s_branch gated_mix__ssm_conv_s5__ssm_conv_s4__prompt_kernel_fs11
gated_mix__ssm_conv_s5__ssm_conv_s4__prompt_kernel_fs13:
    ds_read_b32 v105, v104
    s_waitcnt lgkmcnt(0)
    v_cmp_le_u32 vcc, 3, v105
    s_cmp_eq_u64 vcc, -1
    s_cbranch_scc1 gated_mix__ssm_conv_s5__ssm_conv_s4__prompt_kernel_ok12
    s_cmp_eq_u32 s98, 0
    s_cbranch_scc1 gated_mix__ssm_conv_s5__ssm_conv_s4__prompt_kernel_ok12
    s_sub_u32 s98, s98, 1
    s_branch gated_mix__ssm_conv_s5__ssm_conv_s4__prompt_kernel_fs13
gated_mix__ssm_conv_s5__ssm_conv_s4__prompt_kernel_fs15:
    ds_read_b32 v105, v104
    s_waitcnt lgkmcnt(0)
    v_cmp_le_u32 vcc, 4, v105
    s_cmp_eq_u64 vcc, -1
    s_cbranch_scc1 gated_mix__ssm_conv_s5__ssm_conv_s4__prompt_kernel_ok14
    s_cmp_eq_u32 s98, 0
    s_cbranch_scc1 gated_mix__ssm_conv_s5__ssm_conv_s4__prompt_kernel_ok14
    s_sub_u32 s98, s98, 1
    s_branch gated_mix__ssm_conv_s5__ssm_conv_s4__prompt_kernel_fs15
gated_mix__ssm_conv_s5__ssm_conv_s4__prompt_kernel_fs17:
    ds_read_b32 v105, v104
    s_waitcnt lgkmcnt(0)
    v_cmp_le_u32 vcc, 5, v105
    s_cmp_eq_u64 vcc, -1
    s_cbranch_scc1 gated_mix__ssm_conv_s5__ssm_conv_s4__prompt_kernel_ok16
    s_cmp_eq_u32 s98, 0
    s_cbranch_scc1 gated_mix__ssm_conv_s5__ssm_conv_s4__prompt_kernel_ok16
    s_sub_u32 s98, s98, 1
    s_branch gated_mix__ssm_conv_s5__ssm_conv_s4__prompt_kernel_fs17
gated_mix__ssm_conv_s5__ssm_conv_s4__prompt_kernel_fs19:
    ds_read_b32 v105, v104
    s_waitcnt lgkmcnt(0)
    v_cmp_le_u32 vcc, 6, v105
    s_cmp_eq_u64 vcc, -1
    s_cbranch_scc1 gated_mix__ssm_conv_s5__ssm_conv_s4__prompt_kernel_ok18
    s_cmp_eq_u32 s98, 0
    s_cbranch_scc1 gated_mix__ssm_conv_s5__ssm_conv_s4__prompt_kernel_ok18
    s_sub_u32 s98, s98, 1
    s_branch gated_mix__ssm_conv_s5__ssm_conv_s4__prompt_kernel_fs19
gated_mix__ssm_conv_s5__ssm_conv_s4__prompt_kernel_fs21:
    ds_read_b32 v105, v104
    s_waitcnt lgkmcnt(0)
    v_cmp_le_u32 vcc, 7, v105
    s_cmp_eq_u64 vcc, -1
    s_cbranch_scc1 gated_mix__ssm_conv_s5__ssm_conv_s4__prompt_kernel_ok20
    s_cmp_eq_u32 s98, 0
    s_cbranch_scc1 gated_mix__ssm_conv_s5__ssm_conv_s4__prompt_kernel_ok20
    s_sub_u32 s98, s98, 1
    s_branch gated_mix__ssm_conv_s5__ssm_conv_s4__prompt_kernel_fs21
gated_mix__ssm_conv_s5__ssm_conv_s4__prompt_kernel_fs23:
    ds_read_b32 v105, v104
    s_waitcnt lgkmcnt(0)
    v_cmp_le_u32 vcc, 8, v105
    s_cmp_eq_u64 vcc, -1
    s_cbranch_scc1 gated_mix__ssm_conv_s5__ssm_conv_s4__prompt_kernel_ok22
    s_cmp_eq_u32 s98, 0
    s_cbranch_scc1 gated_mix__ssm_conv_s5__ssm_conv_s4__prompt_kernel_ok22
    s_sub_u32 s98, s98, 1
    s_branch gated_mix__ssm_conv_s5__ssm_conv_s4__prompt_kernel_fs23
gated_mix__ssm_conv_s5__ssm_conv_s4__prompt_kernel_fs25:
    ds_read_b32 v105, v104
    s_waitcnt lgkmcnt(0)
    v_cmp_le_u32 vcc, 9, v105
    s_cmp_eq_u64 vcc, -1
    s_cbranch_scc1 gated_mix__ssm_conv_s5__ssm_conv_s4__prompt_kernel_ok24
    s_cmp_eq_u32 s98, 0
    s_cbranch_scc1 gated_mix__ssm_conv_s5__ssm_conv_s4__prompt_kernel_ok24
    s_sub_u32 s98, s98, 1
    s_branch gated_mix__ssm_conv_s5__ssm_conv_s4__prompt_kernel_fs25
gated_mix__ssm_conv_s5__ssm_conv_s4__prompt_kernel_fs27:
    ds_read_b32 v105, v104
    s_waitcnt lgkmcnt(0)
    v_cmp_le_u32 vcc, 10, v105
    s_cmp_eq_u64 vcc, -1
    s_cbranch_scc1 gated_mix__ssm_conv_s5__ssm_conv_s4__prompt_kernel_ok26
    s_cmp_eq_u32 s98, 0
    s_cbranch_scc1 gated_mix__ssm_conv_s5__ssm_conv_s4__prompt_kernel_ok26
    s_sub_u32 s98, s98, 1
    s_branch gated_mix__ssm_conv_s5__ssm_conv_s4__prompt_kernel_fs27
gated_mix__ssm_conv_s5__ssm_conv_s4__prompt_kernel_aft28:
    s_waitcnt lgkmcnt(0)
    v_mov_b32 v80, 10
    ds_write_b32 v79, v80 offset:16
    s_nop 7
    v_mov_b32 v108, v8
    v_mov_b32 v109, v9
    v_mov_b32 v110, v40
    v_mov_b32 v111, v41
    v_pk_fma_f32 v[116:117], v[82:83], v[108:109], v[10:11] op_sel:[0,0,0] op_sel_hi:[0,1,1]
    v_pk_fma_f32 v[118:119], v[82:83], v[110:111], v[42:43] op_sel:[0,0,0] op_sel_hi:[0,1,1]
    v_pk_fma_f32 v[112:113], v[82:83], v[110:111], v[116:117] op_sel:[1,0,0] op_sel_hi:[1,1,1] neg_lo:[1,0,0] neg_hi:[1,0,0]
    v_pk_fma_f32 v[114:115], v[82:83], v[108:109], v[118:119] op_sel:[1,0,0] op_sel_hi:[1,1,1]
    v_pk_fma_f32 v[116:117], v[82:83], v[112:113], v[12:13] op_sel:[0,0,0] op_sel_hi:[0,1,1]
    v_pk_fma_f32 v[118:119], v[82:83], v[114:115], v[44:45] op_sel:[0,0,0] op_sel_hi:[0,1,1]
    v_pk_fma_f32 v[108:109], v[82:83], v[114:115], v[116:117] op_sel:[1,0,0] op_sel_hi:[1,1,1] neg_lo:[1,0,0] neg_hi:[1,0,0]
    v_pk_fma_f32 v[110:111], v[82:83], v[112:113], v[118:119] op_sel:[1,0,0] op_sel_hi:[1,1,1]
    v_pk_fma_f32 v[116:117], v[82:83], v[108:109], v[14:15] op_sel:[0,0,0] op_sel_hi:[0,1,1]
    v_pk_fma_f32 v[118:119], v[82:83], v[110:111], v[46:47] op_sel:[0,0,0] op_sel_hi:[0,1,1]
    v_pk_fma_f32 v[112:113], v[82:83], v[110:111], v[116:117] op_sel:[1,0,0] op_sel_hi:[1,1,1] neg_lo:[1,0,0] neg_hi:[1,0,0]
    v_pk_fma_f32 v[114:115], v[82:83], v[108:109], v[118:119] op_sel:[1,0,0] op_sel_hi:[1,1,1]
    v_pk_fma_f32 v[116:117], v[82:83], v[112:113], v[16:17] op_sel:[0,0,0] op_sel_hi:[0,1,1]
    v_pk_fma_f32 v[118:119], v[82:83], v[114:115], v[48:49] op_sel:[0,0,0] op_sel_hi:[0,1,1]
    v_pk_fma_f32 v[108:109], v[82:83], v[114:115], v[116:117] op_sel:[1,0,0] op_sel_hi:[1,1,1] neg_lo:[1,0,0] neg_hi:[1,0,0]
    v_pk_fma_f32 v[110:111], v[82:83], v[112:113], v[118:119] op_sel:[1,0,0] op_sel_hi:[1,1,1]
    v_pk_fma_f32 v[116:117], v[82:83], v[108:109], v[18:19] op_sel:[0,0,0] op_sel_hi:[0,1,1]
    v_pk_fma_f32 v[118:119], v[82:83], v[110:111], v[50:51] op_sel:[0,0,0] op_sel_hi:[0,1,1]
    v_pk_fma_f32 v[112:113], v[82:83], v[110:111], v[116:117] op_sel:[1,0,0] op_sel_hi:[1,1,1] neg_lo:[1,0,0] neg_hi:[1,0,0]
    v_pk_fma_f32 v[114:115], v[82:83], v[108:109], v[118:119] op_sel:[1,0,0] op_sel_hi:[1,1,1]
    v_pk_fma_f32 v[116:117], v[82:83], v[112:113], v[20:21] op_sel:[0,0,0] op_sel_hi:[0,1,1]
    v_pk_fma_f32 v[118:119], v[82:83], v[114:115], v[52:53] op_sel:[0,0,0] op_sel_hi:[0,1,1]
    v_pk_fma_f32 v[108:109], v[82:83], v[114:115], v[116:117] op_sel:[1,0,0] op_sel_hi:[1,1,1] neg_lo:[1,0,0] neg_hi:[1,0,0]
    v_pk_fma_f32 v[110:111], v[82:83], v[112:113], v[118:119] op_sel:[1,0,0] op_sel_hi:[1,1,1]
    v_pk_fma_f32 v[116:117], v[82:83], v[108:109], v[22:23] op_sel:[0,0,0] op_sel_hi:[0,1,1]
    v_pk_fma_f32 v[118:119], v[82:83], v[110:111], v[54:55] op_sel:[0,0,0] op_sel_hi:[0,1,1]
    v_pk_fma_f32 v[112:113], v[82:83], v[110:111], v[116:117] op_sel:[1,0,0] op_sel_hi:[1,1,1] neg_lo:[1,0,0] neg_hi:[1,0,0]
    v_pk_fma_f32 v[114:115], v[82:83], v[108:109], v[118:119] op_sel:[1,0,0] op_sel_hi:[1,1,1]
    v_pk_fma_f32 v[116:117], v[82:83], v[112:113], v[24:25] op_sel:[0,0,0] op_sel_hi:[0,1,1]
    v_pk_fma_f32 v[118:119], v[82:83], v[114:115], v[56:57] op_sel:[0,0,0] op_sel_hi:[0,1,1]
    v_pk_fma_f32 v[108:109], v[82:83], v[114:115], v[116:117] op_sel:[1,0,0] op_sel_hi:[1,1,1] neg_lo:[1,0,0] neg_hi:[1,0,0]
    v_pk_fma_f32 v[110:111], v[82:83], v[112:113], v[118:119] op_sel:[1,0,0] op_sel_hi:[1,1,1]
    v_pk_fma_f32 v[116:117], v[82:83], v[108:109], v[26:27] op_sel:[0,0,0] op_sel_hi:[0,1,1]
    v_pk_fma_f32 v[118:119], v[82:83], v[110:111], v[58:59] op_sel:[0,0,0] op_sel_hi:[0,1,1]
    v_pk_fma_f32 v[112:113], v[82:83], v[110:111], v[116:117] op_sel:[1,0,0] op_sel_hi:[1,1,1] neg_lo:[1,0,0] neg_hi:[1,0,0]
    v_pk_fma_f32 v[114:115], v[82:83], v[108:109], v[118:119] op_sel:[1,0,0] op_sel_hi:[1,1,1]
    v_pk_fma_f32 v[116:117], v[82:83], v[112:113], v[28:29] op_sel:[0,0,0] op_sel_hi:[0,1,1]
    v_pk_fma_f32 v[118:119], v[82:83], v[114:115], v[60:61] op_sel:[0,0,0] op_sel_hi:[0,1,1]
    v_pk_fma_f32 v[108:109], v[82:83], v[114:115], v[116:117] op_sel:[1,0,0] op_sel_hi:[1,1,1] neg_lo:[1,0,0] neg_hi:[1,0,0]
    v_pk_fma_f32 v[110:111], v[82:83], v[112:113], v[118:119] op_sel:[1,0,0] op_sel_hi:[1,1,1]
    v_pk_fma_f32 v[116:117], v[82:83], v[108:109], v[30:31] op_sel:[0,0,0] op_sel_hi:[0,1,1]
    v_pk_fma_f32 v[118:119], v[82:83], v[110:111], v[62:63] op_sel:[0,0,0] op_sel_hi:[0,1,1]
    v_pk_fma_f32 v[112:113], v[82:83], v[110:111], v[116:117] op_sel:[1,0,0] op_sel_hi:[1,1,1] neg_lo:[1,0,0] neg_hi:[1,0,0]
    v_pk_fma_f32 v[114:115], v[82:83], v[108:109], v[118:119] op_sel:[1,0,0] op_sel_hi:[1,1,1]
    v_pk_fma_f32 v[116:117], v[82:83], v[112:113], v[32:33] op_sel:[0,0,0] op_sel_hi:[0,1,1]
    v_pk_fma_f32 v[118:119], v[82:83], v[114:115], v[64:65] op_sel:[0,0,0] op_sel_hi:[0,1,1]
    v_pk_fma_f32 v[108:109], v[82:83], v[114:115], v[116:117] op_sel:[1,0,0] op_sel_hi:[1,1,1] neg_lo:[1,0,0] neg_hi:[1,0,0]
    v_pk_fma_f32 v[110:111], v[82:83], v[112:113], v[118:119] op_sel:[1,0,0] op_sel_hi:[1,1,1]
    v_pk_fma_f32 v[116:117], v[82:83], v[108:109], v[34:35] op_sel:[0,0,0] op_sel_hi:[0,1,1]
    v_pk_fma_f32 v[118:119], v[82:83], v[110:111], v[66:67] op_sel:[0,0,0] op_sel_hi:[0,1,1]
    v_pk_fma_f32 v[112:113], v[82:83], v[110:111], v[116:117] op_sel:[1,0,0] op_sel_hi:[1,1,1] neg_lo:[1,0,0] neg_hi:[1,0,0]
    v_pk_fma_f32 v[114:115], v[82:83], v[108:109], v[118:119] op_sel:[1,0,0] op_sel_hi:[1,1,1]
    v_pk_fma_f32 v[116:117], v[82:83], v[112:113], v[36:37] op_sel:[0,0,0] op_sel_hi:[0,1,1]
    v_pk_fma_f32 v[118:119], v[82:83], v[114:115], v[68:69] op_sel:[0,0,0] op_sel_hi:[0,1,1]
    v_pk_fma_f32 v[108:109], v[82:83], v[114:115], v[116:117] op_sel:[1,0,0] op_sel_hi:[1,1,1] neg_lo:[1,0,0] neg_hi:[1,0,0]
    v_pk_fma_f32 v[110:111], v[82:83], v[112:113], v[118:119] op_sel:[1,0,0] op_sel_hi:[1,1,1]
    v_pk_fma_f32 v[116:117], v[82:83], v[108:109], v[38:39] op_sel:[0,0,0] op_sel_hi:[0,1,1]
    v_pk_fma_f32 v[118:119], v[82:83], v[110:111], v[70:71] op_sel:[0,0,0] op_sel_hi:[0,1,1]
    v_pk_fma_f32 v[112:113], v[82:83], v[110:111], v[116:117] op_sel:[1,0,0] op_sel_hi:[1,1,1] neg_lo:[1,0,0] neg_hi:[1,0,0]
    v_pk_fma_f32 v[114:115], v[82:83], v[108:109], v[118:119] op_sel:[1,0,0] op_sel_hi:[1,1,1]
    v_mov_b32 v128, v112
    v_mov_b32 v129, v113
    v_mov_b32 v130, v114
    v_mov_b32 v131, v115
    v_fma_f32 v132, v84, v128, v129
    v_fma_f32 v133, v84, v130, v131
    v_fma_f32 v132, -v85, v130, v132
    v_fma_f32 v133, v85, v128, v133
    s_lshl_b32 s68, s4, 9
    s_add_u32 s68, s68, 160512
    v_lshl_add_u32 v148, v1, 3, s68
    v_lshl_add_u32 v149, v2, 3, s68
    ds_write_b64 v148, v[132:133]
    ds_read_b32 v105, v4 offset:48
    s_waitcnt lgkmcnt(0)
    ds_read_b64 v[120:121], v149 offset:0
    ds_read_b64 v[122:123], v149 offset:128
    ds_read_b64 v[124:125], v149 offset:256
    ds_read_b64 v[126:127], v149 offset:384
    v_readfirstlane_b32 s68, v105
    s_nop 1
    s_cmp_lg_u32 s68, 0
    s_cbranch_scc1 gated_mix__ssm_conv_s5__ssm_conv_s4__prompt_kernel_tgo29
gated_mix__ssm_conv_s5__ssm_conv_s4__prompt_kernel_sp30:
    ds_read_b32 v105, v4 offset:48
    s_waitcnt lgkmcnt(0)
    s_nop 0
    v_readfirstlane_b32 s68, v105
    s_nop 1
    s_cmp_ge_u32 s68, 1
    s_cbranch_scc1 gated_mix__ssm_conv_s5__ssm_conv_s4__prompt_kernel_spd31
    s_cmp_eq_u32 s98, 0
    s_cbranch_scc1 gated_mix__ssm_conv_s5__ssm_conv_s4__prompt_kernel_spd31
    s_sub_u32 s98, s98, 1
    s_sleep 1
    s_branch gated_mix__ssm_conv_s5__ssm_conv_s4__prompt_kernel_sp30
gated_mix__ssm_conv_s5__ssm_conv_s4__prompt_kernel_spd31:
gated_mix__ssm_conv_s5__ssm_conv_s4__prompt_kernel_tgo29:
    s_waitcnt lgkmcnt(0)
    v_fma_f32 v134, v86, v120, v122
    v_fma_f32 v135, v86, v121, v123
    v_fma_f32 v134, -v87, v121, v134
    v_fma_f32 v135, v87, v120, v135
    v_fma_f32 v136, v86, v134, v124
    v_fma_f32 v137, v86, v135, v125
    v_fma_f32 v136, -v87, v135, v136
    v_fma_f32 v137, v87, v134, v137
    v_fma_f32 v140, v86, v136, v126
    v_fma_f32 v142, v86, v137, v127
    v_fma_f32 v140, -v87, v137, v140
    v_fma_f32 v142, v87, v136, v142
    v_mov_b32 v141, v105
    v_mov_b32 v143, v105
    v_add_u32 v152, s74, v2
    v_lshlrev_b32 v152, 4, v152
    s_mul_i32 s68, s5, 10240
    s_add_u32 s68, s68, 10551296
    s_mov_b64 exec, 0xffff
    buffer_store_dwordx4 v[140:143], v152, s[44:47], s68 offen sc1
    s_mov_b64 exec, -1
    v_mov_b32 v150, 0
    v_mov_b32 v151, 0
    v_cmp_eq_u32 vcc, 1, v3
    s_nop 1
    v_cndmask_b32 v150, v150, v120, vcc
    v_cndmask_b32 v151, v151, v121, vcc
    v_cmp_eq_u32 vcc, 2, v3
    s_nop 1
    v_cndmask_b32 v150, v150, v134, vcc
    v_cndmask_b32 v151, v151, v135, vcc
    v_cmp_eq_u32 vcc, 3, v3
    s_nop 1
    v_cndmask_b32 v150, v150, v136, vcc
    v_cndmask_b32 v151, v151, v137, vcc
    v_mul_u32_u24 v158, 10240, v3
    v_add_u32 v158, v158, v152
    v_mov_b32 v144, 0x40000000
    v_add_u32 v145, 12, v3
    v_cmp_gt_u32 vcc, s5, v145
    s_nop 1
    v_cndmask_b32 v78, v144, v158, vcc
    v_add_u32 v145, 8, v3
    v_cmp_gt_u32 vcc, s5, v145
    s_nop 1
    v_cndmask_b32 v77, v144, v158, vcc
    v_add_u32 v145, 4, v3
    v_cmp_gt_u32 vcc, s5, v145
    s_nop 1
    v_cndmask_b32 v76, v144, v158, vcc
    v_add_u32 v145, 0, v3
    v_cmp_gt_u32 vcc, s5, v145
    s_nop 1
    v_cndmask_b32 v158, v144, v158, vcc
    v_pk_mul_f32 v[144:145], v[98:99], v[8:9] op_sel:[0,0] op_sel_hi:[0,1]
    v_pk_mul_f32 v[146:147], v[98:99], v[40:41] op_sel:[0,0] op_sel_hi:[0,1] neg_lo:[1,0] neg_hi:[1,0]
    v_pk_fma_f32 v[146:147], v[98:99], v[8:9], v[146:147] op_sel:[1,0,0] op_sel_hi:[1,1,1] neg_lo:[1,0,0] neg_hi:[1,0,0]
    v_pk_fma_f32 v[8:9], v[98:99], v[40:41], v[144:145] op_sel:[1,0,0] op_sel_hi:[1,1,1] neg_lo:[1,0,0] neg_hi:[1,0,0]
    v_mov_b32 v40, v146
    v_mov_b32 v41, v147
    v_pk_mul_f32 v[144:145], v[98:99], v[10:11] op_sel:[0,0] op_sel_hi:[0,1]
    v_pk_mul_f32 v[146:147], v[98:99], v[42:43] op_sel:[0,0] op_sel_hi:[0,1] neg_lo:[1,0] neg_hi:[1,0]
    v_pk_fma_f32 v[146:147], v[98:99], v[10:11], v[146:147] op_sel:[1,0,0] op_sel_hi:[1,1,1] neg_lo:[1,0,0] neg_hi:[1,0,0]
    v_pk_fma_f32 v[10:11], v[98:99], v[42:43], v[144:145] op_sel:[1,0,0] op_sel_hi:[1,1,1] neg_lo:[1,0,0] neg_hi:[1,0,0]
    v_mov_b32 v42, v146
    v_mov_b32 v43, v147
    v_pk_mul_f32 v[144:145], v[98:99], v[12:13] op_sel:[0,0] op_sel_hi:[0,1]
    v_pk_mul_f32 v[146:147], v[98:99], v[44:45] op_sel:[0,0] op_sel_hi:[0,1] neg_lo:[1,0] neg_hi:[1,0]
    v_pk_fma_f32 v[146:147], v[98:99], v[12:13], v[146:147] op_sel:[1,0,0] op_sel_hi:[1,1,1] neg_lo:[1,0,0] neg_hi:[1,0,0]
    v_pk_fma_f32 v[12:13], v[98:99], v[44:45], v[144:145] op_sel:[1,0,0] op_sel_hi:[1,1,1] neg_lo:[1,0,0] neg_hi:[1,0,0]
    v_mov_b32 v44, v146
    v_mov_b32 v45, v147
    v_pk_mul_f32 v[144:145], v[98:99], v[14:15] op_sel:[0,0] op_sel_hi:[0,1]
    v_pk_mul_f32 v[146:147], v[98:99], v[46:47] op_sel:[0,0] op_sel_hi:[0,1] neg_lo:[1,0] neg_hi:[1,0]
    v_pk_fma_f32 v[146:147], v[98:99], v[14:15], v[146:147] op_sel:[1,0,0] op_sel_hi:[1,1,1] neg_lo:[1,0,0] neg_hi:[1,0,0]
    v_pk_fma_f32 v[14:15], v[98:99], v[46:47], v[144:145] op_sel:[1,0,0] op_sel_hi:[1,1,1] neg_lo:[1,0,0] neg_hi:[1,0,0]
    v_mov_b32 v46, v146
    v_mov_b32 v47, v147
    v_pk_mul_f32 v[144:145], v[98:99], v[16:17] op_sel:[0,0] op_sel_hi:[0,1]
    v_pk_mul_f32 v[146:147], v[98:99], v[48:49] op_sel:[0,0] op_sel_hi:[0,1] neg_lo:[1,0] neg_hi:[1,0]
    v_pk_fma_f32 v[146:147], v[98:99], v[16:17], v[146:147] op_sel:[1,0,0] op_sel_hi:[1,1,1] neg_lo:[1,0,0] neg_hi:[1,0,0]
    v_pk_fma_f32 v[16:17], v[98:99], v[48:49], v[144:145] op_sel:[1,0,0] op_sel_hi:[1,1,1] neg_lo:[1,0,0] neg_hi:[1,0,0]
    v_mov_b32 v48, v146
    v_mov_b32 v49, v147
    v_pk_mul_f32 v[144:145], v[98:99], v[18:19] op_sel:[0,0] op_sel_hi:[0,1]
    v_pk_mul_f32 v[146:147], v[98:99], v[50:51] op_sel:[0,0] op_sel_hi:[0,1] neg_lo:[1,0] neg_hi:[1,0]
    v_pk_fma_f32 v[146:147], v[98:99], v[18:19], v[146:147] op_sel:[1,0,0] op_sel_hi:[1,1,1] neg_lo:[1,0,0] neg_hi:[1,0,0]
    v_pk_fma_f32 v[18:19], v[98:99], v[50:51], v[144:145] op_sel:[1,0,0] op_sel_hi:[1,1,1] neg_lo:[1,0,0] neg_hi:[1,0,0]
    v_mov_b32 v50, v146
    v_mov_b32 v51, v147
    s_mov_b32 s68, 10551296
    buffer_load_dwordx4 v[112:115], v158, s[44:47], s68 offen sc1
    s_mov_b32 s68, 10592256
    buffer_load_dwordx4 v[116:119], v76, s[44:47], s68 offen sc1
    s_mov_b32 s68, 10633216
    buffer_load_dwordx4 v[120:123], v77, s[44:47], s68 offen sc1
    s_mov_b32 s68, 10674176
    buffer_load_dwordx4 v[124:127], v78, s[44:47], s68 offen sc1
    v_pk_mul_f32 v[144:145], v[98:99], v[20:21] op_sel:[0,0] op_sel_hi:[0,1]
    v_pk_mul_f32 v[146:147], v[98:99], v[52:53] op_sel:[0,0] op_sel_hi:[0,1] neg_lo:[1,0] neg_hi:[1,0]
    v_pk_fma_f32 v[146:147], v[98:99], v[20:21], v[146:147] op_sel:[1,0,0] op_sel_hi:[1,1,1] neg_lo:[1,0,0] neg_hi:[1,0,0]
    v_pk_fma_f32 v[20:21], v[98:99], v[52:53], v[144:145] op_sel:[1,0,0] op_sel_hi:[1,1,1] neg_lo:[1,0,0] neg_hi:[1,0,0]
    v_mov_b32 v52, v146
    v_mov_b32 v53, v147
    v_pk_mul_f32 v[144:145], v[98:99], v[22:23] op_sel:[0,0] op_sel_hi:[0,1]
    v_pk_mul_f32 v[146:147], v[98:99], v[54:55] op_sel:[0,0] op_sel_hi:[0,1] neg_lo:[1,0] neg_hi:[1,0]
    v_pk_fma_f32 v[146:147], v[98:99], v[22:23], v[146:147] op_sel:[1,0,0] op_sel_hi:[1,1,1] neg_lo:[1,0,0] neg_hi:[1,0,0]
    v_pk_fma_f32 v[22:23], v[98:99], v[54:55], v[144:145] op_sel:[1,0,0] op_sel_hi:[1,1,1] neg_lo:[1,0,0] neg_hi:[1,0,0]
    v_mov_b32 v54, v146
    v_mov_b32 v55, v147
    v_pk_mul_f32 v[144:145], v[98:99], v[24:25] op_sel:[0,0] op_sel_hi:[0,1]
    v_pk_mul_f32 v[146:147], v[98:99], v[56:57] op_sel:[0,0] op_sel_hi:[0,1] neg_lo:[1,0] neg_hi:[1,0]
    v_pk_fma_f32 v[146:147], v[98:99], v[24:25], v[146:147] op_sel:[1,0,0] op_sel_hi:[1,1,1] neg_lo:[1,0,0] neg_hi:[1,0,0]
    v_pk_fma_f32 v[24:25], v[98:99], v[56:57], v[144:145] op_sel:[1,0,0] op_sel_hi:[1,1,1] neg_lo:[1,0,0] neg_hi:[1,0,0]
    v_mov_b32 v56, v146
    v_mov_b32 v57, v147
    v_pk_mul_f32 v[144:145], v[98:99], v[26:27] op_sel:[0,0] op_sel_hi:[0,1]
    v_pk_mul_f32 v[146:147], v[98:99], v[58:59] op_sel:[0,0] op_sel_hi:[0,1] neg_lo:[1,0] neg_hi:[1,0]
    v_pk_fma_f32 v[146:147], v[98:99], v[26:27], v[146:147] op_sel:[1,0,0] op_sel_hi:[1,1,1] neg_lo:[1,0,0] neg_hi:[1,0,0]
    v_pk_fma_f32 v[26:27], v[98:99], v[58:59], v[144:145] op_sel:[1,0,0] op_sel_hi:[1,1,1] neg_lo:[1,0,0] neg_hi:[1,0,0]
    v_mov_b32 v58, v146
    v_mov_b32 v59, v147
    v_pk_mul_f32 v[144:145], v[98:99], v[28:29] op_sel:[0,0] op_sel_hi:[0,1]
    v_pk_mul_f32 v[146:147], v[98:99], v[60:61] op_sel:[0,0] op_sel_hi:[0,1] neg_lo:[1,0] neg_hi:[1,0]
    v_pk_fma_f32 v[146:147], v[98:99], v[28:29], v[146:147] op_sel:[1,0,0] op_sel_hi:[1,1,1] neg_lo:[1,0,0] neg_hi:[1,0,0]
    v_pk_fma_f32 v[28:29], v[98:99], v[60:61], v[144:145] op_sel:[1,0,0] op_sel_hi:[1,1,1] neg_lo:[1,0,0] neg_hi:[1,0,0]
    v_mov_b32 v60, v146
    v_mov_b32 v61, v147
    v_pk_mul_f32 v[144:145], v[98:99], v[30:31] op_sel:[0,0] op_sel_hi:[0,1]
    v_pk_mul_f32 v[146:147], v[98:99], v[62:63] op_sel:[0,0] op_sel_hi:[0,1] neg_lo:[1,0] neg_hi:[1,0]
    v_pk_fma_f32 v[146:147], v[98:99], v[30:31], v[146:147] op_sel:[1,0,0] op_sel_hi:[1,1,1] neg_lo:[1,0,0] neg_hi:[1,0,0]
    v_pk_fma_f32 v[30:31], v[98:99], v[62:63], v[144:145] op_sel:[1,0,0] op_sel_hi:[1,1,1] neg_lo:[1,0,0] neg_hi:[1,0,0]
    v_mov_b32 v62, v146
    v_mov_b32 v63, v147
    v_pk_mul_f32 v[144:145], v[98:99], v[32:33] op_sel:[0,0] op_sel_hi:[0,1]
    v_pk_mul_f32 v[146:147], v[98:99], v[64:65] op_sel:[0,0] op_sel_hi:[0,1] neg_lo:[1,0] neg_hi:[1,0]
    v_pk_fma_f32 v[146:147], v[98:99], v[32:33], v[146:147] op_sel:[1,0,0] op_sel_hi:[1,1,1] neg_lo:[1,0,0] neg_hi:[1,0,0]
    v_pk_fma_f32 v[32:33], v[98:99], v[64:65], v[144:145] op_sel:[1,0,0] op_sel_hi:[1,1,1] neg_lo:[1,0,0] neg_hi:[1,0,0]
    v_mov_b32 v64, v146
    v_mov_b32 v65, v147
    v_pk_mul_f32 v[144:145], v[98:99], v[34:35] op_sel:[0,0] op_sel_hi:[0,1]
    v_pk_mul_f32 v[146:147], v[98:99], v[66:67] op_sel:[0,0] op_sel_hi:[0,1] neg_lo:[1,0] neg_hi:[1,0]
    v_pk_fma_f32 v[146:147], v[98:99], v[34:35], v[146:147] op_sel:[1,0,0] op_sel_hi:[1,1,1] neg_lo:[1,0,0] neg_hi:[1,0,0]
    v_pk_fma_f32 v[34:35], v[98:99], v[66:67], v[144:145] op_sel:[1,0,0] op_sel_hi:[1,1,1] neg_lo:[1,0,0] neg_hi:[1,0,0]
    v_mov_b32 v66, v146
    v_mov_b32 v67, v147
    v_pk_mul_f32 v[144:145], v[98:99], v[36:37] op_sel:[0,0] op_sel_hi:[0,1]
    v_pk_mul_f32 v[146:147], v[98:99], v[68:69] op_sel:[0,0] op_sel_hi:[0,1] neg_lo:[1,0] neg_hi:[1,0]
    v_pk_fma_f32 v[146:147], v[98:99], v[36:37], v[146:147] op_sel:[1,0,0] op_sel_hi:[1,1,1] neg_lo:[1,0,0] neg_hi:[1,0,0]
    v_pk_fma_f32 v[36:37], v[98:99], v[68:69], v[144:145] op_sel:[1,0,0] op_sel_hi:[1,1,1] neg_lo:[1,0,0] neg_hi:[1,0,0]
    v_mov_b32 v68, v146
    v_mov_b32 v69, v147
    v_pk_mul_f32 v[144:145], v[98:99], v[38:39] op_sel:[0,0] op_sel_hi:[0,1]
    v_pk_mul_f32 v[146:147], v[98:99], v[70:71] op_sel:[0,0] op_sel_hi:[0,1] neg_lo:[1,0] neg_hi:[1,0]
    v_pk_fma_f32 v[146:147], v[98:99], v[38:39], v[146:147] op_sel:[1,0,0] op_sel_hi:[1,1,1] neg_lo:[1,0,0] neg_hi:[1,0,0]
    v_pk_fma_f32 v[38:39], v[98:99], v[70:71], v[144:145] op_sel:[1,0,0] op_sel_hi:[1,1,1] neg_lo:[1,0,0] neg_hi:[1,0,0]
    v_mov_b32 v70, v146
    v_mov_b32 v71, v147
    v_mov_b32 v154, v82
    v_sub_f32 v155, 0, v83
    v_mov_b32 v156, 0
    v_mov_b32 v157, 0
    s_cmp_eq_u32 s5, 0
    s_cbranch_scc1 gated_mix__ssm_conv_s5__ssm_conv_s4__prompt_kernel_nolb32
    s_branch gated_mix__ssm_conv_s5__ssm_conv_s4__prompt_kernel_chk35
gated_mix__ssm_conv_s5__ssm_conv_s4__prompt_kernel_poll33:
    s_mov_b32 s68, 10551296
    buffer_load_dwordx4 v[112:115], v158, s[44:47], s68 offen sc1
    s_mov_b32 s68, 10592256
    buffer_load_dwordx4 v[116:119], v76, s[44:47], s68 offen sc1
    s_mov_b32 s68, 10633216
    buffer_load_dwordx4 v[120:123], v77, s[44:47], s68 offen sc1
    s_mov_b32 s68, 10674176
    buffer_load_dwordx4 v[124:127], v78, s[44:47], s68 offen sc1
gated_mix__ssm_conv_s5__ssm_conv_s4__prompt_kernel_chk35:
    s_waitcnt vmcnt(0)
    s_mov_b64 s[14:15], -1
    v_cmp_eq_u32 s[16:17], v113, v105
    v_cmp_eq_u32 s[18:19], v115, v105
    v_add_u32 v132, 0, v3
    v_cmp_le_u32 s[20:21], s5, v132
    s_and_b64 s[16:17], s[16:17], s[18:19]
    s_or_b64 s[16:17], s[16:17], s[20:21]
    s_and_b64 s[14:15], s[14:15], s[16:17]
    v_cmp_eq_u32 s[16:17], v117, v105
    v_cmp_eq_u32 s[18:19], v119, v105
    v_add_u32 v132, 4, v3
    v_cmp_le_u32 s[20:21], s5, v132
    s_and_b64 s[16:17], s[16:17], s[18:19]
    s_or_b64 s[16:17], s[16:17], s[20:21]
    s_and_b64 s[14:15], s[14:15], s[16:17]
    v_cmp_eq_u32 s[16:17], v121, v105
    v_cmp_eq_u32 s[18:19], v123, v105
    v_add_u32 v132, 8, v3
    v_cmp_le_u32 s[20:21], s5, v132
    s_and_b64 s[16:17], s[16:17], s[18:19]
    s_or_b64 s[16:17], s[16:17], s[20:21]
    s_and_b64 s[14:15], s[14:15], s[16:17]
    v_cmp_eq_u32 s[16:17], v125, v105
    v_cmp_eq_u32 s[18:19], v127, v105
    v_add_u32 v132, 12, v3
    v_cmp_le_u32 s[20:21], s5, v132
    s_and_b64 s[16:17], s[16:17], s[18:19]
    s_or_b64 s[16:17], s[16:17], s[20:21]
    s_and_b64 s[14:15], s[14:15], s[16:17]
    s_cmp_eq_u64 s[14:15], -1
    s_cbranch_scc1 gated_mix__ssm_conv_s5__ssm_conv_s4__prompt_kernel_got34
    s_cmp_eq_u32 s98, 0
    s_cbranch_scc1 gated_mix__ssm_conv_s5__ssm_conv_s4__prompt_kernel_got34
    s_sub_u32 s98, s98, 1
    s_sleep 1
    s_branch gated_mix__ssm_conv_s5__ssm_conv_s4__prompt_kernel_poll33
gated_mix__ssm_conv_s5__ssm_conv_s4__prompt_kernel_got34:
    v_add_u32 v76, 0, v3
    v_cmp_gt_u32 vcc, s5, v76
    s_nop 1
    v_cndmask_b32 v112, 0, v112, vcc
    v_cndmask_b32 v114, 0, v114, vcc
    v_fma_f32 v156, v90, v112, v156
    v_fma_f32 v157, v90, v114, v157
    v_fma_f32 v156, -v91, v114, v156
    v_fma_f32 v157, v91, v112, v157
    v_add_u32 v76, 4, v3
    v_cmp_gt_u32 vcc, s5, v76
    s_nop 1
    v_cndmask_b32 v116, 0, v116, vcc
    v_cndmask_b32 v118, 0, v118, vcc
    v_fma_f32 v156, v92, v116, v156
    v_fma_f32 v157, v92, v118, v157
    v_fma_f32 v156, -v93, v118, v156
    v_fma_f32 v157, v93, v116, v157
    v_add_u32 v76, 8, v3
    v_cmp_gt_u32 vcc, s5, v76
    s_nop 1
    v_cndmask_b32 v120, 0, v120, vcc
    v_cndmask_b32 v122, 0, v122, vcc
    v_fma_f32 v156, v94, v120, v156
    v_fma_f32 v157, v94, v122, v157
    v_fma_f32 v156, -v95, v122, v156
    v_fma_f32 v157, v95, v120, v157
    v_add_u32 v76, 12, v3
    v_cmp_gt_u32 vcc, s5, v76
    s_nop 1
    v_cndmask_b32 v124, 0, v124, vcc
    v_cndmask_b32 v126, 0, v126, vcc
    v_fma_f32 v156, v96, v124, v156
    v_fma_f32 v157, v96, v126, v157
    v_fma_f32 v156, -v97, v126, v156
    v_fma_f32 v157, v97, v124, v157
    ds_write_b64 v148, v[156:157]
    s_waitcnt lgkmcnt(0)
    ds_read_b64 v[120:121], v149 offset:0
    ds_read_b64 v[122:123], v149 offset:128
    ds_read_b64 v[124:125], v149 offset:256
    ds_read_b64 v[126:127], v149 offset:384
    s_waitcnt lgkmcnt(0)
    v_add_f32 v156, v120, v122
    v_add_f32 v157, v121, v123
    v_add_f32 v124, v124, v126
    v_add_f32 v125, v125, v127
    v_add_f32 v156, v156, v124
    v_add_f32 v157, v157, v125
gated_mix__ssm_conv_s5__ssm_conv_s4__prompt_kernel_nolb32:
    s_waitcnt vmcnt(0)
    v_fma_f32 v158, v88, v156, v150
    v_fma_f32 v159, v88, v157, v151
    v_fma_f32 v158, -v89, v157, v158
    v_fma_f32 v159, v89, v156, v159
    v_fma_f32 v160, v84, v158, v128
    v_fma_f32 v161, v84, v159, v130
    v_fma_f32 v160, -v85, v159, v160
    v_fma_f32 v161, v85, v158, v161
    v_mul_f32 v108, v98, v158
    v_fma_f32 v108, -v99, v159, v108
    v_mul_f32 v110, -v98, v159
    v_fma_f32 v110, -v99, v158, v110
    v_mul_f32 v109, v98, v160
    v_fma_f32 v109, -v99, v161, v109
    v_mul_f32 v111, -v98, v161
    v_fma_f32 v111, -v99, v160, v111
gated_mix__ssm_conv_s5__ssm_conv_s4__prompt_kernel_sp36:
    ds_read_b128 v[120:123], v4 offset:16
    s_waitcnt lgkmcnt(0)
    v_min_u32 v120, v120, v121
    v_min_u32 v122, v122, v123
    v_min_u32 v120, v120, v122
    s_nop 0
    v_readfirstlane_b32 s68, v120
    s_nop 1
    s_cmp_ge_u32 s68, 10
    s_cbranch_scc1 gated_mix__ssm_conv_s5__ssm_conv_s4__prompt_kernel_spd37
    s_cmp_eq_u32 s98, 0
    s_cbranch_scc1 gated_mix__ssm_conv_s5__ssm_conv_s4__prompt_kernel_spd37
    s_sub_u32 s98, s98, 1
    s_sleep 1
    s_branch gated_mix__ssm_conv_s5__ssm_conv_s4__prompt_kernel_sp36
gated_mix__ssm_conv_s5__ssm_conv_s4__prompt_kernel_spd37:
    v_mul_u32_u24 v162, 8512, v3
    v_lshl_add_u32 v162, v2, 2, v162
    s_lshl_b32 s68, s4, 6
    s_add_u32 s68, s68, 45568
    v_add_u32 v162, s68, v162
    v_pk_fma_f32 v[8:9], v[154:155], v[108:109], v[8:9] op_sel:[0,0,0] op_sel_hi:[0,1,1]
    v_pk_fma_f32 v[40:41], v[154:155], v[110:111], v[40:41] op_sel:[0,0,0] op_sel_hi:[0,1,1]
    v_pk_fma_f32 v[8:9], v[154:155], v[110:111], v[8:9] op_sel:[1,0,0] op_sel_hi:[1,1,1] neg_lo:[1,0,0] neg_hi:[1,0,0]
    v_pk_fma_f32 v[40:41], v[154:155], v[108:109], v[40:41] op_sel:[1,0,0] op_sel_hi:[1,1,1]
    v_pk_fma_f32 v[10:11], v[154:155], v[8:9], v[10:11] op_sel:[0,0,0] op_sel_hi:[0,1,1]
    v_pk_fma_f32 v[42:43], v[154:155], v[40:41], v[42:43] op_sel:[0,0,0] op_sel_hi:[0,1,1]
    v_pk_fma_f32 v[10:11], v[154:155], v[40:41], v[10:11] op_sel:[1,0,0] op_sel_hi:[1,1,1] neg_lo:[1,0,0] neg_hi:[1,0,0]
    v_pk_fma_f32 v[42:43], v[154:155], v[8:9], v[42:43] op_sel:[1,0,0] op_sel_hi:[1,1,1]
    v_cvt_pk_bf16_f32 v112, v8, v10
    v_cvt_pk_bf16_f32 v113, v9, v11
    v_cvt_pk_bf16_f32 v114, v40, v42
    v_cvt_pk_bf16_f32 v115, v41, v43
    ds_write_b32 v162, v112 offset:0
    ds_write_b32 v162, v113 offset:4224
    ds_write_b32 v162, v114 offset:256
    ds_write_b32 v162, v115 offset:4480
    v_pk_fma_f32 v[12:13], v[154:155], v[10:11], v[12:13] op_sel:[0,0,0] op_sel_hi:[0,1,1]
    v_pk_fma_f32 v[44:45], v[154:155], v[42:43], v[44:45] op_sel:[0,0,0] op_sel_hi:[0,1,1]
    v_pk_fma_f32 v[12:13], v[154:155], v[42:43], v[12:13] op_sel:[1,0,0] op_sel_hi:[1,1,1] neg_lo:[1,0,0] neg_hi:[1,0,0]
    v_pk_fma_f32 v[44:45], v[154:155], v[10:11], v[44:45] op_sel:[1,0,0] op_sel_hi:[1,1,1]
    v_pk_fma_f32 v[14:15], v[154:155], v[12:13], v[14:15] op_sel:[0,0,0] op_sel_hi:[0,1,1]
    v_pk_fma_f32 v[46:47], v[154:155], v[44:45], v[46:47] op_sel:[0,0,0] op_sel_hi:[0,1,1]
    v_pk_fma_f32 v[14:15], v[154:155], v[44:45], v[14:15] op_sel:[1,0,0] op_sel_hi:[1,1,1] neg_lo:[1,0,0] neg_hi:[1,0,0]
    v_pk_fma_f32 v[46:47], v[154:155], v[12:13], v[46:47] op_sel:[1,0,0] op_sel_hi:[1,1,1]
    v_cvt_pk_bf16_f32 v112, v12, v14
    v_cvt_pk_bf16_f32 v113, v13, v15
    v_cvt_pk_bf16_f32 v114, v44, v46
    v_cvt_pk_bf16_f32 v115, v45, v47
    ds_write_b32 v162, v112 offset:528
    ds_write_b32 v162, v113 offset:4752
    ds_write_b32 v162, v114 offset:784
    ds_write_b32 v162, v115 offset:5008
    v_pk_fma_f32 v[16:17], v[154:155], v[14:15], v[16:17] op_sel:[0,0,0] op_sel_hi:[0,1,1]
    v_pk_fma_f32 v[48:49], v[154:155], v[46:47], v[48:49] op_sel:[0,0,0] op_sel_hi:[0,1,1]
    v_pk_fma_f32 v[16:17], v[154:155], v[46:47], v[16:17] op_sel:[1,0,0] op_sel_hi:[1,1,1] neg_lo:[1,0,0] neg_hi:[1,0,0]
    v_pk_fma_f32 v[48:49], v[154:155], v[14:15], v[48:49] op_sel:[1,0,0] op_sel_hi:[1,1,1]
    v_pk_fma_f32 v[18:19], v[154:155], v[16:17], v[18:19] op_sel:[0,0,0] op_sel_hi:[0,1,1]
    v_pk_fma_f32 v[50:51], v[154:155], v[48:49], v[50:51] op_sel:[0,0,0] op_sel_hi:[0,1,1]
    v_pk_fma_f32 v[18:19], v[154:155], v[48:49], v[18:19] op_sel:[1,0,0] op_sel_hi:[1,1,1] neg_lo:[1,0,0] neg_hi:[1,0,0]
    v_pk_fma_f32 v[50:51], v[154:155], v[16:17], v[50:51] op_sel:[1,0,0] op_sel_hi:[1,1,1]
    v_cvt_pk_bf16_f32 v112, v16, v18
    v_cvt_pk_bf16_f32 v113, v17, v19
    v_cvt_pk_bf16_f32 v114, v48, v50
    v_cvt_pk_bf16_f32 v115, v49, v51
    ds_write_b32 v162, v112 offset:1056
    ds_write_b32 v162, v113 offset:5280
    ds_write_b32 v162, v114 offset:1312
    ds_write_b32 v162, v115 offset:5536
    v_pk_fma_f32 v[20:21], v[154:155], v[18:19], v[20:21] op_sel:[0,0,0] op_sel_hi:[0,1,1]
    v_pk_fma_f32 v[52:53], v[154:155], v[50:51], v[52:53] op_sel:[0,0,0] op_sel_hi:[0,1,1]
    v_pk_fma_f32 v[20:21], v[154:155], v[50:51], v[20:21] op_sel:[1,0,0] op_sel_hi:[1,1,1] neg_lo:[1,0,0] neg_hi:[1,0,0]
    v_pk_fma_f32 v[52:53], v[154:155], v[18:19], v[52:53] op_sel:[1,0,0] op_sel_hi:[1,1,1]
    v_pk_fma_f32 v[22:23], v[154:155], v[20:21], v[22:23] op_sel:[0,0,0] op_sel_hi:[0,1,1]
    v_pk_fma_f32 v[54:55], v[154:155], v[52:53], v[54:55] op_sel:[0,0,0] op_sel_hi:[0,1,1]
    v_pk_fma_f32 v[22:23], v[154:155], v[52:53], v[22:23] op_sel:[1,0,0] op_sel_hi:[1,1,1] neg_lo:[1,0,0] neg_hi:[1,0,0]
    v_pk_fma_f32 v[54:55], v[154:155], v[20:21], v[54:55] op_sel:[1,0,0] op_sel_hi:[1,1,1]
    v_cvt_pk_bf16_f32 v112, v20, v22
    v_cvt_pk_bf16_f32 v113, v21, v23
    v_cvt_pk_bf16_f32 v114, v52, v54
    v_cvt_pk_bf16_f32 v115, v53, v55
    ds_write_b32 v162, v112 offset:1584
    ds_write_b32 v162, v113 offset:5808
    ds_write_b32 v162, v114 offset:1840
    ds_write_b32 v162, v115 offset:6064
    v_pk_fma_f32 v[24:25], v[154:155], v[22:23], v[24:25] op_sel:[0,0,0] op_sel_hi:[0,1,1]
    v_pk_fma_f32 v[56:57], v[154:155], v[54:55], v[56:57] op_sel:[0,0,0] op_sel_hi:[0,1,1]
    v_pk_fma_f32 v[24:25], v[154:155], v[54:55], v[24:25] op_sel:[1,0,0] op_sel_hi:[1,1,1] neg_lo:[1,0,0] neg_hi:[1,0,0]
    v_pk_fma_f32 v[56:57], v[154:155], v[22:23], v[56:57] op_sel:[1,0,0] op_sel_hi:[1,1,1]
    v_pk_fma_f32 v[26:27], v[154:155], v[24:25], v[26:27] op_sel:[0,0,0] op_sel_hi:[0,1,1]
    v_pk_fma_f32 v[58:59], v[154:155], v[56:57], v[58:59] op_sel:[0,0,0] op_sel_hi:[0,1,1]
    v_pk_fma_f32 v[26:27], v[154:155], v[56:57], v[26:27] op_sel:[1,0,0] op_sel_hi:[1,1,1] neg_lo:[1,0,0] neg_hi:[1,0,0]
    v_pk_fma_f32 v[58:59], v[154:155], v[24:25], v[58:59] op_sel:[1,0,0] op_sel_hi:[1,1,1]
    v_cvt_pk_bf16_f32 v112, v24, v26
    v_cvt_pk_bf16_f32 v113, v25, v27
    v_cvt_pk_bf16_f32 v114, v56, v58
    v_cvt_pk_bf16_f32 v115, v57, v59
    ds_write_b32 v162, v112 offset:2112
    ds_write_b32 v162, v113 offset:6336
    ds_write_b32 v162, v114 offset:2368
    ds_write_b32 v162, v115 offset:6592
    v_pk_fma_f32 v[28:29], v[154:155], v[26:27], v[28:29] op_sel:[0,0,0] op_sel_hi:[0,1,1]
    v_pk_fma_f32 v[60:61], v[154:155], v[58:59], v[60:61] op_sel:[0,0,0] op_sel_hi:[0,1,1]
    v_pk_fma_f32 v[28:29], v[154:155], v[58:59], v[28:29] op_sel:[1,0,0] op_sel_hi:[1,1,1] neg_lo:[1,0,0] neg_hi:[1,0,0]
    v_pk_fma_f32 v[60:61], v[154:155], v[26:27], v[60:61] op_sel:[1,0,0] op_sel_hi:[1,1,1]
    v_pk_fma_f32 v[30:31], v[154:155], v[28:29], v[30:31] op_sel:[0,0,0] op_sel_hi:[0,1,1]
    v_pk_fma_f32 v[62:63], v[154:155], v[60:61], v[62:63] op_sel:[0,0,0] op_sel_hi:[0,1,1]
    v_pk_fma_f32 v[30:31], v[154:155], v[60:61], v[30:31] op_sel:[1,0,0] op_sel_hi:[1,1,1] neg_lo:[1,0,0] neg_hi:[1,0,0]
    v_pk_fma_f32 v[62:63], v[154:155], v[28:29], v[62:63] op_sel:[1,0,0] op_sel_hi:[1,1,1]
    v_cvt_pk_bf16_f32 v112, v28, v30
    v_cvt_pk_bf16_f32 v113, v29, v31
    v_cvt_pk_bf16_f32 v114, v60, v62
    v_cvt_pk_bf16_f32 v115, v61, v63
    ds_write_b32 v162, v112 offset:2640
    ds_write_b32 v162, v113 offset:6864
    ds_write_b32 v162, v114 offset:2896
    ds_write_b32 v162, v115 offset:7120
    v_pk_fma_f32 v[32:33], v[154:155], v[30:31], v[32:33] op_sel:[0,0,0] op_sel_hi:[0,1,1]
    v_pk_fma_f32 v[64:65], v[154:155], v[62:63], v[64:65] op_sel:[0,0,0] op_sel_hi:[0,1,1]
    v_pk_fma_f32 v[32:33], v[154:155], v[62:63], v[32:33] op_sel:[1,0,0] op_sel_hi:[1,1,1] neg_lo:[1,0,0] neg_hi:[1,0,0]
    v_pk_fma_f32 v[64:65], v[154:155], v[30:31], v[64:65] op_sel:[1,0,0] op_sel_hi:[1,1,1]
    v_pk_fma_f32 v[34:35], v[154:155], v[32:33], v[34:35] op_sel:[0,0,0] op_sel_hi:[0,1,1]
    v_pk_fma_f32 v[66:67], v[154:155], v[64:65], v[66:67] op_sel:[0,0,0] op_sel_hi:[0,1,1]
    v_pk_fma_f32 v[34:35], v[154:155], v[64:65], v[34:35] op_sel:[1,0,0] op_sel_hi:[1,1,1] neg_lo:[1,0,0] neg_hi:[1,0,0]
    v_pk_fma_f32 v[66:67], v[154:155], v[32:33], v[66:67] op_sel:[1,0,0] op_sel_hi:[1,1,1]
    v_cvt_pk_bf16_f32 v112, v32, v34
    v_cvt_pk_bf16_f32 v113, v33, v35
    v_cvt_pk_bf16_f32 v114, v64, v66
    v_cvt_pk_bf16_f32 v115, v65, v67
    ds_write_b32 v162, v112 offset:3168
    ds_write_b32 v162, v113 offset:7392
    ds_write_b32 v162, v114 offset:3424
    ds_write_b32 v162, v115 offset:7648
    v_pk_fma_f32 v[36:37], v[154:155], v[34:35], v[36:37] op_sel:[0,0,0] op_sel_hi:[0,1,1]
    v_pk_fma_f32 v[68:69], v[154:155], v[66:67], v[68:69] op_sel:[0,0,0] op_sel_hi:[0,1,1]
    v_pk_fma_f32 v[36:37], v[154:155], v[66:67], v[36:37] op_sel:[1,0,0] op_sel_hi:[1,1,1] neg_lo:[1,0,0] neg_hi:[1,0,0]
    v_pk_fma_f32 v[68:69], v[154:155], v[34:35], v[68:69] op_sel:[1,0,0] op_sel_hi:[1,1,1]
    v_pk_fma_f32 v[38:39], v[154:155], v[36:37], v[38:39] op_sel:[0,0,0] op_sel_hi:[0,1,1]
    v_pk_fma_f32 v[70:71], v[154:155], v[68:69], v[70:71] op_sel:[0,0,0] op_sel_hi:[0,1,1]
    v_pk_fma_f32 v[38:39], v[154:155], v[68:69], v[38:39] op_sel:[1,0,0] op_sel_hi:[1,1,1] neg_lo:[1,0,0] neg_hi:[1,0,0]
    v_pk_fma_f32 v[70:71], v[154:155], v[36:37], v[70:71] op_sel:[1,0,0] op_sel_hi:[1,1,1]
    v_cvt_pk_bf16_f32 v112, v36, v38
    v_cvt_pk_bf16_f32 v113, v37, v39
    v_cvt_pk_bf16_f32 v114, v68, v70
    v_cvt_pk_bf16_f32 v115, v69, v71
    ds_write_b32 v162, v112 offset:3696
    ds_write_b32 v162, v113 offset:7920
    ds_write_b32 v162, v114 offset:3952
    ds_write_b32 v162, v115 offset:8176
    s_waitcnt lgkmcnt(0)
    ds_write_b32 v79, v80 offset:96
gated_mix__ssm_conv_s5__ssm_conv_s4__prompt_kernel_sp38:
    ds_read_b128 v[120:123], v4 offset:96
    s_waitcnt lgkmcnt(0)
    v_min_u32 v120, v120, v121
    v_min_u32 v122, v122, v123
    v_min_u32 v120, v120, v122
    s_nop 0
    v_readfirstlane_b32 s68, v120
    s_nop 1
    s_cmp_ge_u32 s68, 1
    s_cbranch_scc1 gated_mix__ssm_conv_s5__ssm_conv_s4__prompt_kernel_spd39
    s_cmp_eq_u32 s98, 0
    s_cbranch_scc1 gated_mix__ssm_conv_s5__ssm_conv_s4__prompt_kernel_spd39
    s_sub_u32 s98, s98, 1
    s_sleep 0
    s_branch gated_mix__ssm_conv_s5__ssm_conv_s4__prompt_kernel_sp38
gated_mix__ssm_conv_s5__ssm_conv_s4__prompt_kernel_spd39:
    v_mul_u32_u24 v77, 528, v3
    v_lshl_add_u32 v77, v2, 5, v77
    s_mul_i32 s69, s4, 8512
    s_add_u32 s69, s69, 45568
    v_add_u32 v77, s69, v77
    ds_read_b128 v[8:11], v77 offset:0
    ds_read_b128 v[12:15], v77 offset:16
    ds_read_b128 v[16:19], v77 offset:2112
    ds_read_b128 v[20:23], v77 offset:2128
    ds_read_b128 v[24:27], v77 offset:4224
    ds_read_b128 v[28:31], v77 offset:4240
    ds_read_b128 v[32:35], v77 offset:6336
    ds_read_b128 v[36:39], v77 offset:6352
    s_lshl_b32 s68, s4, 5
    v_lshlrev_b32 v76, 1, v3
    v_add_u32 v76, s68, v76
    v_mul_u32_u24 v76, 2560, v76
    v_lshl_add_u32 v76, v2, 4, v76
    s_lshl_b32 s68, s5, 7
    s_mul_i32 s68, s68, 2560
    s_lshl_b32 s69, s6, 8
    s_add_u32 s68, s68, s69
    s_mov_b32 s70, 0x05040100
    s_mov_b32 s71, 0x07060302
    s_waitcnt lgkmcnt(6)
    v_perm_b32 v40, v9, v8, s70
    v_perm_b32 v44, v9, v8, s71
    v_perm_b32 v41, v11, v10, s70
    v_perm_b32 v45, v11, v10, s71
    v_perm_b32 v42, v13, v12, s70
    v_perm_b32 v46, v13, v12, s71
    v_perm_b32 v43, v15, v14, s70
    v_perm_b32 v47, v15, v14, s71
    s_add_u32 s69, s68, 0
    buffer_store_dwordx4 v[40:43], v76, s[44:47], s69 offen sc1
    s_add_u32 s69, s69, 2560
    buffer_store_dwordx4 v[44:47], v76, s[44:47], s69 offen sc1
    s_waitcnt lgkmcnt(4)
    v_perm_b32 v48, v17, v16, s70
    v_perm_b32 v52, v17, v16, s71
    v_perm_b32 v49, v19, v18, s70
    v_perm_b32 v53, v19, v18, s71
    v_perm_b32 v50, v21, v20, s70
    v_perm_b32 v54, v21, v20, s71
    v_perm_b32 v51, v23, v22, s70
    v_perm_b32 v55, v23, v22, s71
    s_add_u32 s69, s68, 20480
    buffer_store_dwordx4 v[48:51], v76, s[44:47], s69 offen sc1
    s_add_u32 s69, s69, 2560
    buffer_store_dwordx4 v[52:55], v76, s[44:47], s69 offen sc1
    s_waitcnt lgkmcnt(2)
    v_perm_b32 v56, v25, v24, s70
    v_perm_b32 v60, v25, v24, s71
    v_perm_b32 v57, v27, v26, s70
    v_perm_b32 v61, v27, v26, s71
    v_perm_b32 v58, v29, v28, s70
    v_perm_b32 v62, v29, v28, s71
    v_perm_b32 v59, v31, v30, s70
    v_perm_b32 v63, v31, v30, s71
    s_add_u32 s69, s68, 40960
    buffer_store_dwordx4 v[56:59], v76, s[44:47], s69 offen sc1
    s_add_u32 s69, s69, 2560
    buffer_store_dwordx4 v[60:63], v76, s[44:47], s69 offen sc1
    s_waitcnt lgkmcnt(0)
    v_perm_b32 v64, v33, v32, s70
    v_perm_b32 v68, v33, v32, s71
    v_perm_b32 v65, v35, v34, s70
    v_perm_b32 v69, v35, v34, s71
    v_perm_b32 v66, v37, v36, s70
    v_perm_b32 v70, v37, v36, s71
    v_perm_b32 v67, v39, v38, s70
    v_perm_b32 v71, v39, v38, s71
    s_add_u32 s69, s68, 61440
    buffer_store_dwordx4 v[64:67], v76, s[44:47], s69 offen sc1
    s_add_u32 s69, s69, 2560
    buffer_store_dwordx4 v[68:71], v76, s[44:47], s69 offen sc1
    s_waitcnt vmcnt(0)
    ds_write_b32 v79, v80 offset:112
    s_cmp_lg_u32 s4, 0
    s_cbranch_scc1 gated_mix__ssm_conv_s5__ssm_conv_s4__prompt_kernel_nw040
gated_mix__ssm_conv_s5__ssm_conv_s4__prompt_kernel_sp41:
    ds_read_b128 v[120:123], v4 offset:112
    s_waitcnt lgkmcnt(0)
    v_min_u32 v120, v120, v121
    v_min_u32 v122, v122, v123
    v_min_u32 v120, v120, v122
    s_nop 0
    v_readfirstlane_b32 s68, v120
    s_nop 1
    s_cmp_ge_u32 s68, 10
    s_cbranch_scc1 gated_mix__ssm_conv_s5__ssm_conv_s4__prompt_kernel_spd42
    s_cmp_eq_u32 s98, 0
    s_cbranch_scc1 gated_mix__ssm_conv_s5__ssm_conv_s4__prompt_kernel_spd42
    s_sub_u32 s98, s98, 1
    s_sleep 0
    s_branch gated_mix__ssm_conv_s5__ssm_conv_s4__prompt_kernel_sp41
gated_mix__ssm_conv_s5__ssm_conv_s4__prompt_kernel_spd42:
    s_lshl_b32 s68, s5, 7
    s_lshl_b32 s69, s6, 2
    s_add_u32 s68, s68, s69
    s_add_u32 s68, s68, 10813440
    v_mov_b32 v76, 0
    s_mov_b64 exec, 1
    buffer_store_dword v105, v76, s[44:47], s68 offen sc1
    s_mov_b64 exec, -1
gated_mix__ssm_conv_s5__ssm_conv_s4__prompt_kernel_nw040:
    s_branch gated_mix__ssm_conv_s5__ssm_conv_s4__prompt_kernel_p2
gated_mix__ssm_conv_s5__ssm_conv_s4__prompt_kernel_ap4:
    s_setprio 3
    v_and_b32 v2, 15, v1
    v_lshrrev_b32 v3, 4, v1
    v_mov_b32 v4, 160256
    s_lshl_b32 s68, s7, 2
    v_add_u32 v5, s68, v4
    v_lshrrev_b32 v10, 3, v1
    v_mul_u32_u24 v10, 1280, v10
    v_and_b32 v11, 7, v1
    s_cmp_ge_u32 s7, 2
    s_cbranch_scc1 gated_mix__ssm_conv_s5__ssm_conv_s4__prompt_kernel_bprod43
    s_lshl_b32 s68, s7, 2
    s_add_u32 s69, s68, 0
    v_xor_b32 v12, s69, v11
    v_lshl_add_u32 v6, v12, 4, v10
    s_add_u32 s69, s68, 1
    v_xor_b32 v12, s69, v11
    v_lshl_add_u32 v7, v12, 4, v10
    s_add_u32 s69, s68, 2
    v_xor_b32 v12, s69, v11
    v_lshl_add_u32 v8, v12, 4, v10
    s_add_u32 s69, s68, 3
    v_xor_b32 v12, s69, v11
    v_lshl_add_u32 v9, v12, 4, v10
    s_lshl_b32 s72, s5, 7
    s_lshl_b32 s68, s7, 6
    s_add_u32 s72, s72, s68
    s_mul_i32 s72, s72, 1280
    s_lshl_b32 s75, s7, 13
    s_add_u32 s75, s75, 45568
    s_mov_b32 s76, 0
    s_waitcnt lgkmcnt(0)
    s_mov_b32 s32, s8
    s_mov_b32 s33, s9
    s_mov_b32 s34, 2621440
    s_mov_b32 s35, 0x20000
    s_or_b32 s68, s2, s7
    s_cmp_lg_u32 s68, 0
    s_cbranch_scc1 gated_mix__ssm_conv_s5__ssm_conv_s4__prompt_kernel_nw44
    s_mov_b32 s48, s28
    s_mov_b32 s49, s29
    s_mov_b32 s50, 256
    s_mov_b32 s51, 0x20000
    s_memrealtime s[68:69]
    s_waitcnt lgkmcnt(0)
    s_or_b32 s68, s68, 1
    v_mov_b32 v16, s68
    v_mov_b32 v15, 0
    s_mov_b64 exec, 1
    buffer_store_dword v16, v15, s[48:51], 0 offen sc1
    s_mov_b64 exec, -1
gated_mix__ssm_conv_s5__ssm_conv_s4__prompt_kernel_nw44:
    s_add_u32 s77, s72, s76
    s_add_u32 m0, s75, 0
    s_nop 0
    buffer_load_dwordx4 v6, s[32:35], s77 offen lds
    s_add_u32 m0, s75, 1024
    s_add_u32 s77, s77, 10240
    buffer_load_dwordx4 v6, s[32:35], s77 offen lds
    s_add_u32 m0, s75, 2048
    s_add_u32 s77, s77, 10240
    buffer_load_dwordx4 v7, s[32:35], s77 offen lds
    s_add_u32 m0, s75, 3072
    s_add_u32 s77, s77, 10240
    buffer_load_dwordx4 v7, s[32:35], s77 offen lds
    s_add_u32 m0, s75, 4096
    s_add_u32 s77, s77, 10240
    buffer_load_dwordx4 v8, s[32:35], s77 offen lds
    s_add_u32 m0, s75, 5120
    s_add_u32 s77, s77, 10240
    buffer_load_dwordx4 v8, s[32:35], s77 offen lds
    s_add_u32 m0, s75, 6144
    s_add_u32 s77, s77, 10240
    buffer_load_dwordx4 v9, s[32:35], s77 offen lds
    s_add_u32 m0, s75, 7168
    s_add_u32 s77, s77, 10240
    buffer_load_dwordx4 v9, s[32:35], s77 offen lds
    s_add_u32 s76, s76, 128
    s_cmp_eq_u32 s76, 1280
    s_cselect_b32 s76, 0, s76
    s_add_u32 s77, s72, s76
    s_add_u32 m0, s75, 16384
    s_nop 0
    buffer_load_dwordx4 v6, s[32:35], s77 offen lds
    s_add_u32 m0, s75, 17408
    s_add_u32 s77, s77, 10240
    buffer_load_dwordx4 v6, s[32:35], s77 offen lds
    s_add_u32 m0, s75, 18432
    s_add_u32 s77, s77, 10240
    buffer_load_dwordx4 v7, s[32:35], s77 offen lds
    s_add_u32 m0, s75, 19456
    s_add_u32 s77, s77, 10240
    buffer_load_dwordx4 v7, s[32:35], s77 offen lds
    s_add_u32 m0, s75, 20480
    s_add_u32 s77, s77, 10240
    buffer_load_dwordx4 v8, s[32:35], s77 offen lds
    s_add_u32 m0, s75, 21504
    s_add_u32 s77, s77, 10240
    buffer_load_dwordx4 v8, s[32:35], s77 offen lds
    s_add_u32 m0, s75, 22528
    s_add_u32 s77, s77, 10240
    buffer_load_dwordx4 v9, s[32:35], s77 offen lds
    s_add_u32 m0, s75, 23552
    s_add_u32 s77, s77, 10240
    buffer_load_dwordx4 v9, s[32:35], s77 offen lds
    s_add_u32 s76, s76, 128
    s_cmp_eq_u32 s76, 1280
    s_cselect_b32 s76, 0, s76
    s_mov_b32 s48, s28
    s_mov_b32 s49, s29
    s_mov_b32 s50, 256
    s_mov_b32 s51, 0x20000
    s_waitcnt vmcnt(8)
    s_mov_b64 exec, 1
    v_mov_b32 v16, 1
    ds_write_b32 v5, v16 offset:0
    s_mov_b64 exec, -1
    s_add_u32 s77, s72, s76
    s_add_u32 m0, s75, 32768
    s_nop 0
    buffer_load_dwordx4 v6, s[32:35], s77 offen lds
    s_add_u32 m0, s75, 33792
    s_add_u32 s77, s77, 10240
    buffer_load_dwordx4 v6, s[32:35], s77 offen lds
    s_add_u32 m0, s75, 34816
    s_add_u32 s77, s77, 10240
    buffer_load_dwordx4 v7, s[32:35], s77 offen lds
    s_add_u32 m0, s75, 35840
    s_add_u32 s77, s77, 10240
    buffer_load_dwordx4 v7, s[32:35], s77 offen lds
    s_add_u32 m0, s75, 36864
    s_add_u32 s77, s77, 10240
    buffer_load_dwordx4 v8, s[32:35], s77 offen lds
    s_add_u32 m0, s75, 37888
    s_add_u32 s77, s77, 10240
    buffer_load_dwordx4 v8, s[32:35], s77 offen lds
    s_add_u32 m0, s75, 38912
    s_add_u32 s77, s77, 10240
    buffer_load_dwordx4 v9, s[32:35], s77 offen lds
    s_add_u32 m0, s75, 39936
    s_add_u32 s77, s77, 10240
    buffer_load_dwordx4 v9, s[32:35], s77 offen lds
    s_add_u32 s76, s76, 128
    s_cmp_eq_u32 s76, 1280
    s_cselect_b32 s76, 0, s76
    s_waitcnt vmcnt(8)
    s_mov_b64 exec, 1
    v_mov_b32 v16, 2
    ds_write_b32 v5, v16 offset:0
    s_mov_b64 exec, -1
    s_add_u32 s77, s72, s76
    s_add_u32 m0, s75, 49152
    s_nop 0
    buffer_load_dwordx4 v6, s[32:35], s77 offen lds
    s_add_u32 m0, s75, 50176
    s_add_u32 s77, s77, 10240
    buffer_load_dwordx4 v6, s[32:35], s77 offen lds
    s_add_u32 m0, s75, 51200
    s_add_u32 s77, s77, 10240
    buffer_load_dwordx4 v7, s[32:35], s77 offen lds
    s_add_u32 m0, s75, 52224
    s_add_u32 s77, s77, 10240
    buffer_load_dwordx4 v7, s[32:35], s77 offen lds
    s_add_u32 m0, s75, 53248
    s_add_u32 s77, s77, 10240
    buffer_load_dwordx4 v8, s[32:35], s77 offen lds
    s_add_u32 m0, s75, 54272
    s_add_u32 s77, s77, 10240
    buffer_load_dwordx4 v8, s[32:35], s77 offen lds
    s_add_u32 m0, s75, 55296
    s_add_u32 s77, s77, 10240
    buffer_load_dwordx4 v9, s[32:35], s77 offen lds
    s_add_u32 m0, s75, 56320
    s_add_u32 s77, s77, 10240
    buffer_load_dwordx4 v9, s[32:35], s77 offen lds
    s_add_u32 s76, s76, 128
    s_cmp_eq_u32 s76, 1280
    s_cselect_b32 s76, 0, s76
gated_mix__ssm_conv_s5__ssm_conv_s4__prompt_kernel_sp45:
    ds_read_b128 v[20:23], v4 offset:16
    s_waitcnt lgkmcnt(0)
    v_min_u32 v20, v20, v21
    v_min_u32 v22, v22, v23
    v_min_u32 v20, v20, v22
    s_nop 0
    v_readfirstlane_b32 s68, v20
    s_nop 1
    s_cmp_ge_u32 s68, 1
    s_cbranch_scc1 gated_mix__ssm_conv_s5__ssm_conv_s4__prompt_kernel_spd46
    s_cmp_eq_u32 s98, 0
    s_cbranch_scc1 gated_mix__ssm_conv_s5__ssm_conv_s4__prompt_kernel_spd46
    s_sub_u32 s98, s98, 1
    s_sleep 0
    s_branch gated_mix__ssm_conv_s5__ssm_conv_s4__prompt_kernel_sp45
gated_mix__ssm_conv_s5__ssm_conv_s4__prompt_kernel_spd46:
    s_waitcnt vmcnt(8)
    s_mov_b64 exec, 1
    v_mov_b32 v16, 3
    ds_write_b32 v5, v16 offset:0
    s_mov_b64 exec, -1
    s_add_u32 s77, s72, s76
    s_add_u32 m0, s75, 0
    s_nop 0
    buffer_load_dwordx4 v6, s[32:35], s77 offen lds
    s_add_u32 m0, s75, 1024
    s_add_u32 s77, s77, 10240
    buffer_load_dwordx4 v6, s[32:35], s77 offen lds
    s_add_u32 m0, s75, 2048
    s_add_u32 s77, s77, 10240
    buffer_load_dwordx4 v7, s[32:35], s77 offen lds
    s_add_u32 m0, s75, 3072
    s_add_u32 s77, s77, 10240
    buffer_load_dwordx4 v7, s[32:35], s77 offen lds
    s_add_u32 m0, s75, 4096
    s_add_u32 s77, s77, 10240
    buffer_load_dwordx4 v8, s[32:35], s77 offen lds
    s_add_u32 m0, s75, 5120
    s_add_u32 s77, s77, 10240
    buffer_load_dwordx4 v8, s[32:35], s77 offen lds
    s_add_u32 m0, s75, 6144
    s_add_u32 s77, s77, 10240
    buffer_load_dwordx4 v9, s[32:35], s77 offen lds
    s_add_u32 m0, s75, 7168
    s_add_u32 s77, s77, 10240
    buffer_load_dwordx4 v9, s[32:35], s77 offen lds
    s_add_u32 s76, s76, 128
    s_cmp_eq_u32 s76, 1280
    s_cselect_b32 s76, 0, s76
gated_mix__ssm_conv_s5__ssm_conv_s4__prompt_kernel_sp47:
    ds_read_b128 v[20:23], v4 offset:16
    s_waitcnt lgkmcnt(0)
    v_min_u32 v20, v20, v21
    v_min_u32 v22, v22, v23
    v_min_u32 v20, v20, v22
    s_nop 0
    v_readfirstlane_b32 s68, v20
    s_nop 1
    s_cmp_ge_u32 s68, 2
    s_cbranch_scc1 gated_mix__ssm_conv_s5__ssm_conv_s4__prompt_kernel_spd48
    s_cmp_eq_u32 s98, 0
    s_cbranch_scc1 gated_mix__ssm_conv_s5__ssm_conv_s4__prompt_kernel_spd48
    s_sub_u32 s98, s98, 1
    s_sleep 0
    s_branch gated_mix__ssm_conv_s5__ssm_conv_s4__prompt_kernel_sp47
gated_mix__ssm_conv_s5__ssm_conv_s4__prompt_kernel_spd48:
    s_waitcnt vmcnt(8)
    s_mov_b64 exec, 1
    v_mov_b32 v16, 4
    ds_write_b32 v5, v16 offset:0
    s_mov_b64 exec, -1
    s_add_u32 s77, s72, s76
    s_add_u32 m0, s75, 16384
    s_nop 0
    buffer_load_dwordx4 v6, s[32:35], s77 offen lds
    s_add_u32 m0, s75, 17408
    s_add_u32 s77, s77, 10240
    buffer_load_dwordx4 v6, s[32:35], s77 offen lds
    s_add_u32 m0, s75, 18432
    s_add_u32 s77, s77, 10240
    buffer_load_dwordx4 v7, s[32:35], s77 offen lds
    s_add_u32 m0, s75, 19456
    s_add_u32 s77, s77, 10240
    buffer_load_dwordx4 v7, s[32:35], s77 offen lds
    s_add_u32 m0, s75, 20480
    s_add_u32 s77, s77, 10240
    buffer_load_dwordx4 v8, s[32:35], s77 offen lds
    s_add_u32 m0, s75, 21504
    s_add_u32 s77, s77, 10240
    buffer_load_dwordx4 v8, s[32:35], s77 offen lds
    s_add_u32 m0, s75, 22528
    s_add_u32 s77, s77, 10240
    buffer_load_dwordx4 v9, s[32:35], s77 offen lds
    s_add_u32 m0, s75, 23552
    s_add_u32 s77, s77, 10240
    buffer_load_dwordx4 v9, s[32:35], s77 offen lds
    s_add_u32 s76, s76, 128
    s_cmp_eq_u32 s76, 1280
    s_cselect_b32 s76, 0, s76
gated_mix__ssm_conv_s5__ssm_conv_s4__prompt_kernel_sp49:
    ds_read_b128 v[20:23], v4 offset:16
    s_waitcnt lgkmcnt(0)
    v_min_u32 v20, v20, v21
    v_min_u32 v22, v22, v23
    v_min_u32 v20, v20, v22
    s_nop 0
    v_readfirstlane_b32 s68, v20
    s_nop 1
    s_cmp_ge_u32 s68, 3
    s_cbranch_scc1 gated_mix__ssm_conv_s5__ssm_conv_s4__prompt_kernel_spd50
    s_cmp_eq_u32 s98, 0
    s_cbranch_scc1 gated_mix__ssm_conv_s5__ssm_conv_s4__prompt_kernel_spd50
    s_sub_u32 s98, s98, 1
    s_sleep 0
    s_branch gated_mix__ssm_conv_s5__ssm_conv_s4__prompt_kernel_sp49
gated_mix__ssm_conv_s5__ssm_conv_s4__prompt_kernel_spd50:
    s_waitcnt vmcnt(8)
    s_mov_b64 exec, 1
    v_mov_b32 v16, 5
    ds_write_b32 v5, v16 offset:0
    s_mov_b64 exec, -1
    s_add_u32 s77, s72, s76
    s_add_u32 m0, s75, 32768
    s_nop 0
    buffer_load_dwordx4 v6, s[32:35], s77 offen lds
    s_add_u32 m0, s75, 33792
    s_add_u32 s77, s77, 10240
    buffer_load_dwordx4 v6, s[32:35], s77 offen lds
    s_add_u32 m0, s75, 34816
    s_add_u32 s77, s77, 10240
    buffer_load_dwordx4 v7, s[32:35], s77 offen lds
    s_add_u32 m0, s75, 35840
    s_add_u32 s77, s77, 10240
    buffer_load_dwordx4 v7, s[32:35], s77 offen lds
    s_add_u32 m0, s75, 36864
    s_add_u32 s77, s77, 10240
    buffer_load_dwordx4 v8, s[32:35], s77 offen lds
    s_add_u32 m0, s75, 37888
    s_add_u32 s77, s77, 10240
    buffer_load_dwordx4 v8, s[32:35], s77 offen lds
    s_add_u32 m0, s75, 38912
    s_add_u32 s77, s77, 10240
    buffer_load_dwordx4 v9, s[32:35], s77 offen lds
    s_add_u32 m0, s75, 39936
    s_add_u32 s77, s77, 10240
    buffer_load_dwordx4 v9, s[32:35], s77 offen lds
    s_add_u32 s76, s76, 128
    s_cmp_eq_u32 s76, 1280
    s_cselect_b32 s76, 0, s76
gated_mix__ssm_conv_s5__ssm_conv_s4__prompt_kernel_sp51:
    ds_read_b128 v[20:23], v4 offset:16
    s_waitcnt lgkmcnt(0)
    v_min_u32 v20, v20, v21
    v_min_u32 v22, v22, v23
    v_min_u32 v20, v20, v22
    s_nop 0
    v_readfirstlane_b32 s68, v20
    s_nop 1
    s_cmp_ge_u32 s68, 4
    s_cbranch_scc1 gated_mix__ssm_conv_s5__ssm_conv_s4__prompt_kernel_spd52
    s_cmp_eq_u32 s98, 0
    s_cbranch_scc1 gated_mix__ssm_conv_s5__ssm_conv_s4__prompt_kernel_spd52
    s_sub_u32 s98, s98, 1
    s_sleep 0
    s_branch gated_mix__ssm_conv_s5__ssm_conv_s4__prompt_kernel_sp51
gated_mix__ssm_conv_s5__ssm_conv_s4__prompt_kernel_spd52:
    s_waitcnt vmcnt(8)
    s_mov_b64 exec, 1
    v_mov_b32 v16, 6
    ds_write_b32 v5, v16 offset:0
    s_mov_b64 exec, -1
    v_mov_b32 v15, 0
    buffer_load_dword v18, v15, s[48:51], 0 offen sc1
    s_add_u32 s77, s72, s76
    s_add_u32 m0, s75, 49152
    s_nop 0
    buffer_load_dwordx4 v6, s[32:35], s77 offen lds
    s_add_u32 m0, s75, 50176
    s_add_u32 s77, s77, 10240
    buffer_load_dwordx4 v6, s[32:35], s77 offen lds
    s_add_u32 m0, s75, 51200
    s_add_u32 s77, s77, 10240
    buffer_load_dwordx4 v7, s[32:35], s77 offen lds
    s_add_u32 m0, s75, 52224
    s_add_u32 s77, s77, 10240
    buffer_load_dwordx4 v7, s[32:35], s77 offen lds
    s_add_u32 m0, s75, 53248
    s_add_u32 s77, s77, 10240
    buffer_load_dwordx4 v8, s[32:35], s77 offen lds
    s_add_u32 m0, s75, 54272
    s_add_u32 s77, s77, 10240
    buffer_load_dwordx4 v8, s[32:35], s77 offen lds
    s_add_u32 m0, s75, 55296
    s_add_u32 s77, s77, 10240
    buffer_load_dwordx4 v9, s[32:35], s77 offen lds
    s_add_u32 m0, s75, 56320
    s_add_u32 s77, s77, 10240
    buffer_load_dwordx4 v9, s[32:35], s77 offen lds
    s_add_u32 s76, s76, 128
    s_cmp_eq_u32 s76, 1280
    s_cselect_b32 s76, 0, s76
gated_mix__ssm_conv_s5__ssm_conv_s4__prompt_kernel_sp53:
    ds_read_b128 v[20:23], v4 offset:16
    s_waitcnt lgkmcnt(0)
    v_min_u32 v20, v20, v21
    v_min_u32 v22, v22, v23
    v_min_u32 v20, v20, v22
    s_nop 0
    v_readfirstlane_b32 s68, v20
    s_nop 1
    s_cmp_ge_u32 s68, 5
    s_cbranch_scc1 gated_mix__ssm_conv_s5__ssm_conv_s4__prompt_kernel_spd54
    s_cmp_eq_u32 s98, 0
    s_cbranch_scc1 gated_mix__ssm_conv_s5__ssm_conv_s4__prompt_kernel_spd54
    s_sub_u32 s98, s98, 1
    s_sleep 0
    s_branch gated_mix__ssm_conv_s5__ssm_conv_s4__prompt_kernel_sp53
gated_mix__ssm_conv_s5__ssm_conv_s4__prompt_kernel_spd54:
    s_waitcnt vmcnt(8)
    s_mov_b64 exec, 1
    v_mov_b32 v16, 7
    ds_write_b32 v5, v16 offset:0
    s_mov_b64 exec, -1
    s_add_u32 s77, s72, s76
    s_add_u32 m0, s75, 0
    s_nop 0
    buffer_load_dwordx4 v6, s[32:35], s77 offen lds
    s_add_u32 m0, s75, 1024
    s_add_u32 s77, s77, 10240
    buffer_load_dwordx4 v6, s[32:35], s77 offen lds
    s_add_u32 m0, s75, 2048
    s_add_u32 s77, s77, 10240
    buffer_load_dwordx4 v7, s[32:35], s77 offen lds
    s_add_u32 m0, s75, 3072
    s_add_u32 s77, s77, 10240
    buffer_load_dwordx4 v7, s[32:35], s77 offen lds
    s_add_u32 m0, s75, 4096
    s_add_u32 s77, s77, 10240
    buffer_load_dwordx4 v8, s[32:35], s77 offen lds
    s_add_u32 m0, s75, 5120
    s_add_u32 s77, s77, 10240
    buffer_load_dwordx4 v8, s[32:35], s77 offen lds
    s_add_u32 m0, s75, 6144
    s_add_u32 s77, s77, 10240
    buffer_load_dwordx4 v9, s[32:35], s77 offen lds
    s_add_u32 m0, s75, 7168
    s_add_u32 s77, s77, 10240
    buffer_load_dwordx4 v9, s[32:35], s77 offen lds
    s_add_u32 s76, s76, 128
    s_cmp_eq_u32 s76, 1280
    s_cselect_b32 s76, 0, s76
gated_mix__ssm_conv_s5__ssm_conv_s4__prompt_kernel_sp55:
    ds_read_b128 v[20:23], v4 offset:16
    s_waitcnt lgkmcnt(0)
    v_min_u32 v20, v20, v21
    v_min_u32 v22, v22, v23
    v_min_u32 v20, v20, v22
    s_nop 0
    v_readfirstlane_b32 s68, v20
    s_nop 1
    s_cmp_ge_u32 s68, 6
    s_cbranch_scc1 gated_mix__ssm_conv_s5__ssm_conv_s4__prompt_kernel_spd56
    s_cmp_eq_u32 s98, 0
    s_cbranch_scc1 gated_mix__ssm_conv_s5__ssm_conv_s4__prompt_kernel_spd56
    s_sub_u32 s98, s98, 1
    s_sleep 0
    s_branch gated_mix__ssm_conv_s5__ssm_conv_s4__prompt_kernel_sp55
gated_mix__ssm_conv_s5__ssm_conv_s4__prompt_kernel_spd56:
    s_waitcnt vmcnt(8)
    s_mov_b64 exec, 1
    v_mov_b32 v16, 8
    ds_write_b32 v5, v16 offset:0
    s_mov_b64 exec, -1
    s_add_u32 s77, s72, s76
    s_add_u32 m0, s75, 16384
    s_nop 0
    buffer_load_dwordx4 v6, s[32:35], s77 offen lds
    s_add_u32 m0, s75, 17408
    s_add_u32 s77, s77, 10240
    buffer_load_dwordx4 v6, s[32:35], s77 offen lds
    s_add_u32 m0, s75, 18432
    s_add_u32 s77, s77, 10240
    buffer_load_dwordx4 v7, s[32:35], s77 offen lds
    s_add_u32 m0, s75, 19456
    s_add_u32 s77, s77, 10240
    buffer_load_dwordx4 v7, s[32:35], s77 offen lds
    s_add_u32 m0, s75, 20480
    s_add_u32 s77, s77, 10240
    buffer_load_dwordx4 v8, s[32:35], s77 offen lds
    s_add_u32 m0, s75, 21504
    s_add_u32 s77, s77, 10240
    buffer_load_dwordx4 v8, s[32:35], s77 offen lds
    s_add_u32 m0, s75, 22528
    s_add_u32 s77, s77, 10240
    buffer_load_dwordx4 v9, s[32:35], s77 offen lds
    s_add_u32 m0, s75, 23552
    s_add_u32 s77, s77, 10240
    buffer_load_dwordx4 v9, s[32:35], s77 offen lds
    s_add_u32 s76, s76, 128
    s_cmp_eq_u32 s76, 1280
    s_cselect_b32 s76, 0, s76
    s_waitcnt vmcnt(8)
    s_mov_b64 exec, 1
    v_mov_b32 v16, 9
    ds_write_b32 v5, v16 offset:0
    s_mov_b64 exec, -1
    s_cmp_lg_u32 s7, 0
    s_cbranch_scc1 gated_mix__ssm_conv_s5__ssm_conv_s4__prompt_kernel_tg57
gated_mix__ssm_conv_s5__ssm_conv_s4__prompt_kernel_np58:
    v_readfirstlane_b32 s9, v18
    s_nop 1
    s_cmp_lg_u32 s9, 0
    s_cbranch_scc1 gated_mix__ssm_conv_s5__ssm_conv_s4__prompt_kernel_ngot59
    s_cmp_eq_u32 s98, 0
    s_cbranch_scc1 gated_mix__ssm_conv_s5__ssm_conv_s4__prompt_kernel_ngot59
    s_sub_u32 s98, s98, 1
    s_sleep 4
    buffer_load_dword v18, v15, s[48:51], 0 offen sc1
    s_waitcnt vmcnt(0)
    s_branch gated_mix__ssm_conv_s5__ssm_conv_s4__prompt_kernel_np58
gated_mix__ssm_conv_s5__ssm_conv_s4__prompt_kernel_ngot59:
    s_mov_b64 exec, 1
    v_mov_b32 v16, s9
    ds_write_b32 v4, v16 offset:48
    s_mov_b64 exec, -1
gated_mix__ssm_conv_s5__ssm_conv_s4__prompt_kernel_tg57:
    s_waitcnt vmcnt(0)
    s_mov_b64 exec, 1
    v_mov_b32 v16, 10
    ds_write_b32 v5, v16 offset:0
    s_mov_b64 exec, -1
    s_branch gated_mix__ssm_conv_s5__ssm_conv_s4__prompt_kernel_p2
gated_mix__ssm_conv_s5__ssm_conv_s4__prompt_kernel_bprod43:
    v_xor_b32 v12, v3, v11
    v_lshl_add_u32 v6, v12, 4, v10
    v_xor_b32 v12, 4, v12
    v_lshl_add_u32 v7, v12, 4, v10
    s_sub_u32 s7, s7, 2
    s_lshl_b32 s73, s6, 6
    s_lshl_b32 s68, s7, 5
    s_add_u32 s73, s73, s68
    s_mul_i32 s73, s73, 1280
    s_lshl_b32 s75, s7, 13
    s_add_u32 s75, s75, 45568
    s_mov_b32 s79, 0
    s_waitcnt lgkmcnt(0)
    s_mov_b32 s36, s14
    s_mov_b32 s37, s15
    s_mov_b32 s38, 819200
    s_mov_b32 s39, 0x20000
    s_mov_b32 s40, s16
    s_mov_b32 s41, s17
    s_mov_b32 s42, 819200
    s_mov_b32 s43, 0x20000
    s_add_u32 s78, s73, s79
    s_add_u32 m0, s75, 65536
    s_add_u32 s77, s78, 0
    buffer_load_dwordx4 v6, s[36:39], s77 offen lds
    s_add_u32 m0, s75, 66560
    s_add_u32 s77, s78, 10240
    buffer_load_dwordx4 v7, s[36:39], s77 offen lds
    s_add_u32 m0, s75, 67584
    s_add_u32 s77, s78, 0
    buffer_load_dwordx4 v6, s[40:43], s77 offen lds
    s_add_u32 m0, s75, 68608
    s_add_u32 s77, s78, 10240
    buffer_load_dwordx4 v7, s[40:43], s77 offen lds
    s_add_u32 m0, s75, 69632
    s_add_u32 s77, s78, 20480
    buffer_load_dwordx4 v6, s[36:39], s77 offen lds
    s_add_u32 m0, s75, 70656
    s_add_u32 s77, s78, 30720
    buffer_load_dwordx4 v7, s[36:39], s77 offen lds
    s_add_u32 m0, s75, 71680
    s_add_u32 s77, s78, 20480
    buffer_load_dwordx4 v6, s[40:43], s77 offen lds
    s_add_u32 m0, s75, 72704
    s_add_u32 s77, s78, 30720
    buffer_load_dwordx4 v7, s[40:43], s77 offen lds
    s_add_u32 s79, s79, 128
    s_cmp_eq_u32 s79, 1280
    s_cselect_b32 s79, 0, s79
    s_add_u32 s78, s73, s79
    s_add_u32 m0, s75, 81920
    s_add_u32 s77, s78, 0
    buffer_load_dwordx4 v6, s[36:39], s77 offen lds
    s_add_u32 m0, s75, 82944
    s_add_u32 s77, s78, 10240
    buffer_load_dwordx4 v7, s[36:39], s77 offen lds
    s_add_u32 m0, s75, 83968
    s_add_u32 s77, s78, 0
    buffer_load_dwordx4 v6, s[40:43], s77 offen lds
    s_add_u32 m0, s75, 84992
    s_add_u32 s77, s78, 10240
    buffer_load_dwordx4 v7, s[40:43], s77 offen lds
    s_add_u32 m0, s75, 86016
    s_add_u32 s77, s78, 20480
    buffer_load_dwordx4 v6, s[36:39], s77 offen lds
    s_add_u32 m0, s75, 87040
    s_add_u32 s77, s78, 30720
    buffer_load_dwordx4 v7, s[36:39], s77 offen lds
    s_add_u32 m0, s75, 88064
    s_add_u32 s77, s78, 20480
    buffer_load_dwordx4 v6, s[40:43], s77 offen lds
    s_add_u32 m0, s75, 89088
    s_add_u32 s77, s78, 30720
    buffer_load_dwordx4 v7, s[40:43], s77 offen lds
    s_add_u32 s79, s79, 128
    s_cmp_eq_u32 s79, 1280
    s_cselect_b32 s79, 0, s79
    s_waitcnt vmcnt(8)
    s_mov_b64 exec, 1
    v_mov_b32 v16, 1
    ds_write_b32 v5, v16 offset:0
    s_mov_b64 exec, -1
    s_add_u32 s78, s73, s79
    s_add_u32 m0, s75, 98304
    s_add_u32 s77, s78, 0
    buffer_load_dwordx4 v6, s[36:39], s77 offen lds
    s_add_u32 m0, s75, 99328
    s_add_u32 s77, s78, 10240
    buffer_load_dwordx4 v7, s[36:39], s77 offen lds
    s_add_u32 m0, s75, 100352
    s_add_u32 s77, s78, 0
    buffer_load_dwordx4 v6, s[40:43], s77 offen lds
    s_add_u32 m0, s75, 101376
    s_add_u32 s77, s78, 10240
    buffer_load_dwordx4 v7, s[40:43], s77 offen lds
    s_add_u32 m0, s75, 102400
    s_add_u32 s77, s78, 20480
    buffer_load_dwordx4 v6, s[36:39], s77 offen lds
    s_add_u32 m0, s75, 103424
    s_add_u32 s77, s78, 30720
    buffer_load_dwordx4 v7, s[36:39], s77 offen lds
    s_add_u32 m0, s75, 104448
    s_add_u32 s77, s78, 20480
    buffer_load_dwordx4 v6, s[40:43], s77 offen lds
    s_add_u32 m0, s75, 105472
    s_add_u32 s77, s78, 30720
    buffer_load_dwordx4 v7, s[40:43], s77 offen lds
    s_add_u32 s79, s79, 128
    s_cmp_eq_u32 s79, 1280
    s_cselect_b32 s79, 0, s79
    s_waitcnt vmcnt(8)
    s_mov_b64 exec, 1
    v_mov_b32 v16, 2
    ds_write_b32 v5, v16 offset:0
    s_mov_b64 exec, -1
gated_mix__ssm_conv_s5__ssm_conv_s4__prompt_kernel_sp60:
    ds_read_b128 v[20:23], v4 offset:32
    s_waitcnt lgkmcnt(0)
    v_min_u32 v20, v20, v21
    v_min_u32 v22, v22, v23
    v_min_u32 v20, v20, v22
    s_nop 0
    v_readfirstlane_b32 s68, v20
    s_nop 1
    s_cmp_ge_u32 s68, 1
    s_cbranch_scc1 gated_mix__ssm_conv_s5__ssm_conv_s4__prompt_kernel_spd61
    s_cmp_eq_u32 s98, 0
    s_cbranch_scc1 gated_mix__ssm_conv_s5__ssm_conv_s4__prompt_kernel_spd61
    s_sub_u32 s98, s98, 1
    s_sleep 0
    s_branch gated_mix__ssm_conv_s5__ssm_conv_s4__prompt_kernel_sp60
gated_mix__ssm_conv_s5__ssm_conv_s4__prompt_kernel_spd61:
    s_waitcnt vmcnt(0)
    s_mov_b64 exec, 1
    v_mov_b32 v16, 3
    ds_write_b32 v5, v16 offset:0
    s_mov_b64 exec, -1
    s_add_u32 s78, s73, s79
    s_add_u32 m0, s75, 65536
    s_add_u32 s77, s78, 0
    buffer_load_dwordx4 v6, s[36:39], s77 offen lds
    s_add_u32 m0, s75, 66560
    s_add_u32 s77, s78, 10240
    buffer_load_dwordx4 v7, s[36:39], s77 offen lds
    s_add_u32 m0, s75, 67584
    s_add_u32 s77, s78, 0
    buffer_load_dwordx4 v6, s[40:43], s77 offen lds
    s_add_u32 m0, s75, 68608
    s_add_u32 s77, s78, 10240
    buffer_load_dwordx4 v7, s[40:43], s77 offen lds
    s_add_u32 m0, s75, 69632
    s_add_u32 s77, s78, 20480
    buffer_load_dwordx4 v6, s[36:39], s77 offen lds
    s_add_u32 m0, s75, 70656
    s_add_u32 s77, s78, 30720
    buffer_load_dwordx4 v7, s[36:39], s77 offen lds
    s_add_u32 m0, s75, 71680
    s_add_u32 s77, s78, 20480
    buffer_load_dwordx4 v6, s[40:43], s77 offen lds
    s_add_u32 m0, s75, 72704
    s_add_u32 s77, s78, 30720
    buffer_load_dwordx4 v7, s[40:43], s77 offen lds
    s_add_u32 s79, s79, 128
    s_cmp_eq_u32 s79, 1280
    s_cselect_b32 s79, 0, s79
gated_mix__ssm_conv_s5__ssm_conv_s4__prompt_kernel_sp62:
    ds_read_b128 v[20:23], v4 offset:32
    s_waitcnt lgkmcnt(0)
    v_min_u32 v20, v20, v21
    v_min_u32 v22, v22, v23
    v_min_u32 v20, v20, v22
    s_nop 0
    v_readfirstlane_b32 s68, v20
    s_nop 1
    s_cmp_ge_u32 s68, 2
    s_cbranch_scc1 gated_mix__ssm_conv_s5__ssm_conv_s4__prompt_kernel_spd63
    s_cmp_eq_u32 s98, 0
    s_cbranch_scc1 gated_mix__ssm_conv_s5__ssm_conv_s4__prompt_kernel_spd63
    s_sub_u32 s98, s98, 1
    s_sleep 0
    s_branch gated_mix__ssm_conv_s5__ssm_conv_s4__prompt_kernel_sp62
gated_mix__ssm_conv_s5__ssm_conv_s4__prompt_kernel_spd63:
    s_waitcnt vmcnt(0)
    s_mov_b64 exec, 1
    v_mov_b32 v16, 4
    ds_write_b32 v5, v16 offset:0
    s_mov_b64 exec, -1
    s_add_u32 s78, s73, s79
    s_add_u32 m0, s75, 81920
    s_add_u32 s77, s78, 0
    buffer_load_dwordx4 v6, s[36:39], s77 offen lds
    s_add_u32 m0, s75, 82944
    s_add_u32 s77, s78, 10240
    buffer_load_dwordx4 v7, s[36:39], s77 offen lds
    s_add_u32 m0, s75, 83968
    s_add_u32 s77, s78, 0
    buffer_load_dwordx4 v6, s[40:43], s77 offen lds
    s_add_u32 m0, s75, 84992
    s_add_u32 s77, s78, 10240
    buffer_load_dwordx4 v7, s[40:43], s77 offen lds
    s_add_u32 m0, s75, 86016
    s_add_u32 s77, s78, 20480
    buffer_load_dwordx4 v6, s[36:39], s77 offen lds
    s_add_u32 m0, s75, 87040
    s_add_u32 s77, s78, 30720
    buffer_load_dwordx4 v7, s[36:39], s77 offen lds
    s_add_u32 m0, s75, 88064
    s_add_u32 s77, s78, 20480
    buffer_load_dwordx4 v6, s[40:43], s77 offen lds
    s_add_u32 m0, s75, 89088
    s_add_u32 s77, s78, 30720
    buffer_load_dwordx4 v7, s[40:43], s77 offen lds
    s_add_u32 s79, s79, 128
    s_cmp_eq_u32 s79, 1280
    s_cselect_b32 s79, 0, s79
gated_mix__ssm_conv_s5__ssm_conv_s4__prompt_kernel_sp64:
    ds_read_b128 v[20:23], v4 offset:32
    s_waitcnt lgkmcnt(0)
    v_min_u32 v20, v20, v21
    v_min_u32 v22, v22, v23
    v_min_u32 v20, v20, v22
    s_nop 0
    v_readfirstlane_b32 s68, v20
    s_nop 1
    s_cmp_ge_u32 s68, 3
    s_cbranch_scc1 gated_mix__ssm_conv_s5__ssm_conv_s4__prompt_kernel_spd65
    s_cmp_eq_u32 s98, 0
    s_cbranch_scc1 gated_mix__ssm_conv_s5__ssm_conv_s4__prompt_kernel_spd65
    s_sub_u32 s98, s98, 1
    s_sleep 0
    s_branch gated_mix__ssm_conv_s5__ssm_conv_s4__prompt_kernel_sp64
gated_mix__ssm_conv_s5__ssm_conv_s4__prompt_kernel_spd65:
    s_waitcnt vmcnt(0)
    s_mov_b64 exec, 1
    v_mov_b32 v16, 5
    ds_write_b32 v5, v16 offset:0
    s_mov_b64 exec, -1
    s_add_u32 s78, s73, s79
    s_add_u32 m0, s75, 98304
    s_add_u32 s77, s78, 0
    buffer_load_dwordx4 v6, s[36:39], s77 offen lds
    s_add_u32 m0, s75, 99328
    s_add_u32 s77, s78, 10240
    buffer_load_dwordx4 v7, s[36:39], s77 offen lds
    s_add_u32 m0, s75, 100352
    s_add_u32 s77, s78, 0
    buffer_load_dwordx4 v6, s[40:43], s77 offen lds
    s_add_u32 m0, s75, 101376
    s_add_u32 s77, s78, 10240
    buffer_load_dwordx4 v7, s[40:43], s77 offen lds
    s_add_u32 m0, s75, 102400
    s_add_u32 s77, s78, 20480
    buffer_load_dwordx4 v6, s[36:39], s77 offen lds
    s_add_u32 m0, s75, 103424
    s_add_u32 s77, s78, 30720
    buffer_load_dwordx4 v7, s[36:39], s77 offen lds
    s_add_u32 m0, s75, 104448
    s_add_u32 s77, s78, 20480
    buffer_load_dwordx4 v6, s[40:43], s77 offen lds
    s_add_u32 m0, s75, 105472
    s_add_u32 s77, s78, 30720
    buffer_load_dwordx4 v7, s[40:43], s77 offen lds
    s_add_u32 s79, s79, 128
    s_cmp_eq_u32 s79, 1280
    s_cselect_b32 s79, 0, s79
gated_mix__ssm_conv_s5__ssm_conv_s4__prompt_kernel_sp66:
    ds_read_b128 v[20:23], v4 offset:32
    s_waitcnt lgkmcnt(0)
    v_min_u32 v20, v20, v21
    v_min_u32 v22, v22, v23
    v_min_u32 v20, v20, v22
    s_nop 0
    v_readfirstlane_b32 s68, v20
    s_nop 1
    s_cmp_ge_u32 s68, 4
    s_cbranch_scc1 gated_mix__ssm_conv_s5__ssm_conv_s4__prompt_kernel_spd67
    s_cmp_eq_u32 s98, 0
    s_cbranch_scc1 gated_mix__ssm_conv_s5__ssm_conv_s4__prompt_kernel_spd67
    s_sub_u32 s98, s98, 1
    s_sleep 0
    s_branch gated_mix__ssm_conv_s5__ssm_conv_s4__prompt_kernel_sp66
gated_mix__ssm_conv_s5__ssm_conv_s4__prompt_kernel_spd67:
    s_waitcnt vmcnt(0)
    s_mov_b64 exec, 1
    v_mov_b32 v16, 6
    ds_write_b32 v5, v16 offset:0
    s_mov_b64 exec, -1
    s_add_u32 s78, s73, s79
    s_add_u32 m0, s75, 65536
    s_add_u32 s77, s78, 0
    buffer_load_dwordx4 v6, s[36:39], s77 offen lds
    s_add_u32 m0, s75, 66560
    s_add_u32 s77, s78, 10240
    buffer_load_dwordx4 v7, s[36:39], s77 offen lds
    s_add_u32 m0, s75, 67584
    s_add_u32 s77, s78, 0
    buffer_load_dwordx4 v6, s[40:43], s77 offen lds
    s_add_u32 m0, s75, 68608
    s_add_u32 s77, s78, 10240
    buffer_load_dwordx4 v7, s[40:43], s77 offen lds
    s_add_u32 m0, s75, 69632
    s_add_u32 s77, s78, 20480
    buffer_load_dwordx4 v6, s[36:39], s77 offen lds
    s_add_u32 m0, s75, 70656
    s_add_u32 s77, s78, 30720
    buffer_load_dwordx4 v7, s[36:39], s77 offen lds
    s_add_u32 m0, s75, 71680
    s_add_u32 s77, s78, 20480
    buffer_load_dwordx4 v6, s[40:43], s77 offen lds
    s_add_u32 m0, s75, 72704
    s_add_u32 s77, s78, 30720
    buffer_load_dwordx4 v7, s[40:43], s77 offen lds
    s_add_u32 s79, s79, 128
    s_cmp_eq_u32 s79, 1280
    s_cselect_b32 s79, 0, s79
gated_mix__ssm_conv_s5__ssm_conv_s4__prompt_kernel_sp68:
    ds_read_b128 v[20:23], v4 offset:32
    s_waitcnt lgkmcnt(0)
    v_min_u32 v20, v20, v21
    v_min_u32 v22, v22, v23
    v_min_u32 v20, v20, v22
    s_nop 0
    v_readfirstlane_b32 s68, v20
    s_nop 1
    s_cmp_ge_u32 s68, 5
    s_cbranch_scc1 gated_mix__ssm_conv_s5__ssm_conv_s4__prompt_kernel_spd69
    s_cmp_eq_u32 s98, 0
    s_cbranch_scc1 gated_mix__ssm_conv_s5__ssm_conv_s4__prompt_kernel_spd69
    s_sub_u32 s98, s98, 1
    s_sleep 0
    s_branch gated_mix__ssm_conv_s5__ssm_conv_s4__prompt_kernel_sp68
gated_mix__ssm_conv_s5__ssm_conv_s4__prompt_kernel_spd69:
    s_waitcnt vmcnt(0)
    s_mov_b64 exec, 1
    v_mov_b32 v16, 7
    ds_write_b32 v5, v16 offset:0
    s_mov_b64 exec, -1
    s_add_u32 s78, s73, s79
    s_add_u32 m0, s75, 81920
    s_add_u32 s77, s78, 0
    buffer_load_dwordx4 v6, s[36:39], s77 offen lds
    s_add_u32 m0, s75, 82944
    s_add_u32 s77, s78, 10240
    buffer_load_dwordx4 v7, s[36:39], s77 offen lds
    s_add_u32 m0, s75, 83968
    s_add_u32 s77, s78, 0
    buffer_load_dwordx4 v6, s[40:43], s77 offen lds
    s_add_u32 m0, s75, 84992
    s_add_u32 s77, s78, 10240
    buffer_load_dwordx4 v7, s[40:43], s77 offen lds
    s_add_u32 m0, s75, 86016
    s_add_u32 s77, s78, 20480
    buffer_load_dwordx4 v6, s[36:39], s77 offen lds
    s_add_u32 m0, s75, 87040
    s_add_u32 s77, s78, 30720
    buffer_load_dwordx4 v7, s[36:39], s77 offen lds
    s_add_u32 m0, s75, 88064
    s_add_u32 s77, s78, 20480
    buffer_load_dwordx4 v6, s[40:43], s77 offen lds
    s_add_u32 m0, s75, 89088
    s_add_u32 s77, s78, 30720
    buffer_load_dwordx4 v7, s[40:43], s77 offen lds
    s_add_u32 s79, s79, 128
    s_cmp_eq_u32 s79, 1280
    s_cselect_b32 s79, 0, s79
gated_mix__ssm_conv_s5__ssm_conv_s4__prompt_kernel_sp70:
    ds_read_b128 v[20:23], v4 offset:32
    s_waitcnt lgkmcnt(0)
    v_min_u32 v20, v20, v21
    v_min_u32 v22, v22, v23
    v_min_u32 v20, v20, v22
    s_nop 0
    v_readfirstlane_b32 s68, v20
    s_nop 1
    s_cmp_ge_u32 s68, 6
    s_cbranch_scc1 gated_mix__ssm_conv_s5__ssm_conv_s4__prompt_kernel_spd71
    s_cmp_eq_u32 s98, 0
    s_cbranch_scc1 gated_mix__ssm_conv_s5__ssm_conv_s4__prompt_kernel_spd71
    s_sub_u32 s98, s98, 1
    s_sleep 0
    s_branch gated_mix__ssm_conv_s5__ssm_conv_s4__prompt_kernel_sp70
gated_mix__ssm_conv_s5__ssm_conv_s4__prompt_kernel_spd71:
    s_waitcnt vmcnt(0)
    s_mov_b64 exec, 1
    v_mov_b32 v16, 8
    ds_write_b32 v5, v16 offset:0
    s_mov_b64 exec, -1
    s_add_u32 s78, s73, s79
    s_add_u32 m0, s75, 98304
    s_add_u32 s77, s78, 0
    buffer_load_dwordx4 v6, s[36:39], s77 offen lds
    s_add_u32 m0, s75, 99328
    s_add_u32 s77, s78, 10240
    buffer_load_dwordx4 v7, s[36:39], s77 offen lds
    s_add_u32 m0, s75, 100352
    s_add_u32 s77, s78, 0
    buffer_load_dwordx4 v6, s[40:43], s77 offen lds
    s_add_u32 m0, s75, 101376
    s_add_u32 s77, s78, 10240
    buffer_load_dwordx4 v7, s[40:43], s77 offen lds
    s_add_u32 m0, s75, 102400
    s_add_u32 s77, s78, 20480
    buffer_load_dwordx4 v6, s[36:39], s77 offen lds
    s_add_u32 m0, s75, 103424
    s_add_u32 s77, s78, 30720
    buffer_load_dwordx4 v7, s[36:39], s77 offen lds
    s_add_u32 m0, s75, 104448
    s_add_u32 s77, s78, 20480
    buffer_load_dwordx4 v6, s[40:43], s77 offen lds
    s_add_u32 m0, s75, 105472
    s_add_u32 s77, s78, 30720
    buffer_load_dwordx4 v7, s[40:43], s77 offen lds
    s_add_u32 s79, s79, 128
    s_cmp_eq_u32 s79, 1280
    s_cselect_b32 s79, 0, s79
gated_mix__ssm_conv_s5__ssm_conv_s4__prompt_kernel_sp72:
    ds_read_b128 v[20:23], v4 offset:32
    s_waitcnt lgkmcnt(0)
    v_min_u32 v20, v20, v21
    v_min_u32 v22, v22, v23
    v_min_u32 v20, v20, v22
    s_nop 0
    v_readfirstlane_b32 s68, v20
    s_nop 1
    s_cmp_ge_u32 s68, 7
    s_cbranch_scc1 gated_mix__ssm_conv_s5__ssm_conv_s4__prompt_kernel_spd73
    s_cmp_eq_u32 s98, 0
    s_cbranch_scc1 gated_mix__ssm_conv_s5__ssm_conv_s4__prompt_kernel_spd73
    s_sub_u32 s98, s98, 1
    s_sleep 0
    s_branch gated_mix__ssm_conv_s5__ssm_conv_s4__prompt_kernel_sp72
gated_mix__ssm_conv_s5__ssm_conv_s4__prompt_kernel_spd73:
    s_waitcnt vmcnt(0)
    s_mov_b64 exec, 1
    v_mov_b32 v16, 9
    ds_write_b32 v5, v16 offset:0
    s_mov_b64 exec, -1
    s_add_u32 s78, s73, s79
    s_add_u32 m0, s75, 65536
    s_add_u32 s77, s78, 0
    buffer_load_dwordx4 v6, s[36:39], s77 offen lds
    s_add_u32 m0, s75, 66560
    s_add_u32 s77, s78, 10240
    buffer_load_dwordx4 v7, s[36:39], s77 offen lds
    s_add_u32 m0, s75, 67584
    s_add_u32 s77, s78, 0
    buffer_load_dwordx4 v6, s[40:43], s77 offen lds
    s_add_u32 m0, s75, 68608
    s_add_u32 s77, s78, 10240
    buffer_load_dwordx4 v7, s[40:43], s77 offen lds
    s_add_u32 m0, s75, 69632
    s_add_u32 s77, s78, 20480
    buffer_load_dwordx4 v6, s[36:39], s77 offen lds
    s_add_u32 m0, s75, 70656
    s_add_u32 s77, s78, 30720
    buffer_load_dwordx4 v7, s[36:39], s77 offen lds
    s_add_u32 m0, s75, 71680
    s_add_u32 s77, s78, 20480
    buffer_load_dwordx4 v6, s[40:43], s77 offen lds
    s_add_u32 m0, s75, 72704
    s_add_u32 s77, s78, 30720
    buffer_load_dwordx4 v7, s[40:43], s77 offen lds
    s_add_u32 s79, s79, 128
    s_cmp_eq_u32 s79, 1280
    s_cselect_b32 s79, 0, s79
    s_waitcnt vmcnt(0)
    s_mov_b64 exec, 1
    v_mov_b32 v16, 10
    ds_write_b32 v5, v16 offset:0
    s_mov_b64 exec, -1
    s_branch gated_mix__ssm_conv_s5__ssm_conv_s4__prompt_kernel_p2
gated_mix__ssm_conv_s5__ssm_conv_s4__prompt_kernel_bb2:
    s_cmp_ge_u32 s2, 240
    s_cbranch_scc1 gated_mix__ssm_conv_s5__ssm_conv_s4__prompt_kernel_nb74
    s_cmp_ge_u32 s4, 8
    s_cbranch_scc1 gated_mix__ssm_conv_s5__ssm_conv_s4__prompt_kernel_pw5
    s_mov_b32 s3, s4
    s_lshr_b32 s6, s3, 1
    s_sub_u32 s5, s2, 160
    s_lshl_b32 s5, s5, 2
    s_add_u32 s5, s5, s6
    s_add_u32 s5, s5, 320
    s_and_b32 s7, s3, 1
    s_mov_b32 s63, 54272
gated_mix__ssm_conv_s5__ssm_conv_s4__prompt_kernel_brole3:
    s_setprio 3
    s_load_dwordx16 s[8:23], s[0:1], 80
    s_load_dwordx4 s[24:27], s[0:1], 160
    v_and_b32 v2, 15, v1
    v_lshrrev_b32 v3, 4, v1
    v_mov_b32 v4, 160256
    v_lshlrev_b32 v15, 2, v1
    s_lshl_b32 s60, s5, 8
    s_lshl_b32 s61, s5, 1
    v_mov_b32 v16, s61
    s_waitcnt lgkmcnt(0)
    s_mov_b32 s28, s8
    s_mov_b32 s29, s9
    s_mov_b32 s30, 163840
    s_mov_b32 s31, 0x20000
    buffer_load_dword v6, v15, s[28:31], s60 offen
    s_mov_b32 s32, s10
    s_mov_b32 s33, s11
    s_mov_b32 s34, 163840
    s_mov_b32 s35, 0x20000
    buffer_load_dword v7, v15, s[32:35], s60 offen
    s_mov_b32 s36, s12
    s_mov_b32 s37, s13
    s_mov_b32 s38, 163840
    s_mov_b32 s39, 0x20000
    buffer_load_dword v8, v15, s[36:39], s60 offen
    s_mov_b32 s40, s14
    s_mov_b32 s41, s15
    s_mov_b32 s42, 163840
    s_mov_b32 s43, 0x20000
    buffer_load_dword v9, v15, s[40:43], s60 offen
    s_mov_b32 s44, s16
    s_mov_b32 s45, s17
    s_mov_b32 s46, 163840
    s_mov_b32 s47, 0x20000
    buffer_load_dword v10, v15, s[44:47], s60 offen
    s_mov_b32 s48, s18
    s_mov_b32 s49, s19
    s_mov_b32 s50, 163840
    s_mov_b32 s51, 0x20000
    buffer_load_dword v11, v15, s[48:51], s60 offen
    s_mov_b32 s52, s20
    s_mov_b32 s53, s21
    s_mov_b32 s54, 1280
    s_mov_b32 s55, 0x20000
    buffer_load_ushort v12, v16, s[52:55], 0 offen
    s_setprio 0
    s_mov_b32 s56, s26
    s_mov_b32 s57, s27
    s_mov_b32 s58, 14680064
    s_mov_b32 s59, 0x20000
    s_mov_b32 s64, s24
    s_mov_b32 s65, s25
    s_mov_b32 s66, 256
    s_mov_b32 s67, 0x20000
    s_mul_i32 s62, s3, 6784
    s_mul_i32 s68, s6, 9216
    s_add_u32 s63, s63, s68
    s_mov_b32 s94, 0
gated_mix__ssm_conv_s5__ssm_conv_s4__prompt_kernel_bloop76:
    s_lshl_b32 s60, s5, 8
    s_lshl_b32 s61, s5, 1
    v_mov_b32 v16, s61
    v_lshlrev_b32 v15, 2, v1
    s_cmp_lt_u32 s2, 160
    s_cbranch_scc1 gated_mix__ssm_conv_s5__ssm_conv_s4__prompt_kernel_npf77
    s_load_dwordx2 s[72:73], s[0:1], 0
    s_load_dwordx4 s[76:79], s[0:1], 24
    v_mul_u32_u24 v13, 1280, v1
    s_sub_u32 s93, s2, 160
    s_lshr_b32 s93, s93, 3
    s_lshl_b32 s93, s93, 3
    s_add_u32 s93, s93, s3
    s_waitcnt lgkmcnt(0)
    s_add_u32 s68, s93, 0
    s_cmp_ge_u32 s68, 72
    s_cbranch_scc1 gated_mix__ssm_conv_s5__ssm_conv_s4__prompt_kernel_pfi78
    s_mul_i32 s69, s68, 3641
    s_lshr_b32 s69, s69, 16
    s_mul_i32 s70, s69, 18
    s_sub_u32 s70, s68, s70
    s_add_u32 s69, s69, 0
    s_lshl_b32 s69, s69, 7
    s_and_b32 s71, s2, 7
    s_cmp_lt_u32 s70, 8
    s_cselect_b32 s88, s72, s76
    s_cselect_b32 s89, s73, s77
    s_cmp_ge_u32 s70, 13
    s_cselect_b32 s88, s78, s88
    s_cselect_b32 s89, s79, s89
    s_mov_b32 s90, 819200
    s_cmp_lt_u32 s70, 8
    s_cselect_b32 s90, 2621440, s90
    s_mov_b32 s91, 0x20000
    s_lshr_b32 s92, s71, 1
    s_lshl_b32 s92, s92, 9
    s_lshl_b32 s68, s70, 6
    s_add_u32 s92, s92, s68
    s_and_b32 s71, s71, 1
    s_mul_i32 s71, s71, 320
    s_cmp_ge_u32 s70, 13
    s_cselect_b32 s68, 13, 8
    s_sub_u32 s68, s70, s68
    s_lshl_b32 s68, s68, 6
    s_add_u32 s71, s71, s68
    s_cmp_lt_u32 s70, 8
    s_cselect_b32 s92, s92, s71
    s_mul_i32 s92, s92, 1280
    s_add_u32 s92, s92, s69
    buffer_load_dword v166, v13, s[88:91], s92 offen
gated_mix__ssm_conv_s5__ssm_conv_s4__prompt_kernel_pfi78:
gated_mix__ssm_conv_s5__ssm_conv_s4__prompt_kernel_npf77:
    s_mov_b32 m0, s62
    v_lshlrev_b32 v13, 2, v2
    s_mov_b32 s68, 0x76543210
    s_mov_b32 s69, 0xfedcba98
    v_lshrrev_b64 v[18:19], v13, s[68:69]
    v_and_b32 v18, 15, v18
    v_add_u32 v18, 0, v18
    v_mul_u32_u24 v18, 288, v18
    v_lshl_add_u32 v18, v3, 4, v18
    v_add_u32 v18, s62, v18
    v_lshlrev_b32 v13, 2, v2
    s_mov_b32 s68, 0x44322210
    s_mov_b32 s69, 0x88766654
    v_lshrrev_b64 v[20:21], v13, s[68:69]
    v_and_b32 v20, 15, v20
    v_add_u32 v20, 0, v20
    v_mul_u32_u24 v20, 288, v20
    v_lshl_add_u32 v20, v3, 4, v20
    v_add_u32 v20, s62, v20
    v_lshlrev_b32 v13, 2, v2
    s_mov_b32 s68, 0x76216510
    s_mov_b32 s69, 0x98438732
    v_lshrrev_b64 v[22:23], v13, s[68:69]
    v_and_b32 v22, 15, v22
    v_add_u32 v22, 9, v22
    v_mul_u32_u24 v22, 288, v22
    v_lshl_add_u32 v22, v3, 4, v22
    v_add_u32 v22, s62, v22
    v_lshlrev_b32 v13, 2, v2
    s_mov_b32 s68, 0x43103300
    s_mov_b32 s69, 0x55224411
    v_lshrrev_b64 v[24:25], v13, s[68:69]
    v_and_b32 v24, 15, v24
    v_add_u32 v24, 0, v24
    v_mul_u32_u24 v24, 288, v24
    v_lshl_add_u32 v24, v3, 4, v24
    v_add_u32 v24, s62, v24
    v_mov_b32 v28, 0
    v_mov_b32 v29, 0
    v_mov_b32 v30, 0
    v_mov_b32 v31, 0
    v_mov_b32 v32, 0
    v_mov_b32 v33, 0
    v_mov_b32 v34, 0
    v_mov_b32 v35, 0
    v_mov_b32 v36, 0
    v_mov_b32 v37, 0
    v_mov_b32 v38, 0
    v_mov_b32 v39, 0
    v_mov_b32 v40, 0
    v_mov_b32 v41, 0
    v_mov_b32 v42, 0
    v_mov_b32 v43, 0
    v_mov_b32 v44, 0
    v_mov_b32 v45, 0
    v_mov_b32 v46, 0
    v_mov_b32 v47, 0
    s_waitcnt vmcnt(0)
    v_lshlrev_b32 v58, 16, v12
    v_mul_f32 v58, 0x3fb8aa3b, v58
    v_exp_f32 v58, v58
    s_nop 0
    v_cvt_pk_bf16_f32 v58, v58, v58
    v_lshlrev_b32 v58, 16, v58
    s_lshl_b32 s68, s7, 4
    s_sub_u32 s68, 16, s68
    v_lshlrev_b32 v96, s68, v6
    v_and_b32 v96, 0xffff0000, v96
    v_lshlrev_b32 v97, s68, v7
    v_and_b32 v97, 0xffff0000, v97
    v_lshlrev_b32 v98, s68, v8
    v_and_b32 v98, 0xffff0000, v98
    v_lshlrev_b32 v99, s68, v9
    v_and_b32 v99, 0xffff0000, v99
    v_lshlrev_b32 v100, s68, v10
    v_and_b32 v100, 0xffff0000, v100
    v_lshlrev_b32 v101, s68, v11
    v_and_b32 v101, 0xffff0000, v101
    v_mul_f32 v90, v58, v96
    v_mul_f32 v91, v58, v97
    v_mul_f32 v90, 0x3fb8aa3b, v90
    v_mul_f32 v91, 0x3e22f983, v91
    v_mul_f32 v98, v58, v98
    v_mul_f32 v99, v58, v99
    v_mul_f32 v76, v100, v98
    v_mul_f32 v77, v100, v99
    v_fma_f32 v76, -v101, v99, v76
    v_fma_f32 v77, v101, v98, v77
    v_exp_f32 v92, v90
    v_fract_f32 v93, v91
    v_cos_f32 v60, v93
    v_sin_f32 v61, v93
    s_nop 0
    v_mul_f32 v60, v60, v92
    v_mul_f32 v61, v61, v92
    v_mul_f32 v92, 0x41800000, v90
    v_mul_f32 v93, 0x41800000, v91
    v_exp_f32 v92, v92
    v_fract_f32 v93, v93
    v_cos_f32 v68, v93
    v_sin_f32 v69, v93
    s_nop 0
    v_mul_f32 v68, v68, v92
    v_mul_f32 v69, v69, v92
    v_mul_f32 v92, 0x43800000, v90
    v_mul_f32 v93, 0x43800000, v91
    v_exp_f32 v92, v92
    v_fract_f32 v93, v93
    v_cos_f32 v70, v93
    v_sin_f32 v71, v93
    s_nop 0
    v_mul_f32 v70, v70, v92
    v_mul_f32 v71, v71, v92
    v_sub_f32 v69, 0, v69
    v_mov_b32 v102, 0x3f80
    ds_write_addtid_b32 v102 offset:0
    v_cvt_pk_bf16_f32 v103, v68, v69
    v_cvt_pk_bf16_f32 v140, v76, v77
    v_pk_mul_f32 v[62:63], v[60:61], v[60:61] op_sel:[0,0] op_sel_hi:[1,0]
    ds_write_addtid_b32 v103 offset:288
    v_pk_mul_f32 v[78:79], v[76:77], v[60:61] op_sel:[0,0] op_sel_hi:[1,0]
    v_pk_fma_f32 v[62:63], v[60:61], v[60:61], v[62:63] op_sel:[1,1,0] op_sel_hi:[0,1,1] neg_lo:[1,0,0]
    v_pk_mul_f32 v[82:83], v[68:69], v[68:69] op_sel:[0,0] op_sel_hi:[1,0]
    v_pk_fma_f32 v[78:79], v[76:77], v[60:61], v[78:79] op_sel:[1,1,0] op_sel_hi:[0,1,1] neg_lo:[1,0,0]
    v_pk_mul_f32 v[64:65], v[62:63], v[62:63] op_sel:[0,0] op_sel_hi:[1,0]
    v_pk_fma_f32 v[82:83], v[68:69], v[68:69], v[82:83] op_sel:[1,1,0] op_sel_hi:[0,1,1] neg_lo:[1,0,0]
    v_cvt_pk_bf16_f32 v141, v78, v79
    v_pk_fma_f32 v[64:65], v[62:63], v[62:63], v[64:65] op_sel:[1,1,0] op_sel_hi:[0,1,1] neg_lo:[1,0,0]
    v_cvt_pk_bf16_f32 v102, v82, v83
    v_pk_mul_f32 v[80:81], v[78:79], v[60:61] op_sel:[0,0] op_sel_hi:[1,0]
    v_pk_mul_f32 v[66:67], v[64:65], v[64:65] op_sel:[0,0] op_sel_hi:[1,0]
    ds_write_addtid_b32 v102 offset:576
    v_pk_fma_f32 v[80:81], v[78:79], v[60:61], v[80:81] op_sel:[1,1,0] op_sel_hi:[0,1,1] neg_lo:[1,0,0]
    v_pk_fma_f32 v[66:67], v[64:65], v[64:65], v[66:67] op_sel:[1,1,0] op_sel_hi:[0,1,1] neg_lo:[1,0,0]
    v_pk_mul_f32 v[84:85], v[82:83], v[68:69] op_sel:[0,0] op_sel_hi:[1,0]
    v_cvt_pk_bf16_f32 v142, v80, v81
    v_pk_mul_f32 v[72:73], v[70:71], v[70:71] op_sel:[0,0] op_sel_hi:[1,0]
    v_pk_fma_f32 v[84:85], v[82:83], v[68:69], v[84:85] op_sel:[1,1,0] op_sel_hi:[0,1,1] neg_lo:[1,0,0]
    v_pk_mul_f32 v[78:79], v[80:81], v[60:61] op_sel:[0,0] op_sel_hi:[1,0]
    v_pk_fma_f32 v[72:73], v[70:71], v[70:71], v[72:73] op_sel:[1,1,0] op_sel_hi:[0,1,1] neg_lo:[1,0,0]
    v_cvt_pk_bf16_f32 v103, v84, v85
    v_pk_fma_f32 v[78:79], v[80:81], v[60:61], v[78:79] op_sel:[1,1,0] op_sel_hi:[0,1,1] neg_lo:[1,0,0]
    v_pk_mul_f32 v[74:75], v[72:73], v[72:73] op_sel:[0,0] op_sel_hi:[1,0]
    ds_write_addtid_b32 v103 offset:864
    v_cvt_pk_bf16_f32 v143, v78, v79
    v_pk_fma_f32 v[74:75], v[72:73], v[72:73], v[74:75] op_sel:[1,1,0] op_sel_hi:[0,1,1] neg_lo:[1,0,0]
    v_pk_mul_f32 v[82:83], v[84:85], v[68:69] op_sel:[0,0] op_sel_hi:[1,0]
    v_pk_mul_f32 v[80:81], v[78:79], v[60:61] op_sel:[0,0] op_sel_hi:[1,0]
    v_pk_fma_f32 v[82:83], v[84:85], v[68:69], v[82:83] op_sel:[1,1,0] op_sel_hi:[0,1,1] neg_lo:[1,0,0]
    v_pk_fma_f32 v[80:81], v[78:79], v[60:61], v[80:81] op_sel:[1,1,0] op_sel_hi:[0,1,1] neg_lo:[1,0,0]
    v_cvt_pk_bf16_f32 v102, v82, v83
    v_cvt_pk_bf16_f32 v144, v80, v81
    ds_write_addtid_b32 v102 offset:1152
    v_pk_mul_f32 v[78:79], v[80:81], v[60:61] op_sel:[0,0] op_sel_hi:[1,0]
    v_pk_mul_f32 v[84:85], v[82:83], v[68:69] op_sel:[0,0] op_sel_hi:[1,0]
    v_pk_fma_f32 v[78:79], v[80:81], v[60:61], v[78:79] op_sel:[1,1,0] op_sel_hi:[0,1,1] neg_lo:[1,0,0]
    v_pk_fma_f32 v[84:85], v[82:83], v[68:69], v[84:85] op_sel:[1,1,0] op_sel_hi:[0,1,1] neg_lo:[1,0,0]
    v_cvt_pk_bf16_f32 v145, v78, v79
    v_cvt_pk_bf16_f32 v103, v84, v85
    v_pk_mul_f32 v[80:81], v[78:79], v[60:61] op_sel:[0,0] op_sel_hi:[1,0]
    ds_write_addtid_b32 v103 offset:1440
    v_pk_fma_f32 v[80:81], v[78:79], v[60:61], v[80:81] op_sel:[1,1,0] op_sel_hi:[0,1,1] neg_lo:[1,0,0]
    v_pk_mul_f32 v[82:83], v[84:85], v[68:69] op_sel:[0,0] op_sel_hi:[1,0]
    v_cvt_pk_bf16_f32 v146, v80, v81
    v_pk_fma_f32 v[82:83], v[84:85], v[68:69], v[82:83] op_sel:[1,1,0] op_sel_hi:[0,1,1] neg_lo:[1,0,0]
    v_pk_mul_f32 v[78:79], v[80:81], v[60:61] op_sel:[0,0] op_sel_hi:[1,0]
    v_cvt_pk_bf16_f32 v102, v82, v83
    v_pk_fma_f32 v[78:79], v[80:81], v[60:61], v[78:79] op_sel:[1,1,0] op_sel_hi:[0,1,1] neg_lo:[1,0,0]
    ds_write_addtid_b32 v102 offset:1728
    v_cvt_pk_bf16_f32 v147, v78, v79
    v_pk_mul_f32 v[84:85], v[82:83], v[68:69] op_sel:[0,0] op_sel_hi:[1,0]
    v_pk_mul_f32 v[80:81], v[78:79], v[60:61] op_sel:[0,0] op_sel_hi:[1,0]
    v_pk_fma_f32 v[84:85], v[82:83], v[68:69], v[84:85] op_sel:[1,1,0] op_sel_hi:[0,1,1] neg_lo:[1,0,0]
    v_pk_fma_f32 v[80:81], v[78:79], v[60:61], v[80:81] op_sel:[1,1,0] op_sel_hi:[0,1,1] neg_lo:[1,0,0]
    v_cvt_pk_bf16_f32 v103, v84, v85
    v_cvt_pk_bf16_f32 v148, v80, v81
    ds_write_addtid_b32 v103 offset:2016
    v_pk_mul_f32 v[78:79], v[80:81], v[60:61] op_sel:[0,0] op_sel_hi:[1,0]
    v_pk_mul_f32 v[82:83], v[84:85], v[68:69] op_sel:[0,0] op_sel_hi:[1,0]
    v_pk_fma_f32 v[78:79], v[80:81], v[60:61], v[78:79] op_sel:[1,1,0] op_sel_hi:[0,1,1] neg_lo:[1,0,0]
    v_pk_fma_f32 v[82:83], v[84:85], v[68:69], v[82:83] op_sel:[1,1,0] op_sel_hi:[0,1,1] neg_lo:[1,0,0]
    v_cvt_pk_bf16_f32 v149, v78, v79
    v_cvt_pk_bf16_f32 v102, v82, v83
    v_pk_mul_f32 v[80:81], v[78:79], v[60:61] op_sel:[0,0] op_sel_hi:[1,0]
    ds_write_addtid_b32 v102 offset:2304
    v_pk_fma_f32 v[80:81], v[78:79], v[60:61], v[80:81] op_sel:[1,1,0] op_sel_hi:[0,1,1] neg_lo:[1,0,0]
    v_pk_mul_f32 v[84:85], v[82:83], v[68:69] op_sel:[0,0] op_sel_hi:[1,0]
    v_cvt_pk_bf16_f32 v150, v80, v81
    v_pk_fma_f32 v[84:85], v[82:83], v[68:69], v[84:85] op_sel:[1,1,0] op_sel_hi:[0,1,1] neg_lo:[1,0,0]
    v_pk_mul_f32 v[78:79], v[80:81], v[60:61] op_sel:[0,0] op_sel_hi:[1,0]
    v_cvt_pk_bf16_f32 v103, v84, v85
    v_pk_fma_f32 v[78:79], v[80:81], v[60:61], v[78:79] op_sel:[1,1,0] op_sel_hi:[0,1,1] neg_lo:[1,0,0]
    ds_write_addtid_b32 v103 offset:2592
    v_cvt_pk_bf16_f32 v151, v78, v79
    v_pk_mul_f32 v[82:83], v[84:85], v[68:69] op_sel:[0,0] op_sel_hi:[1,0]
    v_pk_mul_f32 v[80:81], v[78:79], v[60:61] op_sel:[0,0] op_sel_hi:[1,0]
    v_pk_fma_f32 v[82:83], v[84:85], v[68:69], v[82:83] op_sel:[1,1,0] op_sel_hi:[0,1,1] neg_lo:[1,0,0]
    v_pk_fma_f32 v[80:81], v[78:79], v[60:61], v[80:81] op_sel:[1,1,0] op_sel_hi:[0,1,1] neg_lo:[1,0,0]
    v_cvt_pk_bf16_f32 v102, v82, v83
    v_cvt_pk_bf16_f32 v152, v80, v81
    ds_write_addtid_b32 v102 offset:2880
    v_pk_mul_f32 v[78:79], v[80:81], v[60:61] op_sel:[0,0] op_sel_hi:[1,0]
    v_pk_mul_f32 v[84:85], v[82:83], v[68:69] op_sel:[0,0] op_sel_hi:[1,0]
    v_pk_fma_f32 v[78:79], v[80:81], v[60:61], v[78:79] op_sel:[1,1,0] op_sel_hi:[0,1,1] neg_lo:[1,0,0]
    v_pk_fma_f32 v[84:85], v[82:83], v[68:69], v[84:85] op_sel:[1,1,0] op_sel_hi:[0,1,1] neg_lo:[1,0,0]
    v_cvt_pk_bf16_f32 v153, v78, v79
    v_cvt_pk_bf16_f32 v103, v84, v85
    v_pk_mul_f32 v[80:81], v[78:79], v[60:61] op_sel:[0,0] op_sel_hi:[1,0]
    ds_write_addtid_b32 v103 offset:3168
    v_pk_fma_f32 v[80:81], v[78:79], v[60:61], v[80:81] op_sel:[1,1,0] op_sel_hi:[0,1,1] neg_lo:[1,0,0]
    v_pk_mul_f32 v[82:83], v[84:85], v[68:69] op_sel:[0,0] op_sel_hi:[1,0]
    v_cvt_pk_bf16_f32 v154, v80, v81
    v_pk_fma_f32 v[82:83], v[84:85], v[68:69], v[82:83] op_sel:[1,1,0] op_sel_hi:[0,1,1] neg_lo:[1,0,0]
    v_pk_mul_f32 v[78:79], v[80:81], v[60:61] op_sel:[0,0] op_sel_hi:[1,0]
    v_cvt_pk_bf16_f32 v102, v82, v83
    v_pk_fma_f32 v[78:79], v[80:81], v[60:61], v[78:79] op_sel:[1,1,0] op_sel_hi:[0,1,1] neg_lo:[1,0,0]
    ds_write_addtid_b32 v102 offset:3456
    v_cvt_pk_bf16_f32 v155, v78, v79
    v_pk_mul_f32 v[84:85], v[82:83], v[68:69] op_sel:[0,0] op_sel_hi:[1,0]
    v_pk_fma_f32 v[84:85], v[82:83], v[68:69], v[84:85] op_sel:[1,1,0] op_sel_hi:[0,1,1] neg_lo:[1,0,0]
    v_cvt_pk_bf16_f32 v103, v84, v85
    ds_write_addtid_b32 v103 offset:3744
    v_pk_mul_f32 v[82:83], v[84:85], v[68:69] op_sel:[0,0] op_sel_hi:[1,0]
    v_pk_fma_f32 v[82:83], v[84:85], v[68:69], v[82:83] op_sel:[1,1,0] op_sel_hi:[0,1,1] neg_lo:[1,0,0]
    v_cvt_pk_bf16_f32 v102, v82, v83
    ds_write_addtid_b32 v102 offset:4032
    v_pk_mul_f32 v[84:85], v[82:83], v[68:69] op_sel:[0,0] op_sel_hi:[1,0]
    v_pk_fma_f32 v[84:85], v[82:83], v[68:69], v[84:85] op_sel:[1,1,0] op_sel_hi:[0,1,1] neg_lo:[1,0,0]
    v_cvt_pk_bf16_f32 v103, v84, v85
    ds_write_addtid_b32 v103 offset:4320
    s_waitcnt lgkmcnt(0)
    ds_read_b128 v[108:111], v18 offset:0
    ds_read_b128 v[112:115], v18 offset:64
    ds_read_b128 v[116:119], v18 offset:128
    ds_read_b128 v[120:123], v18 offset:192
    v_pk_mul_f32 v[86:87], v[76:77], v[70:71] op_sel:[0,0] op_sel_hi:[1,0]
    v_pk_fma_f32 v[86:87], v[76:77], v[70:71], v[86:87] op_sel:[1,1,0] op_sel_hi:[0,1,1] neg_lo:[1,0,0]
    v_pk_mul_f32 v[78:79], v[76:77], v[72:73] op_sel:[0,0] op_sel_hi:[1,0]
    v_pk_fma_f32 v[78:79], v[76:77], v[72:73], v[78:79] op_sel:[1,1,0] op_sel_hi:[0,1,1] neg_lo:[1,0,0]
    s_waitcnt lgkmcnt(0)
    ds_write_addtid_b32 v140 offset:0
    ds_write_addtid_b32 v141 offset:288
    ds_write_addtid_b32 v142 offset:576
    ds_write_addtid_b32 v143 offset:864
    ds_write_addtid_b32 v144 offset:1152
    ds_write_addtid_b32 v145 offset:1440
    ds_write_addtid_b32 v146 offset:1728
    ds_write_addtid_b32 v147 offset:2016
    ds_write_addtid_b32 v148 offset:2304
    ds_write_addtid_b32 v149 offset:2592
    ds_write_addtid_b32 v150 offset:2880
    ds_write_addtid_b32 v151 offset:3168
    ds_write_addtid_b32 v152 offset:3456
    ds_write_addtid_b32 v153 offset:3744
    ds_write_addtid_b32 v154 offset:4032
    ds_write_addtid_b32 v155 offset:4320
    v_pk_mul_f32 v[82:83], v[78:79], v[70:71] op_sel:[0,0] op_sel_hi:[1,0]
    v_pk_fma_f32 v[82:83], v[78:79], v[70:71], v[82:83] op_sel:[1,1,0] op_sel_hi:[0,1,1] neg_lo:[1,0,0]
    s_waitcnt lgkmcnt(0)
    ds_read_b128 v[124:127], v18 offset:0
    ds_read_b128 v[128:131], v18 offset:64
    ds_read_b128 v[132:135], v18 offset:128
    ds_read_b128 v[136:139], v18 offset:192
    s_waitcnt lgkmcnt(0)
    v_mfma_f32_16x16x32_bf16 v[28:31], v[124:127], v[108:111], v[28:31]
    v_mfma_f32_16x16x32_bf16 v[28:31], v[128:131], v[112:115], v[28:31]
    v_mfma_f32_16x16x32_bf16 v[28:31], v[132:135], v[116:119], v[28:31]
    v_mfma_f32_16x16x32_bf16 v[28:31], v[136:139], v[120:123], v[28:31]
    v_cvt_pk_bf16_f32 v102, v86, v87
    v_cvt_pk_bf16_f32 v104, v78, v79
    v_cvt_pk_bf16_f32 v106, v82, v83
    ds_write_addtid_b32 v102 offset:0
    ds_write_addtid_b32 v104 offset:2592
    ds_write_addtid_b32 v106 offset:4032
    v_pk_mul_f32 v[88:89], v[86:87], v[62:63] op_sel:[0,0] op_sel_hi:[1,0]
    v_pk_mul_f32 v[80:81], v[78:79], v[64:65] op_sel:[0,0] op_sel_hi:[1,0]
    v_pk_mul_f32 v[84:85], v[82:83], v[64:65] op_sel:[0,0] op_sel_hi:[1,0]
    v_pk_fma_f32 v[88:89], v[86:87], v[62:63], v[88:89] op_sel:[1,1,0] op_sel_hi:[0,1,1] neg_lo:[1,0,0]
    v_pk_fma_f32 v[80:81], v[78:79], v[64:65], v[80:81] op_sel:[1,1,0] op_sel_hi:[0,1,1] neg_lo:[1,0,0]
    v_pk_fma_f32 v[84:85], v[82:83], v[64:65], v[84:85] op_sel:[1,1,0] op_sel_hi:[0,1,1] neg_lo:[1,0,0]
    v_cvt_pk_bf16_f32 v103, v88, v89
    v_cvt_pk_bf16_f32 v105, v80, v81
    v_cvt_pk_bf16_f32 v107, v84, v85
    ds_write_addtid_b32 v103 offset:288
    ds_write_addtid_b32 v105 offset:2880
    ds_write_addtid_b32 v107 offset:4320
    v_pk_mul_f32 v[68:69], v[88:89], v[62:63] op_sel:[0,0] op_sel_hi:[1,0]
    v_pk_mul_f32 v[60:61], v[80:81], v[64:65] op_sel:[0,0] op_sel_hi:[1,0]
    v_pk_mul_f32 v[72:73], v[84:85], v[64:65] op_sel:[0,0] op_sel_hi:[1,0]
    v_pk_fma_f32 v[68:69], v[88:89], v[62:63], v[68:69] op_sel:[1,1,0] op_sel_hi:[0,1,1] neg_lo:[1,0,0]
    v_pk_fma_f32 v[60:61], v[80:81], v[64:65], v[60:61] op_sel:[1,1,0] op_sel_hi:[0,1,1] neg_lo:[1,0,0]
    v_pk_fma_f32 v[72:73], v[84:85], v[64:65], v[72:73] op_sel:[1,1,0] op_sel_hi:[0,1,1] neg_lo:[1,0,0]
    v_cvt_pk_bf16_f32 v102, v68, v69
    v_cvt_pk_bf16_f32 v104, v60, v61
    v_cvt_pk_bf16_f32 v106, v72, v73
    ds_write_addtid_b32 v102 offset:576
    ds_write_addtid_b32 v104 offset:3168
    ds_write_addtid_b32 v106 offset:4608
    v_pk_mul_f32 v[88:89], v[68:69], v[62:63] op_sel:[0,0] op_sel_hi:[1,0]
    v_pk_mul_f32 v[80:81], v[60:61], v[64:65] op_sel:[0,0] op_sel_hi:[1,0]
    v_pk_mul_f32 v[84:85], v[72:73], v[64:65] op_sel:[0,0] op_sel_hi:[1,0]
    v_pk_fma_f32 v[88:89], v[68:69], v[62:63], v[88:89] op_sel:[1,1,0] op_sel_hi:[0,1,1] neg_lo:[1,0,0]
    v_pk_fma_f32 v[80:81], v[60:61], v[64:65], v[80:81] op_sel:[1,1,0] op_sel_hi:[0,1,1] neg_lo:[1,0,0]
    v_pk_fma_f32 v[84:85], v[72:73], v[64:65], v[84:85] op_sel:[1,1,0] op_sel_hi:[0,1,1] neg_lo:[1,0,0]
    v_cvt_pk_bf16_f32 v103, v88, v89
    v_cvt_pk_bf16_f32 v105, v80, v81
    v_cvt_pk_bf16_f32 v107, v84, v85
    ds_write_addtid_b32 v103 offset:864
    ds_write_addtid_b32 v105 offset:3456
    ds_write_addtid_b32 v107 offset:4896
    v_pk_mul_f32 v[68:69], v[88:89], v[62:63] op_sel:[0,0] op_sel_hi:[1,0]
    v_pk_mul_f32 v[60:61], v[80:81], v[64:65] op_sel:[0,0] op_sel_hi:[1,0]
    v_pk_mul_f32 v[72:73], v[84:85], v[64:65] op_sel:[0,0] op_sel_hi:[1,0]
    v_pk_fma_f32 v[68:69], v[88:89], v[62:63], v[68:69] op_sel:[1,1,0] op_sel_hi:[0,1,1] neg_lo:[1,0,0]
    v_pk_fma_f32 v[60:61], v[80:81], v[64:65], v[60:61] op_sel:[1,1,0] op_sel_hi:[0,1,1] neg_lo:[1,0,0]
    v_pk_fma_f32 v[72:73], v[84:85], v[64:65], v[72:73] op_sel:[1,1,0] op_sel_hi:[0,1,1] neg_lo:[1,0,0]
    v_cvt_pk_bf16_f32 v102, v68, v69
    v_cvt_pk_bf16_f32 v104, v60, v61
    v_cvt_pk_bf16_f32 v106, v72, v73
    ds_write_addtid_b32 v102 offset:1152
    ds_write_addtid_b32 v104 offset:3744
    ds_write_addtid_b32 v106 offset:5184
    v_pk_mul_f32 v[88:89], v[68:69], v[62:63] op_sel:[0,0] op_sel_hi:[1,0]
    v_pk_fma_f32 v[88:89], v[68:69], v[62:63], v[88:89] op_sel:[1,1,0] op_sel_hi:[0,1,1] neg_lo:[1,0,0]
    v_cvt_pk_bf16_f32 v103, v88, v89
    ds_write_addtid_b32 v103 offset:1440
    v_pk_mul_f32 v[68:69], v[88:89], v[62:63] op_sel:[0,0] op_sel_hi:[1,0]
    v_pk_fma_f32 v[68:69], v[88:89], v[62:63], v[68:69] op_sel:[1,1,0] op_sel_hi:[0,1,1] neg_lo:[1,0,0]
    v_cvt_pk_bf16_f32 v102, v68, v69
    ds_write_addtid_b32 v102 offset:1728
    v_pk_mul_f32 v[88:89], v[68:69], v[62:63] op_sel:[0,0] op_sel_hi:[1,0]
    v_pk_fma_f32 v[88:89], v[68:69], v[62:63], v[88:89] op_sel:[1,1,0] op_sel_hi:[0,1,1] neg_lo:[1,0,0]
    v_cvt_pk_bf16_f32 v103, v88, v89
    ds_write_addtid_b32 v103 offset:2016
    v_pk_mul_f32 v[68:69], v[88:89], v[62:63] op_sel:[0,0] op_sel_hi:[1,0]
    v_pk_fma_f32 v[68:69], v[88:89], v[62:63], v[68:69] op_sel:[1,1,0] op_sel_hi:[0,1,1] neg_lo:[1,0,0]
    v_cvt_pk_bf16_f32 v102, v68, v69
    ds_write_addtid_b32 v102 offset:2304
    s_waitcnt lgkmcnt(0)
    ds_read_b128 v[124:127], v20 offset:0
    ds_read_b128 v[128:131], v20 offset:64
    ds_read_b128 v[132:135], v20 offset:128
    ds_read_b128 v[136:139], v20 offset:192
    ds_read_b128 v[140:143], v22 offset:0
    ds_read_b128 v[144:147], v22 offset:64
    ds_read_b128 v[148:151], v22 offset:128
    ds_read_b128 v[152:155], v22 offset:192
    v_pk_mul_f32 v[78:79], v[76:77], v[74:75] op_sel:[0,0] op_sel_hi:[1,0]
    v_pk_fma_f32 v[78:79], v[76:77], v[74:75], v[78:79] op_sel:[1,1,0] op_sel_hi:[0,1,1] neg_lo:[1,0,0]
    v_pk_mul_f32 v[80:81], v[78:79], v[66:67] op_sel:[0,0] op_sel_hi:[1,0]
    v_pk_fma_f32 v[80:81], v[78:79], v[66:67], v[80:81] op_sel:[1,1,0] op_sel_hi:[0,1,1] neg_lo:[1,0,0]
    v_pk_mul_f32 v[82:83], v[80:81], v[66:67] op_sel:[0,0] op_sel_hi:[1,0]
    v_pk_fma_f32 v[82:83], v[80:81], v[66:67], v[82:83] op_sel:[1,1,0] op_sel_hi:[0,1,1] neg_lo:[1,0,0]
    s_cmp_lg_u32 s3, 0
    s_cbranch_scc1 gated_mix__ssm_conv_s5__ssm_conv_s4__prompt_kernel_both81
    s_lshr_b32 s68, s5, 6
    v_mov_b32 v92, 0
    s_lshl_b32 s68, s68, 9
    s_add_u32 s68, s68, 10747904
    v_and_b32 v93, 31, v1
    v_lshrrev_b32 v94, 3, v93
    v_and_b32 v93, 7, v93
    v_lshlrev_b32 v93, 2, v93
    v_lshl_add_u32 v93, v94, 7, v93
gated_mix__ssm_conv_s5__ssm_conv_s4__prompt_kernel_bpoll80:
    buffer_load_dword v48, v92, s[64:67], 0 offen sc1
    buffer_load_dword v49, v93, s[56:59], s68 offen sc1
    s_waitcnt vmcnt(0)
    v_cmp_eq_u32 s[70:71], v48, v49
    v_cmp_ne_u32 vcc, 0, v48
    s_and_b64 s[70:71], s[70:71], vcc
    s_cmp_eq_u64 s[70:71], -1
    s_cbranch_scc1 gated_mix__ssm_conv_s5__ssm_conv_s4__prompt_kernel_bpoll80_d
    s_cmp_eq_u32 s98, 0
    s_cbranch_scc1 gated_mix__ssm_conv_s5__ssm_conv_s4__prompt_kernel_bpoll80_d
    s_sub_u32 s98, s98, 1
    s_sleep 8
    s_branch gated_mix__ssm_conv_s5__ssm_conv_s4__prompt_kernel_bpoll80
gated_mix__ssm_conv_s5__ssm_conv_s4__prompt_kernel_bpoll80_d:
    v_readfirstlane_b32 s93, v48
    s_nop 1
    v_add_u32 v93, s94, v4
    s_mov_b64 exec, 1
    v_mov_b32 v92, s93
    ds_write_b32 v93, v92 offset:52
    s_mov_b64 exec, -1
    s_branch gated_mix__ssm_conv_s5__ssm_conv_s4__prompt_kernel_bgot79
gated_mix__ssm_conv_s5__ssm_conv_s4__prompt_kernel_both81:
    v_add_u32 v93, s94, v4
gated_mix__ssm_conv_s5__ssm_conv_s4__prompt_kernel_sp82:
    ds_read_b32 v92, v93 offset:52
    s_waitcnt lgkmcnt(0)
    s_nop 0
    v_readfirstlane_b32 s93, v92
    s_nop 1
    s_cmp_ge_u32 s93, 1
    s_cbranch_scc1 gated_mix__ssm_conv_s5__ssm_conv_s4__prompt_kernel_spd83
    s_cmp_eq_u32 s98, 0
    s_cbranch_scc1 gated_mix__ssm_conv_s5__ssm_conv_s4__prompt_kernel_spd83
    s_sub_u32 s98, s98, 1
    s_sleep 8
    s_branch gated_mix__ssm_conv_s5__ssm_conv_s4__prompt_kernel_sp82
gated_mix__ssm_conv_s5__ssm_conv_s4__prompt_kernel_spd83:
gated_mix__ssm_conv_s5__ssm_conv_s4__prompt_kernel_bgot79:
    s_lshl_b32 s68, s5, 12
    s_lshl_b32 s69, s7, 11
    s_add_u32 s68, s68, s69
    s_add_u32 s68, s68, 11534336
    v_lshlrev_b32 v92, 4, v1
    buffer_load_dwordx4 v[48:51], v92, s[56:59], s68 offen sc1
    buffer_load_dwordx4 v[52:55], v92, s[56:59], s68 offen offset:1024 sc1
    buffer_load_dword v56, v92, s[56:59], s68 offen offset:16 sc1
    buffer_load_dword v57, v92, s[56:59], s68 offen offset:1040 sc1
    s_waitcnt lgkmcnt(0)
    v_mfma_f32_16x16x32_bf16 v[32:35], v[124:127], v[108:111], v[32:35]
    v_mfma_f32_16x16x32_bf16 v[32:35], v[128:131], v[112:115], v[32:35]
    v_mfma_f32_16x16x32_bf16 v[32:35], v[132:135], v[116:119], v[32:35]
    v_mfma_f32_16x16x32_bf16 v[32:35], v[136:139], v[120:123], v[32:35]
    v_mfma_f32_16x16x32_bf16 v[36:39], v[140:143], v[108:111], v[36:39]
    v_mfma_f32_16x16x32_bf16 v[36:39], v[144:147], v[112:115], v[36:39]
    v_mfma_f32_16x16x32_bf16 v[36:39], v[148:151], v[116:119], v[36:39]
    v_mfma_f32_16x16x32_bf16 v[36:39], v[152:155], v[120:123], v[36:39]
    v_cvt_pk_bf16_f32 v103, v78, v79
    v_cvt_pk_bf16_f32 v105, v80, v81
    v_cvt_pk_bf16_f32 v107, v82, v83
    ds_write_addtid_b32 v103 offset:0
    ds_write_addtid_b32 v105 offset:288
    ds_write_addtid_b32 v107 offset:576
    v_pk_mul_f32 v[86:87], v[78:79], v[70:71] op_sel:[0,0] op_sel_hi:[1,0]
    v_pk_mul_f32 v[88:89], v[80:81], v[70:71] op_sel:[0,0] op_sel_hi:[1,0]
    v_pk_mul_f32 v[84:85], v[82:83], v[70:71] op_sel:[0,0] op_sel_hi:[1,0]
    v_pk_fma_f32 v[86:87], v[78:79], v[70:71], v[86:87] op_sel:[1,1,0] op_sel_hi:[0,1,1] neg_lo:[1,0,0]
    v_pk_fma_f32 v[88:89], v[80:81], v[70:71], v[88:89] op_sel:[1,1,0] op_sel_hi:[0,1,1] neg_lo:[1,0,0]
    v_pk_fma_f32 v[84:85], v[82:83], v[70:71], v[84:85] op_sel:[1,1,0] op_sel_hi:[0,1,1] neg_lo:[1,0,0]
    v_cvt_pk_bf16_f32 v102, v86, v87
    v_cvt_pk_bf16_f32 v104, v88, v89
    v_cvt_pk_bf16_f32 v106, v84, v85
    ds_write_addtid_b32 v102 offset:864
    ds_write_addtid_b32 v104 offset:1152
    ds_write_addtid_b32 v106 offset:1440
    v_pk_mul_f32 v[60:61], v[86:87], v[70:71] op_sel:[0,0] op_sel_hi:[1,0]
    v_pk_mul_f32 v[62:63], v[88:89], v[70:71] op_sel:[0,0] op_sel_hi:[1,0]
    v_pk_mul_f32 v[64:65], v[84:85], v[70:71] op_sel:[0,0] op_sel_hi:[1,0]
    v_pk_fma_f32 v[60:61], v[86:87], v[70:71], v[60:61] op_sel:[1,1,0] op_sel_hi:[0,1,1] neg_lo:[1,0,0]
    v_pk_fma_f32 v[62:63], v[88:89], v[70:71], v[62:63] op_sel:[1,1,0] op_sel_hi:[0,1,1] neg_lo:[1,0,0]
    v_pk_fma_f32 v[64:65], v[84:85], v[70:71], v[64:65] op_sel:[1,1,0] op_sel_hi:[0,1,1] neg_lo:[1,0,0]
    v_cvt_pk_bf16_f32 v103, v60, v61
    v_cvt_pk_bf16_f32 v105, v62, v63
    v_cvt_pk_bf16_f32 v107, v64, v65
    ds_write_addtid_b32 v103 offset:1728
    ds_write_addtid_b32 v105 offset:2016
    ds_write_addtid_b32 v107 offset:2304
    v_pk_mul_f32 v[86:87], v[60:61], v[70:71] op_sel:[0,0] op_sel_hi:[1,0]
    v_pk_mul_f32 v[88:89], v[62:63], v[70:71] op_sel:[0,0] op_sel_hi:[1,0]
    v_pk_mul_f32 v[84:85], v[64:65], v[70:71] op_sel:[0,0] op_sel_hi:[1,0]
    v_pk_fma_f32 v[86:87], v[60:61], v[70:71], v[86:87] op_sel:[1,1,0] op_sel_hi:[0,1,1] neg_lo:[1,0,0]
    v_pk_fma_f32 v[88:89], v[62:63], v[70:71], v[88:89] op_sel:[1,1,0] op_sel_hi:[0,1,1] neg_lo:[1,0,0]
    v_pk_fma_f32 v[84:85], v[64:65], v[70:71], v[84:85] op_sel:[1,1,0] op_sel_hi:[0,1,1] neg_lo:[1,0,0]
    v_cvt_pk_bf16_f32 v102, v86, v87
    v_cvt_pk_bf16_f32 v104, v88, v89
    v_cvt_pk_bf16_f32 v106, v84, v85
    ds_write_addtid_b32 v102 offset:2592
    ds_write_addtid_b32 v104 offset:2880
    ds_write_addtid_b32 v106 offset:3168
    s_waitcnt lgkmcnt(0)
    ds_read_b128 v[124:127], v24 offset:0
    ds_read_b128 v[128:131], v24 offset:64
    ds_read_b128 v[132:135], v24 offset:128
    ds_read_b128 v[136:139], v24 offset:192
    ds_read_b128 v[140:143], v24 offset:1728
    ds_read_b128 v[144:147], v24 offset:1792
    ds_read_b128 v[148:151], v24 offset:1856
    ds_read_b128 v[152:155], v24 offset:1920
    s_waitcnt lgkmcnt(0)
    v_mfma_f32_16x16x32_bf16 v[40:43], v[124:127], v[108:111], v[40:43]
    v_mfma_f32_16x16x32_bf16 v[40:43], v[128:131], v[112:115], v[40:43]
    v_mfma_f32_16x16x32_bf16 v[40:43], v[132:135], v[116:119], v[40:43]
    v_mfma_f32_16x16x32_bf16 v[40:43], v[136:139], v[120:123], v[40:43]
    v_mfma_f32_16x16x32_bf16 v[44:47], v[140:143], v[108:111], v[44:47]
    v_mfma_f32_16x16x32_bf16 v[44:47], v[144:147], v[112:115], v[44:47]
    v_mfma_f32_16x16x32_bf16 v[44:47], v[148:151], v[116:119], v[44:47]
    v_mfma_f32_16x16x32_bf16 v[44:47], v[152:155], v[120:123], v[44:47]
    v_lshl_add_u32 v92, v1, 3, s62
    s_xor_b32 s68, s3, 1
    s_mul_i32 s68, s68, 6784
    v_lshl_add_u32 v93, v1, 3, s68
    s_waitcnt vmcnt(0)
    s_cmp_eq_u32 s7, 1
    s_cselect_b32 s68, 63, 64
    v_mov_b32 v94, 0
    v_cmp_eq_u32 vcc, s68, v1
    s_nop 1
    v_cndmask_b32 v57, v57, v94, vcc
    s_lshl_b32 s68, s7, 11
    s_add_u32 s68, s68, s63
    v_lshl_add_u32 v94, v1, 4, s68
    ds_write_b128 v94, v[48:51] offset:4576
    v_alignbyte_b32 v124, v49, v48, 2
    v_alignbyte_b32 v125, v50, v49, 2
    v_alignbyte_b32 v126, v51, v50, 2
    v_alignbyte_b32 v127, v56, v51, 2
    ds_write_b128 v94, v[124:127] offset:0
    ds_write_b128 v94, v[52:55] offset:5600
    v_alignbyte_b32 v128, v53, v52, 2
    v_alignbyte_b32 v129, v54, v53, 2
    v_alignbyte_b32 v130, v55, v54, 2
    v_alignbyte_b32 v131, v57, v55, 2
    ds_write_b128 v94, v[128:131] offset:1024
    v_mov_b32 v86, 0
    v_mov_b32 v87, 0
    s_mul_i32 s68, s7, 4576
    s_add_u32 s68, s68, s63
    v_lshl_add_u32 v95, v1, 3, s68
    v_cmp_gt_u32 vcc, 56, v1
    s_and_saveexec_b64 s[70:71], vcc
    ds_write_b64 v95, v[86:87] offset:4096
    s_mov_b64 exec, s[70:71]
    v_cvt_pk_bf16_f32 v140, v28, v29
    v_cvt_pk_bf16_f32 v141, v30, v31
    ds_write_b64 v92, v[140:141] offset:4224
    v_cvt_pk_bf16_f32 v142, v32, v33
    v_cvt_pk_bf16_f32 v143, v34, v35
    ds_write_b64 v92, v[142:143] offset:4736
    v_cvt_pk_bf16_f32 v144, v36, v37
    v_cvt_pk_bf16_f32 v145, v38, v39
    ds_write_b64 v92, v[144:145] offset:5248
    v_cvt_pk_bf16_f32 v146, v40, v41
    v_cvt_pk_bf16_f32 v147, v42, v43
    ds_write_b64 v92, v[146:147] offset:5760
    v_cvt_pk_bf16_f32 v148, v44, v45
    v_cvt_pk_bf16_f32 v149, v46, v47
    ds_write_b64 v92, v[148:149] offset:6272
    s_waitcnt lgkmcnt(0)
    s_lshl_b32 s68, s3, 2
    v_mov_b32 v26, 160320
    v_add_u32 v26, s68, v26
    s_add_u32 s69, s94, 1
    s_mov_b64 exec, 1
    v_mov_b32 v27, s69
    ds_write_b32 v26, v27 offset:0
    s_mov_b64 exec, -1
    v_xor_b32 v26, 4, v26
gated_mix__ssm_conv_s5__ssm_conv_s4__prompt_kernel_sp84:
    ds_read_b32 v27, v26 offset:0
    s_waitcnt lgkmcnt(0)
    s_nop 0
    v_readfirstlane_b32 s68, v27
    s_nop 1
    s_cmp_ge_u32 s68, s69
    s_cbranch_scc1 gated_mix__ssm_conv_s5__ssm_conv_s4__prompt_kernel_spd85
    s_cmp_eq_u32 s98, 0
    s_cbranch_scc1 gated_mix__ssm_conv_s5__ssm_conv_s4__prompt_kernel_spd85
    s_sub_u32 s98, s98, 1
    s_sleep 1
    s_branch gated_mix__ssm_conv_s5__ssm_conv_s4__prompt_kernel_sp84
gated_mix__ssm_conv_s5__ssm_conv_s4__prompt_kernel_spd85:
    ds_read_b64 v[124:125], v93 offset:4224
    ds_read_b64 v[126:127], v93 offset:4736
    ds_read_b64 v[128:129], v93 offset:5248
    ds_read_b64 v[130:131], v93 offset:5760
    ds_read_b64 v[132:133], v93 offset:6272
    v_lshlrev_b32 v94, 5, v2
    v_lshl_add_u32 v94, v3, 3, v94
    v_add_u32 v94, s62, v94
    v_and_b32 v95, 1, v3
    v_cmp_eq_u32 vcc, 1, v95
    s_waitcnt lgkmcnt(0)
    v_lshlrev_b32 v140, 16, v124
    v_and_b32 v141, 0xffff0000, v124
    v_add_f32 v28, v28, v140
    v_add_f32 v29, v29, v141
    v_lshlrev_b32 v140, 16, v125
    v_and_b32 v141, 0xffff0000, v125
    v_add_f32 v30, v30, v140
    v_add_f32 v31, v31, v141
    v_lshlrev_b32 v140, 16, v126
    v_and_b32 v141, 0xffff0000, v126
    v_add_f32 v32, v32, v140
    v_add_f32 v33, v33, v141
    v_lshlrev_b32 v140, 16, v127
    v_and_b32 v141, 0xffff0000, v127
    v_add_f32 v34, v34, v140
    v_add_f32 v35, v35, v141
    v_lshlrev_b32 v140, 16, v128
    v_and_b32 v141, 0xffff0000, v128
    v_add_f32 v36, v36, v140
    v_add_f32 v37, v37, v141
    v_lshlrev_b32 v140, 16, v129
    v_and_b32 v141, 0xffff0000, v129
    v_add_f32 v38, v38, v140
    v_add_f32 v39, v39, v141
    v_lshlrev_b32 v140, 16, v130
    v_and_b32 v141, 0xffff0000, v130
    v_add_f32 v40, v40, v140
    v_add_f32 v41, v41, v141
    v_lshlrev_b32 v140, 16, v131
    v_and_b32 v141, 0xffff0000, v131
    v_add_f32 v42, v42, v140
    v_add_f32 v43, v43, v141
    v_lshlrev_b32 v140, 16, v132
    v_and_b32 v141, 0xffff0000, v132
    v_add_f32 v44, v44, v140
    v_add_f32 v45, v45, v141
    v_lshlrev_b32 v140, 16, v133
    v_and_b32 v141, 0xffff0000, v133
    v_add_f32 v46, v46, v140
    v_add_f32 v47, v47, v141
    v_cvt_pk_bf16_f32 v108, v28, v29
    v_cvt_pk_bf16_f32 v109, v30, v31
    v_cvt_pk_bf16_f32 v110, v32, v32
    v_cvt_pk_bf16_f32 v111, v33, v34
    v_cndmask_b32 v95, v36, v37, vcc
    v_cvt_pk_bf16_f32 v112, v36, v36
    v_cvt_pk_bf16_f32 v113, v95, v37
    v_cndmask_b32 v95, v38, v39, vcc
    v_cvt_pk_bf16_f32 v114, v38, v38
    v_cvt_pk_bf16_f32 v115, v95, v39
    v_cvt_pk_bf16_f32 v116, v40, v41
    v_cvt_pk_bf16_f32 v117, v41, v41
    v_cvt_pk_bf16_f32 v118, v42, v43
    v_cvt_pk_bf16_f32 v119, v43, v43
    v_cvt_pk_bf16_f32 v120, v44, v45
    v_cvt_pk_bf16_f32 v121, v45, v45
    v_cvt_pk_bf16_f32 v122, v46, v47
    v_cvt_pk_bf16_f32 v123, v47, v47
    v_lshl_add_u32 v93, v1, 2, s62
    s_cmp_eq_u32 s7, 1
    s_cbranch_scc1 gated_mix__ssm_conv_s5__ssm_conv_s4__prompt_kernel_g186
    ds_write_b32 v94, v108 offset:60
    ds_write_b32 v94, v109 offset:64
    ds_write_b32 v94, v110 offset:572
    ds_write_b32 v94, v111 offset:576
    ds_write_b32 v94, v112 offset:1084
    ds_write_b32 v94, v113 offset:1088
    ds_write_b32 v94, v114 offset:1596
    ds_write_b32 v94, v115 offset:1600
    ds_write_b32 v94, v116 offset:2108
    ds_write_b32 v94, v117 offset:2112
    ds_write_b32 v94, v118 offset:2620
    ds_write_b32 v94, v119 offset:2624
    ds_write_b32 v94, v120 offset:3132
    ds_write_b32 v94, v121 offset:3136
    ds_write_b32 v94, v122 offset:3644
    ds_write_b32 v94, v123 offset:3648
    v_cmp_gt_u32 vcc, 15, v1
    s_and_saveexec_b64 s[70:71], vcc
    ds_write_b32 v93, v86
    s_mov_b64 exec, s[70:71]
    s_branch gated_mix__ssm_conv_s5__ssm_conv_s4__prompt_kernel_ge87
gated_mix__ssm_conv_s5__ssm_conv_s4__prompt_kernel_g186:
    ds_write_b64 v94, v[108:109] offset:56
    ds_write_b64 v94, v[110:111] offset:568
    ds_write_b64 v94, v[112:113] offset:1080
    ds_write_b64 v94, v[114:115] offset:1592
    ds_write_b64 v94, v[116:117] offset:2104
    ds_write_b64 v94, v[118:119] offset:2616
    ds_write_b64 v94, v[120:121] offset:3128
    ds_write_b64 v94, v[122:123] offset:3640
    v_cmp_gt_u32 vcc, 14, v1
    s_and_saveexec_b64 s[70:71], vcc
    ds_write_b32 v93, v86
    s_mov_b64 exec, s[70:71]
gated_mix__ssm_conv_s5__ssm_conv_s4__prompt_kernel_ge87:
    s_waitcnt lgkmcnt(0)
    s_lshl_b32 s68, s3, 2
    v_mov_b32 v26, 160320
    v_add_u32 v26, s68, v26
    s_add_u32 s69, s94, 2
    s_mov_b64 exec, 1
    v_mov_b32 v27, s69
    ds_write_b32 v26, v27 offset:0
    s_mov_b64 exec, -1
    v_xor_b32 v26, 4, v26
gated_mix__ssm_conv_s5__ssm_conv_s4__prompt_kernel_sp88:
    ds_read_b32 v27, v26 offset:0
    s_waitcnt lgkmcnt(0)
    s_nop 0
    v_readfirstlane_b32 s68, v27
    s_nop 1
    s_cmp_ge_u32 s68, s69
    s_cbranch_scc1 gated_mix__ssm_conv_s5__ssm_conv_s4__prompt_kernel_spd89
    s_cmp_eq_u32 s98, 0
    s_cbranch_scc1 gated_mix__ssm_conv_s5__ssm_conv_s4__prompt_kernel_spd89
    s_sub_u32 s98, s98, 1
    s_sleep 1
    s_branch gated_mix__ssm_conv_s5__ssm_conv_s4__prompt_kernel_sp88
gated_mix__ssm_conv_s5__ssm_conv_s4__prompt_kernel_spd89:
    v_and_b32 v162, 1, v2
    v_mul_u32_u24 v162, 6780, v162
    v_lshl_add_u32 v162, v2, 2, v162
    v_lshl_add_u32 v162, v3, 4, v162
    s_and_b32 s68, s3, 6
    s_mul_i32 s68, s68, 6784
    s_lshl_b32 s69, s7, 8
    s_add_u32 s68, s68, s69
    v_add_u32 v160, s68, v162
    v_and_b32 v162, 1, v2
    v_mul_u32_u24 v162, 4576, v162
    v_lshrrev_b32 v163, 1, v2
    v_lshlrev_b32 v163, 6, v163
    v_sub_u32 v162, v162, v163
    v_lshl_add_u32 v162, v3, 4, v162
    v_add_u32 v162, 448, v162
    s_add_u32 s68, s63, s69
    v_add_u32 v161, s68, v162
    ds_read_b128 v[152:155], v161 offset:0
    ds_read_b64 v[92:93], v160 offset:0
    ds_read_b64 v[94:95], v160 offset:8
    ds_read_b128 v[148:151], v161 offset:512
    ds_read_b64 v[96:97], v160 offset:512
    ds_read_b64 v[98:99], v160 offset:520
    ds_read_b128 v[144:147], v161 offset:1024
    ds_read_b64 v[100:101], v160 offset:1024
    ds_read_b64 v[102:103], v160 offset:1032
    ds_read_b128 v[140:143], v161 offset:1536
    ds_read_b64 v[104:105], v160 offset:1536
    ds_read_b64 v[106:107], v160 offset:1544
    ds_read_b128 v[136:139], v161 offset:2048
    ds_read_b64 v[108:109], v160 offset:2048
    ds_read_b64 v[110:111], v160 offset:2056
    ds_read_b128 v[132:135], v161 offset:2560
    ds_read_b64 v[112:113], v160 offset:2560
    ds_read_b64 v[114:115], v160 offset:2568
    ds_read_b128 v[128:131], v161 offset:3072
    ds_read_b64 v[116:117], v160 offset:3072
    ds_read_b64 v[118:119], v160 offset:3080
    ds_read_b128 v[124:127], v161 offset:3584
    ds_read_b64 v[120:121], v160 offset:3584
    ds_read_b64 v[122:123], v160 offset:3592
    v_mov_b32 v60, 0
    v_mov_b32 v61, 0
    v_mov_b32 v62, 0
    v_mov_b32 v63, 0
    v_mov_b32 v64, 0
    v_mov_b32 v65, 0
    v_mov_b32 v66, 0
    v_mov_b32 v67, 0
    v_mov_b32 v68, 0
    v_mov_b32 v69, 0
    v_mov_b32 v70, 0
    v_mov_b32 v71, 0
    v_mov_b32 v72, 0
    v_mov_b32 v73, 0
    v_mov_b32 v74, 0
    v_mov_b32 v75, 0
    v_mov_b32 v76, 0
    v_mov_b32 v77, 0
    v_mov_b32 v78, 0
    v_mov_b32 v79, 0
    v_mov_b32 v80, 0
    v_mov_b32 v81, 0
    v_mov_b32 v82, 0
    v_mov_b32 v83, 0
    v_mov_b32 v84, 0
    v_mov_b32 v85, 0
    v_mov_b32 v86, 0
    v_mov_b32 v87, 0
    v_mov_b32 v88, 0
    v_mov_b32 v89, 0
    v_mov_b32 v90, 0
    v_mov_b32 v91, 0
    s_nop 1
    s_waitcnt lgkmcnt(15)
    v_mfma_f32_16x16x32_bf16 v[88:91], v[92:95], v[152:155], v[88:91]
    ds_read_b128 v[152:155], v161 offset:64
    v_mfma_f32_16x16x32_bf16 v[84:87], v[92:95], v[148:151], v[84:87]
    v_mfma_f32_16x16x32_bf16 v[80:83], v[92:95], v[144:147], v[80:83]
    s_waitcnt lgkmcnt(15)
    v_mfma_f32_16x16x32_bf16 v[76:79], v[92:95], v[140:143], v[76:79]
    s_waitcnt lgkmcnt(12)
    v_mfma_f32_16x16x32_bf16 v[72:75], v[92:95], v[136:139], v[72:75]
    s_waitcnt lgkmcnt(9)
    v_mfma_f32_16x16x32_bf16 v[68:71], v[92:95], v[132:135], v[68:71]
    s_waitcnt lgkmcnt(6)
    v_mfma_f32_16x16x32_bf16 v[64:67], v[92:95], v[128:131], v[64:67]
    s_waitcnt lgkmcnt(3)
    v_mfma_f32_16x16x32_bf16 v[60:63], v[92:95], v[124:127], v[60:63]
    ds_read_b64 v[92:93], v160 offset:64
    ds_read_b64 v[94:95], v160 offset:72
    v_mfma_f32_16x16x32_bf16 v[88:91], v[96:99], v[148:151], v[88:91]
    ds_read_b128 v[148:151], v161 offset:576
    v_mfma_f32_16x16x32_bf16 v[84:87], v[96:99], v[144:147], v[84:87]
    v_mfma_f32_16x16x32_bf16 v[80:83], v[96:99], v[140:143], v[80:83]
    v_mfma_f32_16x16x32_bf16 v[76:79], v[96:99], v[136:139], v[76:79]
    v_mfma_f32_16x16x32_bf16 v[72:75], v[96:99], v[132:135], v[72:75]
    v_mfma_f32_16x16x32_bf16 v[68:71], v[96:99], v[128:131], v[68:71]
    v_mfma_f32_16x16x32_bf16 v[64:67], v[96:99], v[124:127], v[64:67]
    ds_read_b64 v[96:97], v160 offset:576
    ds_read_b64 v[98:99], v160 offset:584
    v_mfma_f32_16x16x32_bf16 v[88:91], v[100:103], v[144:147], v[88:91]
    ds_read_b128 v[144:147], v161 offset:1088
    v_mfma_f32_16x16x32_bf16 v[84:87], v[100:103], v[140:143], v[84:87]
    v_mfma_f32_16x16x32_bf16 v[80:83], v[100:103], v[136:139], v[80:83]
    v_mfma_f32_16x16x32_bf16 v[76:79], v[100:103], v[132:135], v[76:79]
    v_mfma_f32_16x16x32_bf16 v[72:75], v[100:103], v[128:131], v[72:75]
    v_mfma_f32_16x16x32_bf16 v[68:71], v[100:103], v[124:127], v[68:71]
    ds_read_b64 v[100:101], v160 offset:1088
    ds_read_b64 v[102:103], v160 offset:1096
    v_mfma_f32_16x16x32_bf16 v[88:91], v[104:107], v[140:143], v[88:91]
    ds_read_b128 v[140:143], v161 offset:1600
    v_mfma_f32_16x16x32_bf16 v[84:87], v[104:107], v[136:139], v[84:87]
    v_mfma_f32_16x16x32_bf16 v[80:83], v[104:107], v[132:135], v[80:83]
    v_mfma_f32_16x16x32_bf16 v[76:79], v[104:107], v[128:131], v[76:79]
    v_mfma_f32_16x16x32_bf16 v[72:75], v[104:107], v[124:127], v[72:75]
    ds_read_b64 v[104:105], v160 offset:1600
    ds_read_b64 v[106:107], v160 offset:1608
    v_mfma_f32_16x16x32_bf16 v[88:91], v[108:111], v[136:139], v[88:91]
    ds_read_b128 v[136:139], v161 offset:2112
    v_mfma_f32_16x16x32_bf16 v[84:87], v[108:111], v[132:135], v[84:87]
    v_mfma_f32_16x16x32_bf16 v[80:83], v[108:111], v[128:131], v[80:83]
    v_mfma_f32_16x16x32_bf16 v[76:79], v[108:111], v[124:127], v[76:79]
    ds_read_b64 v[108:109], v160 offset:2112
    ds_read_b64 v[110:111], v160 offset:2120
    v_mfma_f32_16x16x32_bf16 v[88:91], v[112:115], v[132:135], v[88:91]
    ds_read_b128 v[132:135], v161 offset:2624
    v_mfma_f32_16x16x32_bf16 v[84:87], v[112:115], v[128:131], v[84:87]
    v_mfma_f32_16x16x32_bf16 v[80:83], v[112:115], v[124:127], v[80:83]
    ds_read_b64 v[112:113], v160 offset:2624
    ds_read_b64 v[114:115], v160 offset:2632
    v_mfma_f32_16x16x32_bf16 v[88:91], v[116:119], v[128:131], v[88:91]
    ds_read_b128 v[128:131], v161 offset:3136
    v_mfma_f32_16x16x32_bf16 v[84:87], v[116:119], v[124:127], v[84:87]
    ds_read_b64 v[116:117], v160 offset:3136
    ds_read_b64 v[118:119], v160 offset:3144
    s_waitcnt lgkmcnt(15)
    v_mfma_f32_16x16x32_bf16 v[88:91], v[120:123], v[124:127], v[88:91]
    ds_read_b128 v[124:127], v161 offset:3648
    ds_read_b64 v[120:121], v160 offset:3648
    ds_read_b64 v[122:123], v160 offset:3656
    v_mfma_f32_16x16x32_bf16 v[88:91], v[92:95], v[152:155], v[88:91]
    ds_read_b128 v[152:155], v161 offset:128
    v_mfma_f32_16x16x32_bf16 v[84:87], v[92:95], v[148:151], v[84:87]
    s_waitcnt lgkmcnt(15)
    v_mfma_f32_16x16x32_bf16 v[80:83], v[92:95], v[144:147], v[80:83]
    v_mfma_f32_16x16x32_bf16 v[76:79], v[92:95], v[140:143], v[76:79]
    s_waitcnt lgkmcnt(12)
    v_mfma_f32_16x16x32_bf16 v[72:75], v[92:95], v[136:139], v[72:75]
    s_waitcnt lgkmcnt(9)
    v_mfma_f32_16x16x32_bf16 v[68:71], v[92:95], v[132:135], v[68:71]
    s_waitcnt lgkmcnt(6)
    v_mfma_f32_16x16x32_bf16 v[64:67], v[92:95], v[128:131], v[64:67]
    s_waitcnt lgkmcnt(3)
    v_mfma_f32_16x16x32_bf16 v[60:63], v[92:95], v[124:127], v[60:63]
    ds_read_b64 v[92:93], v160 offset:128
    ds_read_b64 v[94:95], v160 offset:136
    v_mfma_f32_16x16x32_bf16 v[88:91], v[96:99], v[148:151], v[88:91]
    ds_read_b128 v[148:151], v161 offset:640
    v_mfma_f32_16x16x32_bf16 v[84:87], v[96:99], v[144:147], v[84:87]
    v_mfma_f32_16x16x32_bf16 v[80:83], v[96:99], v[140:143], v[80:83]
    v_mfma_f32_16x16x32_bf16 v[76:79], v[96:99], v[136:139], v[76:79]
    v_mfma_f32_16x16x32_bf16 v[72:75], v[96:99], v[132:135], v[72:75]
    v_mfma_f32_16x16x32_bf16 v[68:71], v[96:99], v[128:131], v[68:71]
    v_mfma_f32_16x16x32_bf16 v[64:67], v[96:99], v[124:127], v[64:67]
    ds_read_b64 v[96:97], v160 offset:640
    ds_read_b64 v[98:99], v160 offset:648
    v_mfma_f32_16x16x32_bf16 v[88:91], v[100:103], v[144:147], v[88:91]
    ds_read_b128 v[144:147], v161 offset:1152
    v_mfma_f32_16x16x32_bf16 v[84:87], v[100:103], v[140:143], v[84:87]
    v_mfma_f32_16x16x32_bf16 v[80:83], v[100:103], v[136:139], v[80:83]
    v_mfma_f32_16x16x32_bf16 v[76:79], v[100:103], v[132:135], v[76:79]
    v_mfma_f32_16x16x32_bf16 v[72:75], v[100:103], v[128:131], v[72:75]
    v_mfma_f32_16x16x32_bf16 v[68:71], v[100:103], v[124:127], v[68:71]
    ds_read_b64 v[100:101], v160 offset:1152
    ds_read_b64 v[102:103], v160 offset:1160
    v_mfma_f32_16x16x32_bf16 v[88:91], v[104:107], v[140:143], v[88:91]
    ds_read_b128 v[140:143], v161 offset:1664
    v_mfma_f32_16x16x32_bf16 v[84:87], v[104:107], v[136:139], v[84:87]
    v_mfma_f32_16x16x32_bf16 v[80:83], v[104:107], v[132:135], v[80:83]
    v_mfma_f32_16x16x32_bf16 v[76:79], v[104:107], v[128:131], v[76:79]
    v_mfma_f32_16x16x32_bf16 v[72:75], v[104:107], v[124:127], v[72:75]
    ds_read_b64 v[104:105], v160 offset:1664
    ds_read_b64 v[106:107], v160 offset:1672
    v_mfma_f32_16x16x32_bf16 v[88:91], v[108:111], v[136:139], v[88:91]
    ds_read_b128 v[136:139], v161 offset:2176
    v_mfma_f32_16x16x32_bf16 v[84:87], v[108:111], v[132:135], v[84:87]
    v_mfma_f32_16x16x32_bf16 v[80:83], v[108:111], v[128:131], v[80:83]
    v_mfma_f32_16x16x32_bf16 v[76:79], v[108:111], v[124:127], v[76:79]
    ds_read_b64 v[108:109], v160 offset:2176
    ds_read_b64 v[110:111], v160 offset:2184
    v_mfma_f32_16x16x32_bf16 v[88:91], v[112:115], v[132:135], v[88:91]
    ds_read_b128 v[132:135], v161 offset:2688
    v_mfma_f32_16x16x32_bf16 v[84:87], v[112:115], v[128:131], v[84:87]
    v_mfma_f32_16x16x32_bf16 v[80:83], v[112:115], v[124:127], v[80:83]
    ds_read_b64 v[112:113], v160 offset:2688
    ds_read_b64 v[114:115], v160 offset:2696
    v_mfma_f32_16x16x32_bf16 v[88:91], v[116:119], v[128:131], v[88:91]
    ds_read_b128 v[128:131], v161 offset:3200
    v_mfma_f32_16x16x32_bf16 v[84:87], v[116:119], v[124:127], v[84:87]
    ds_read_b64 v[116:117], v160 offset:3200
    ds_read_b64 v[118:119], v160 offset:3208
    s_waitcnt lgkmcnt(15)
    v_mfma_f32_16x16x32_bf16 v[88:91], v[120:123], v[124:127], v[88:91]
    ds_read_b128 v[124:127], v161 offset:3712
    ds_read_b64 v[120:121], v160 offset:3712
    ds_read_b64 v[122:123], v160 offset:3720
    v_mfma_f32_16x16x32_bf16 v[88:91], v[92:95], v[152:155], v[88:91]
    ds_read_b128 v[152:155], v161 offset:192
    v_mfma_f32_16x16x32_bf16 v[84:87], v[92:95], v[148:151], v[84:87]
    s_waitcnt lgkmcnt(15)
    v_mfma_f32_16x16x32_bf16 v[80:83], v[92:95], v[144:147], v[80:83]
    v_mfma_f32_16x16x32_bf16 v[76:79], v[92:95], v[140:143], v[76:79]
    s_waitcnt lgkmcnt(12)
    v_mfma_f32_16x16x32_bf16 v[72:75], v[92:95], v[136:139], v[72:75]
    s_waitcnt lgkmcnt(9)
    v_mfma_f32_16x16x32_bf16 v[68:71], v[92:95], v[132:135], v[68:71]
    s_waitcnt lgkmcnt(6)
    v_mfma_f32_16x16x32_bf16 v[64:67], v[92:95], v[128:131], v[64:67]
    s_waitcnt lgkmcnt(3)
    v_mfma_f32_16x16x32_bf16 v[60:63], v[92:95], v[124:127], v[60:63]
    ds_read_b64 v[92:93], v160 offset:192
    ds_read_b64 v[94:95], v160 offset:200
    v_mfma_f32_16x16x32_bf16 v[88:91], v[96:99], v[148:151], v[88:91]
    ds_read_b128 v[148:151], v161 offset:704
    v_mfma_f32_16x16x32_bf16 v[84:87], v[96:99], v[144:147], v[84:87]
    v_mfma_f32_16x16x32_bf16 v[80:83], v[96:99], v[140:143], v[80:83]
    v_mfma_f32_16x16x32_bf16 v[76:79], v[96:99], v[136:139], v[76:79]
    v_mfma_f32_16x16x32_bf16 v[72:75], v[96:99], v[132:135], v[72:75]
    v_mfma_f32_16x16x32_bf16 v[68:71], v[96:99], v[128:131], v[68:71]
    v_mfma_f32_16x16x32_bf16 v[64:67], v[96:99], v[124:127], v[64:67]
    ds_read_b64 v[96:97], v160 offset:704
    ds_read_b64 v[98:99], v160 offset:712
    v_mfma_f32_16x16x32_bf16 v[88:91], v[100:103], v[144:147], v[88:91]
    ds_read_b128 v[144:147], v161 offset:1216
    v_mfma_f32_16x16x32_bf16 v[84:87], v[100:103], v[140:143], v[84:87]
    v_mfma_f32_16x16x32_bf16 v[80:83], v[100:103], v[136:139], v[80:83]
    v_mfma_f32_16x16x32_bf16 v[76:79], v[100:103], v[132:135], v[76:79]
    v_mfma_f32_16x16x32_bf16 v[72:75], v[100:103], v[128:131], v[72:75]
    v_mfma_f32_16x16x32_bf16 v[68:71], v[100:103], v[124:127], v[68:71]
    ds_read_b64 v[100:101], v160 offset:1216
    ds_read_b64 v[102:103], v160 offset:1224
    v_mfma_f32_16x16x32_bf16 v[88:91], v[104:107], v[140:143], v[88:91]
    ds_read_b128 v[140:143], v161 offset:1728
    v_mfma_f32_16x16x32_bf16 v[84:87], v[104:107], v[136:139], v[84:87]
    v_mfma_f32_16x16x32_bf16 v[80:83], v[104:107], v[132:135], v[80:83]
    v_mfma_f32_16x16x32_bf16 v[76:79], v[104:107], v[128:131], v[76:79]
    v_mfma_f32_16x16x32_bf16 v[72:75], v[104:107], v[124:127], v[72:75]
    ds_read_b64 v[104:105], v160 offset:1728
    ds_read_b64 v[106:107], v160 offset:1736
    v_mfma_f32_16x16x32_bf16 v[88:91], v[108:111], v[136:139], v[88:91]
    ds_read_b128 v[136:139], v161 offset:2240
    v_mfma_f32_16x16x32_bf16 v[84:87], v[108:111], v[132:135], v[84:87]
    v_mfma_f32_16x16x32_bf16 v[80:83], v[108:111], v[128:131], v[80:83]
    v_mfma_f32_16x16x32_bf16 v[76:79], v[108:111], v[124:127], v[76:79]
    ds_read_b64 v[108:109], v160 offset:2240
    ds_read_b64 v[110:111], v160 offset:2248
    v_mfma_f32_16x16x32_bf16 v[88:91], v[112:115], v[132:135], v[88:91]
    ds_read_b128 v[132:135], v161 offset:2752
    v_mfma_f32_16x16x32_bf16 v[84:87], v[112:115], v[128:131], v[84:87]
    v_mfma_f32_16x16x32_bf16 v[80:83], v[112:115], v[124:127], v[80:83]
    ds_read_b64 v[112:113], v160 offset:2752
    ds_read_b64 v[114:115], v160 offset:2760
    v_mfma_f32_16x16x32_bf16 v[88:91], v[116:119], v[128:131], v[88:91]
    ds_read_b128 v[128:131], v161 offset:3264
    v_mfma_f32_16x16x32_bf16 v[84:87], v[116:119], v[124:127], v[84:87]
    ds_read_b64 v[116:117], v160 offset:3264
    ds_read_b64 v[118:119], v160 offset:3272
    s_waitcnt lgkmcnt(15)
    v_mfma_f32_16x16x32_bf16 v[88:91], v[120:123], v[124:127], v[88:91]
    ds_read_b128 v[124:127], v161 offset:3776
    ds_read_b64 v[120:121], v160 offset:3776
    ds_read_b64 v[122:123], v160 offset:3784
    v_mfma_f32_16x16x32_bf16 v[88:91], v[92:95], v[152:155], v[88:91]
    v_mfma_f32_16x16x32_bf16 v[84:87], v[92:95], v[148:151], v[84:87]
    s_waitcnt lgkmcnt(15)
    v_mfma_f32_16x16x32_bf16 v[80:83], v[92:95], v[144:147], v[80:83]
    s_waitcnt lgkmcnt(14)
    v_mfma_f32_16x16x32_bf16 v[76:79], v[92:95], v[140:143], v[76:79]
    s_waitcnt lgkmcnt(11)
    v_mfma_f32_16x16x32_bf16 v[72:75], v[92:95], v[136:139], v[72:75]
    s_waitcnt lgkmcnt(8)
    v_mfma_f32_16x16x32_bf16 v[68:71], v[92:95], v[132:135], v[68:71]
    s_waitcnt lgkmcnt(5)
    v_mfma_f32_16x16x32_bf16 v[64:67], v[92:95], v[128:131], v[64:67]
    s_waitcnt lgkmcnt(2)
    v_mfma_f32_16x16x32_bf16 v[60:63], v[92:95], v[124:127], v[60:63]
    v_mfma_f32_16x16x32_bf16 v[88:91], v[96:99], v[148:151], v[88:91]
    v_mfma_f32_16x16x32_bf16 v[84:87], v[96:99], v[144:147], v[84:87]
    v_mfma_f32_16x16x32_bf16 v[80:83], v[96:99], v[140:143], v[80:83]
    v_mfma_f32_16x16x32_bf16 v[76:79], v[96:99], v[136:139], v[76:79]
    v_mfma_f32_16x16x32_bf16 v[72:75], v[96:99], v[132:135], v[72:75]
    v_mfma_f32_16x16x32_bf16 v[68:71], v[96:99], v[128:131], v[68:71]
    v_mfma_f32_16x16x32_bf16 v[64:67], v[96:99], v[124:127], v[64:67]
    v_mfma_f32_16x16x32_bf16 v[88:91], v[100:103], v[144:147], v[88:91]
    v_mfma_f32_16x16x32_bf16 v[84:87], v[100:103], v[140:143], v[84:87]
    v_mfma_f32_16x16x32_bf16 v[80:83], v[100:103], v[136:139], v[80:83]
    v_mfma_f32_16x16x32_bf16 v[76:79], v[100:103], v[132:135], v[76:79]
    v_mfma_f32_16x16x32_bf16 v[72:75], v[100:103], v[128:131], v[72:75]
    v_mfma_f32_16x16x32_bf16 v[68:71], v[100:103], v[124:127], v[68:71]
    v_mfma_f32_16x16x32_bf16 v[88:91], v[104:107], v[140:143], v[88:91]
    v_mfma_f32_16x16x32_bf16 v[84:87], v[104:107], v[136:139], v[84:87]
    v_mfma_f32_16x16x32_bf16 v[80:83], v[104:107], v[132:135], v[80:83]
    v_mfma_f32_16x16x32_bf16 v[76:79], v[104:107], v[128:131], v[76:79]
    v_mfma_f32_16x16x32_bf16 v[72:75], v[104:107], v[124:127], v[72:75]
    v_mfma_f32_16x16x32_bf16 v[88:91], v[108:111], v[136:139], v[88:91]
    v_mfma_f32_16x16x32_bf16 v[84:87], v[108:111], v[132:135], v[84:87]
    v_mfma_f32_16x16x32_bf16 v[80:83], v[108:111], v[128:131], v[80:83]
    v_mfma_f32_16x16x32_bf16 v[76:79], v[108:111], v[124:127], v[76:79]
    v_mfma_f32_16x16x32_bf16 v[88:91], v[112:115], v[132:135], v[88:91]
    v_mfma_f32_16x16x32_bf16 v[84:87], v[112:115], v[128:131], v[84:87]
    v_mfma_f32_16x16x32_bf16 v[80:83], v[112:115], v[124:127], v[80:83]
    v_mfma_f32_16x16x32_bf16 v[88:91], v[116:119], v[128:131], v[88:91]
    v_mfma_f32_16x16x32_bf16 v[84:87], v[116:119], v[124:127], v[84:87]
    s_waitcnt lgkmcnt(0)
    v_mfma_f32_16x16x32_bf16 v[88:91], v[120:123], v[124:127], v[88:91]
    s_waitcnt lgkmcnt(0)
    s_lshl_b32 s68, s3, 2
    v_mov_b32 v26, 160320
    v_add_u32 v26, s68, v26
    s_add_u32 s69, s94, 3
    s_mov_b64 exec, 1
    v_mov_b32 v27, s69
    ds_write_b32 v26, v27 offset:0
    s_mov_b64 exec, -1
    v_xor_b32 v26, 4, v26
gated_mix__ssm_conv_s5__ssm_conv_s4__prompt_kernel_sp90:
    ds_read_b32 v27, v26 offset:0
    s_waitcnt lgkmcnt(0)
    s_nop 0
    v_readfirstlane_b32 s68, v27
    s_nop 1
    s_cmp_ge_u32 s68, s69
    s_cbranch_scc1 gated_mix__ssm_conv_s5__ssm_conv_s4__prompt_kernel_spd91
    s_cmp_eq_u32 s98, 0
    s_cbranch_scc1 gated_mix__ssm_conv_s5__ssm_conv_s4__prompt_kernel_spd91
    s_sub_u32 s98, s98, 1
    s_sleep 0
    s_branch gated_mix__ssm_conv_s5__ssm_conv_s4__prompt_kernel_sp90
gated_mix__ssm_conv_s5__ssm_conv_s4__prompt_kernel_spd91:
    v_lshl_add_u32 v162, v1, 4, s62
    s_xor_b32 s68, s3, 1
    s_mul_i32 s68, s68, 6784
    v_lshl_add_u32 v163, v1, 4, s68
    s_cmp_eq_u32 s7, 1
    s_cbranch_scc1 gated_mix__ssm_conv_s5__ssm_conv_s4__prompt_kernel_s192
    ds_write_b128 v162, v[76:79] offset:0
    ds_write_b128 v162, v[80:83] offset:1024
    ds_write_b128 v162, v[84:87] offset:2048
    ds_write_b128 v162, v[88:91] offset:3072
    s_branch gated_mix__ssm_conv_s5__ssm_conv_s4__prompt_kernel_se93
gated_mix__ssm_conv_s5__ssm_conv_s4__prompt_kernel_s192:
    ds_write_b128 v162, v[60:63] offset:0
    ds_write_b128 v162, v[64:67] offset:1024
    ds_write_b128 v162, v[68:71] offset:2048
    ds_write_b128 v162, v[72:75] offset:3072
    v_mov_b32 v60, v76
    v_mov_b32 v61, v77
    v_mov_b32 v62, v78
    v_mov_b32 v63, v79
    v_mov_b32 v64, v80
    v_mov_b32 v65, v81
    v_mov_b32 v66, v82
    v_mov_b32 v67, v83
    v_mov_b32 v68, v84
    v_mov_b32 v69, v85
    v_mov_b32 v70, v86
    v_mov_b32 v71, v87
    v_mov_b32 v72, v88
    v_mov_b32 v73, v89
    v_mov_b32 v74, v90
    v_mov_b32 v75, v91
gated_mix__ssm_conv_s5__ssm_conv_s4__prompt_kernel_se93:
    s_waitcnt lgkmcnt(0)
    v_xor_b32 v26, 4, v26
    s_add_u32 s69, s94, 4
    s_mov_b64 exec, 1
    v_mov_b32 v27, s69
    ds_write_b32 v26, v27 offset:0
    s_mov_b64 exec, -1
    v_xor_b32 v26, 4, v26
gated_mix__ssm_conv_s5__ssm_conv_s4__prompt_kernel_sp94:
    ds_read_b32 v27, v26 offset:0
    s_waitcnt lgkmcnt(0)
    s_nop 0
    v_readfirstlane_b32 s68, v27
    s_nop 1
    s_cmp_ge_u32 s68, s69
    s_cbranch_scc1 gated_mix__ssm_conv_s5__ssm_conv_s4__prompt_kernel_spd95
    s_cmp_eq_u32 s98, 0
    s_cbranch_scc1 gated_mix__ssm_conv_s5__ssm_conv_s4__prompt_kernel_spd95
    s_sub_u32 s98, s98, 1
    s_sleep 0
    s_branch gated_mix__ssm_conv_s5__ssm_conv_s4__prompt_kernel_sp94
gated_mix__ssm_conv_s5__ssm_conv_s4__prompt_kernel_spd95:
    ds_read_b128 v[124:127], v163 offset:0
    ds_read_b128 v[128:131], v163 offset:1024
    ds_read_b128 v[132:135], v163 offset:2048
    ds_read_b128 v[136:139], v163 offset:3072
    v_lshrrev_b32 v162, 1, v2
    v_lshlrev_b32 v162, 6, v162
    v_lshl_add_u32 v162, v3, 4, v162
    s_lshl_b32 s68, s5, 12
    s_lshl_b32 s69, s7, 11
    s_add_u32 s68, s68, s69
    s_add_u32 s68, s68, 7340032
    s_waitcnt lgkmcnt(0)
    v_add_f32 v60, v60, v124
    v_add_f32 v61, v61, v125
    v_add_f32 v62, v62, v126
    v_add_f32 v63, v63, v127
    v_add_f32 v64, v64, v128
    v_add_f32 v65, v65, v129
    v_add_f32 v66, v66, v130
    v_add_f32 v67, v67, v131
    v_add_f32 v68, v68, v132
    v_add_f32 v69, v69, v133
    v_add_f32 v70, v70, v134
    v_add_f32 v71, v71, v135
    v_add_f32 v72, v72, v136
    v_add_f32 v73, v73, v137
    v_add_f32 v74, v74, v138
    v_add_f32 v75, v75, v139
    s_nop 1
    v_mov_b32_dpp v156, v60 quad_perm:[1,0,3,2] row_mask:0xf bank_mask:0xf
    v_mov_b32_dpp v157, v61 quad_perm:[1,0,3,2] row_mask:0xf bank_mask:0xf
    v_mov_b32_dpp v158, v62 quad_perm:[1,0,3,2] row_mask:0xf bank_mask:0xf
    v_mov_b32_dpp v159, v63 quad_perm:[1,0,3,2] row_mask:0xf bank_mask:0xf
    v_cvt_pk_bf16_f32 v92, v60, v156
    v_cvt_pk_bf16_f32 v93, v61, v157
    v_cvt_pk_bf16_f32 v94, v62, v158
    v_cvt_pk_bf16_f32 v95, v63, v159
    s_nop 1
    v_mov_b32_dpp v156, v64 quad_perm:[1,0,3,2] row_mask:0xf bank_mask:0xf
    v_mov_b32_dpp v157, v65 quad_perm:[1,0,3,2] row_mask:0xf bank_mask:0xf
    v_mov_b32_dpp v158, v66 quad_perm:[1,0,3,2] row_mask:0xf bank_mask:0xf
    v_mov_b32_dpp v159, v67 quad_perm:[1,0,3,2] row_mask:0xf bank_mask:0xf
    v_cvt_pk_bf16_f32 v96, v64, v156
    v_cvt_pk_bf16_f32 v97, v65, v157
    v_cvt_pk_bf16_f32 v98, v66, v158
    v_cvt_pk_bf16_f32 v99, v67, v159
    s_nop 1
    v_mov_b32_dpp v156, v68 quad_perm:[1,0,3,2] row_mask:0xf bank_mask:0xf
    v_mov_b32_dpp v157, v69 quad_perm:[1,0,3,2] row_mask:0xf bank_mask:0xf
    v_mov_b32_dpp v158, v70 quad_perm:[1,0,3,2] row_mask:0xf bank_mask:0xf
    v_mov_b32_dpp v159, v71 quad_perm:[1,0,3,2] row_mask:0xf bank_mask:0xf
    v_cvt_pk_bf16_f32 v100, v68, v156
    v_cvt_pk_bf16_f32 v101, v69, v157
    v_cvt_pk_bf16_f32 v102, v70, v158
    v_cvt_pk_bf16_f32 v103, v71, v159
    s_nop 1
    v_mov_b32_dpp v156, v72 quad_perm:[1,0,3,2] row_mask:0xf bank_mask:0xf
    v_mov_b32_dpp v157, v73 quad_perm:[1,0,3,2] row_mask:0xf bank_mask:0xf
    v_mov_b32_dpp v158, v74 quad_perm:[1,0,3,2] row_mask:0xf bank_mask:0xf
    v_mov_b32_dpp v159, v75 quad_perm:[1,0,3,2] row_mask:0xf bank_mask:0xf
    v_cvt_pk_bf16_f32 v104, v72, v156
    v_cvt_pk_bf16_f32 v105, v73, v157
    v_cvt_pk_bf16_f32 v106, v74, v158
    v_cvt_pk_bf16_f32 v107, v75, v159
    v_and_b32 v163, 1, v2
    v_cmp_eq_u32 vcc, 0, v163
    s_and_saveexec_b64 s[70:71], vcc
    buffer_store_dwordx4 v[92:95], v162, s[56:59], s68 offen offset:0 sc1
    buffer_store_dwordx4 v[96:99], v162, s[56:59], s68 offen offset:512 sc1
    buffer_store_dwordx4 v[100:103], v162, s[56:59], s68 offen offset:1024 sc1
    buffer_store_dwordx4 v[104:107], v162, s[56:59], s68 offen offset:1536 sc1
    s_mov_b64 exec, s[70:71]
    s_waitcnt vmcnt(0)
    s_lshl_b32 s68, s5, 3
    s_lshl_b32 s69, s7, 2
    s_add_u32 s68, s68, s69
    s_add_u32 s68, s68, 10817536
    v_mov_b32 v162, 0
    v_mov_b32 v163, s93
    s_mov_b64 exec, 1
    buffer_store_dword v163, v162, s[56:59], s68 offen sc1
    s_mov_b64 exec, -1
    s_branch gated_mix__ssm_conv_s5__ssm_conv_s4__prompt_kernel_p2
gated_mix__ssm_conv_s5__ssm_conv_s4__prompt_kernel_nb74:
    s_load_dwordx2 s[72:73], s[0:1], 0
    s_load_dwordx4 s[76:79], s[0:1], 24
    s_load_dwordx4 s[84:87], s[0:1], 40
    v_mul_u32_u24 v2, 1280, v1
    s_sub_u32 s3, s2, 240
    s_lshr_b32 s3, s3, 3
    s_mul_i32 s3, s3, 12
    s_add_u32 s3, s3, s4
    s_waitcnt lgkmcnt(0)
    s_add_u32 s68, s3, 0
    s_cmp_ge_u32 s68, 36
    s_cbranch_scc1 gated_mix__ssm_conv_s5__ssm_conv_s4__prompt_kernel_pfi96
    s_mul_i32 s69, s68, 3641
    s_lshr_b32 s69, s69, 16
    s_mul_i32 s70, s69, 18
    s_sub_u32 s70, s68, s70
    s_add_u32 s69, s69, 4
    s_lshl_b32 s69, s69, 7
    s_and_b32 s71, s2, 7
    s_cmp_lt_u32 s70, 8
    s_cselect_b32 s88, s72, s76
    s_cselect_b32 s89, s73, s77
    s_cmp_ge_u32 s70, 13
    s_cselect_b32 s88, s78, s88
    s_cselect_b32 s89, s79, s89
    s_mov_b32 s90, 819200
    s_cmp_lt_u32 s70, 8
    s_cselect_b32 s90, 2621440, s90
    s_mov_b32 s91, 0x20000
    s_lshr_b32 s92, s71, 1
    s_lshl_b32 s92, s92, 9
    s_lshl_b32 s68, s70, 6
    s_add_u32 s92, s92, s68
    s_and_b32 s71, s71, 1
    s_mul_i32 s71, s71, 320
    s_cmp_ge_u32 s70, 13
    s_cselect_b32 s68, 13, 8
    s_sub_u32 s68, s70, s68
    s_lshl_b32 s68, s68, 6
    s_add_u32 s71, s71, s68
    s_cmp_lt_u32 s70, 8
    s_cselect_b32 s92, s92, s71
    s_mul_i32 s92, s92, 1280
    s_add_u32 s92, s92, s69
    buffer_load_dword v3, v2, s[88:91], s92 offen
gated_mix__ssm_conv_s5__ssm_conv_s4__prompt_kernel_pfi96:
    s_add_u32 s68, s3, 24
    s_cmp_ge_u32 s68, 36
    s_cbranch_scc1 gated_mix__ssm_conv_s5__ssm_conv_s4__prompt_kernel_pfi97
    s_mul_i32 s69, s68, 3641
    s_lshr_b32 s69, s69, 16
    s_mul_i32 s70, s69, 18
    s_sub_u32 s70, s68, s70
    s_add_u32 s69, s69, 4
    s_lshl_b32 s69, s69, 7
    s_and_b32 s71, s2, 7
    s_cmp_lt_u32 s70, 8
    s_cselect_b32 s88, s72, s76
    s_cselect_b32 s89, s73, s77
    s_cmp_ge_u32 s70, 13
    s_cselect_b32 s88, s78, s88
    s_cselect_b32 s89, s79, s89
    s_mov_b32 s90, 819200
    s_cmp_lt_u32 s70, 8
    s_cselect_b32 s90, 2621440, s90
    s_mov_b32 s91, 0x20000
    s_lshr_b32 s92, s71, 1
    s_lshl_b32 s92, s92, 9
    s_lshl_b32 s68, s70, 6
    s_add_u32 s92, s92, s68
    s_and_b32 s71, s71, 1
    s_mul_i32 s71, s71, 320
    s_cmp_ge_u32 s70, 13
    s_cselect_b32 s68, 13, 8
    s_sub_u32 s68, s70, s68
    s_lshl_b32 s68, s68, 6
    s_add_u32 s71, s71, s68
    s_cmp_lt_u32 s70, 8
    s_cselect_b32 s92, s92, s71
    s_mul_i32 s92, s92, 1280
    s_add_u32 s92, s92, s69
    buffer_load_dword v3, v2, s[88:91], s92 offen
gated_mix__ssm_conv_s5__ssm_conv_s4__prompt_kernel_pfi97:
    s_sub_u32 s68, s2, 240
    s_mul_i32 s68, s68, 12
    s_add_u32 s68, s68, s4
    s_mul_i32 s70, s68, 4352
    v_lshlrev_b32 v2, 7, v1
    s_bfm_b64 exec, 34, 0
    s_mov_b32 s88, s84
    s_mov_b32 s89, s85
    s_mov_b32 s90, 819200
    s_mov_b32 s91, 0x20000
    buffer_load_dword v3, v2, s[88:91], s70 offen
    s_mov_b32 s88, s86
    s_mov_b32 s89, s87
    s_mov_b32 s90, 819200
    s_mov_b32 s91, 0x20000
    buffer_load_dword v3, v2, s[88:91], s70 offen
    s_mov_b64 exec, -1
    s_branch gated_mix__ssm_conv_s5__ssm_conv_s4__prompt_kernel_p2
gated_mix__ssm_conv_s5__ssm_conv_s4__prompt_kernel_pw5:
    s_sub_u32 s68, s2, 160
    s_lshl_b32 s97, s68, 2
    s_sub_u32 s69, s4, 8
    s_add_u32 s97, s97, s69
    s_cmp_ge_u32 s97, 320
    s_cbranch_scc1 gated_mix__ssm_conv_s5__ssm_conv_s4__prompt_kernel_nt98
    s_mov_b32 s5, s97
    s_lshl_b32 s3, s69, 13
    s_add_u32 s3, s3, 92160
    s_setprio 3
    s_load_dwordx2 s[8:9], s[0:1], 0
    s_load_dwordx4 s[28:31], s[0:1], 160
    s_mul_i32 s6, s5, 6554
    s_lshr_b32 s6, s6, 16
    s_mul_i32 s7, s6, 10
    s_sub_u32 s7, s5, s7
    v_lshrrev_b32 v36, 3, v1
    v_and_b32 v37, 7, v1
    v_mul_u32_u24 v38, 1280, v36
    v_lshl_add_u32 v38, v37, 4, v38
    s_lshl_b32 s10, s6, 6
    s_mul_i32 s10, s10, 1280
    s_lshl_b32 s11, s7, 7
    s_add_u32 s12, s10, s11
    v_and_b32 v39, 3, v1
    v_lshrrev_b32 v40, 2, v1
    v_and_b32 v40, 3, v40
    v_sub_u32 v40, 3, v40
    v_lshlrev_b32 v40, 7, v40
    v_lshl_add_u32 v40, v39, 3, v40
    v_lshrrev_b32 v39, 4, v1
    v_lshl_add_u32 v40, v39, 5, v40
    v_add_u32 v40, s3, v40
    s_waitcnt lgkmcnt(0)
    s_mov_b32 s32, s8
    s_mov_b32 s33, s9
    s_mov_b32 s34, 2621440
    s_mov_b32 s35, 0x20000
    s_mov_b32 s44, s30
    s_mov_b32 s45, s31
    s_mov_b32 s46, 14680064
    s_mov_b32 s47, 0x20000
    s_mov_b32 s48, s28
    s_mov_b32 s49, s29
    s_mov_b32 s50, 256
    s_mov_b32 s51, 0x20000
    s_add_u32 m0, s3, 0
    s_add_u32 s13, s12, 0
    buffer_load_dwordx4 v38, s[32:35], s13 offen lds
    s_add_u32 m0, s3, 1024
    s_add_u32 s13, s12, 10240
    buffer_load_dwordx4 v38, s[32:35], s13 offen lds
    s_add_u32 m0, s3, 2048
    s_add_u32 s13, s12, 20480
    buffer_load_dwordx4 v38, s[32:35], s13 offen lds
    s_add_u32 m0, s3, 3072
    s_add_u32 s13, s12, 30720
    buffer_load_dwordx4 v38, s[32:35], s13 offen lds
    s_add_u32 m0, s3, 4096
    s_add_u32 s13, s12, 40960
    buffer_load_dwordx4 v38, s[32:35], s13 offen lds
    s_add_u32 m0, s3, 5120
    s_add_u32 s13, s12, 51200
    buffer_load_dwordx4 v38, s[32:35], s13 offen lds
    s_add_u32 m0, s3, 6144
    s_add_u32 s13, s12, 61440
    buffer_load_dwordx4 v38, s[32:35], s13 offen lds
    s_add_u32 m0, s3, 7168
    s_add_u32 s13, s12, 71680
    buffer_load_dwordx4 v38, s[32:35], s13 offen lds
    v_mov_b32 v43, 0
    v_and_b32 v41, 7, v1
    v_lshlrev_b32 v42, 7, v1
    v_add_u32 v42, s3, v42
    s_waitcnt vmcnt(0)
    buffer_load_dword v44, v43, s[48:51], 0 offen sc1
    ds_read_b64_tr_b16 v[4:5], v40 offset:7680
    ds_read_b64_tr_b16 v[6:7], v40 offset:7168
    ds_read_b64_tr_b16 v[8:9], v40 offset:6656
    ds_read_b64_tr_b16 v[10:11], v40 offset:6144
    ds_read_b64_tr_b16 v[12:13], v40 offset:5632
    ds_read_b64_tr_b16 v[14:15], v40 offset:5120
    ds_read_b64_tr_b16 v[16:17], v40 offset:4608
    ds_read_b64_tr_b16 v[18:19], v40 offset:4096
    ds_read_b64_tr_b16 v[20:21], v40 offset:3584
    ds_read_b64_tr_b16 v[22:23], v40 offset:3072
    ds_read_b64_tr_b16 v[24:25], v40 offset:2560
    ds_read_b64_tr_b16 v[26:27], v40 offset:2048
    ds_read_b64_tr_b16 v[28:29], v40 offset:1536
    ds_read_b64_tr_b16 v[30:31], v40 offset:1024
    ds_read_b64_tr_b16 v[32:33], v40 offset:512
    ds_read_b64_tr_b16 v[34:35], v40 offset:0
    v_xor_b32 v39, 0, v41
    v_lshl_add_u32 v37, v39, 4, v42
    s_waitcnt lgkmcnt(0)
    ds_write_b128 v37, v[4:7]
    v_xor_b32 v39, 1, v41
    v_lshl_add_u32 v36, v39, 4, v42
    ds_write_b128 v36, v[8:11]
    v_xor_b32 v39, 2, v41
    v_lshl_add_u32 v37, v39, 4, v42
    ds_write_b128 v37, v[12:15]
    v_xor_b32 v39, 3, v41
    v_lshl_add_u32 v36, v39, 4, v42
    ds_write_b128 v36, v[16:19]
    v_xor_b32 v39, 4, v41
    v_lshl_add_u32 v37, v39, 4, v42
    ds_write_b128 v37, v[20:23]
    v_xor_b32 v39, 5, v41
    v_lshl_add_u32 v36, v39, 4, v42
    ds_write_b128 v36, v[24:27]
    v_xor_b32 v39, 6, v41
    v_lshl_add_u32 v37, v39, 4, v42
    ds_write_b128 v37, v[28:31]
    v_xor_b32 v39, 7, v41
    v_lshl_add_u32 v36, v39, 4, v42
    ds_write_b128 v36, v[32:35]
    v_lshrrev_b32 v36, 3, v1
    v_and_b32 v37, 7, v1
    v_xor_b32 v38, v36, v37
    v_lshlrev_b32 v38, 4, v38
    v_lshl_add_u32 v38, v36, 7, v38
    v_add_u32 v38, s3, v38
    v_lshlrev_b32 v39, 12, v36
    v_lshl_add_u32 v39, v37, 4, v39
    s_lshl_b32 s10, s7, 18
    s_sub_u32 s11, 31, s6
    s_lshl_b32 s11, s11, 7
    s_add_u32 s10, s10, s11
    s_add_u32 s10, s10, 11534336
    s_waitcnt lgkmcnt(0)
    ds_read_b128 v[4:7], v38 offset:0
    ds_read_b128 v[8:11], v38 offset:1024
    ds_read_b128 v[12:15], v38 offset:2048
    ds_read_b128 v[16:19], v38 offset:3072
    ds_read_b128 v[20:23], v38 offset:4096
    ds_read_b128 v[24:27], v38 offset:5120
    ds_read_b128 v[28:31], v38 offset:6144
    ds_read_b128 v[32:35], v38 offset:7168
    s_waitcnt lgkmcnt(7)
    s_add_u32 s13, s10, 0
    buffer_store_dwordx4 v[4:7], v39, s[44:47], s13 offen sc1
    s_waitcnt lgkmcnt(6)
    s_add_u32 s13, s10, 32768
    buffer_store_dwordx4 v[8:11], v39, s[44:47], s13 offen sc1
    s_waitcnt lgkmcnt(5)
    s_add_u32 s13, s10, 65536
    buffer_store_dwordx4 v[12:15], v39, s[44:47], s13 offen sc1
    s_waitcnt lgkmcnt(4)
    s_add_u32 s13, s10, 98304
    buffer_store_dwordx4 v[16:19], v39, s[44:47], s13 offen sc1
    s_waitcnt lgkmcnt(3)
    s_add_u32 s13, s10, 131072
    buffer_store_dwordx4 v[20:23], v39, s[44:47], s13 offen sc1
    s_waitcnt lgkmcnt(2)
    s_add_u32 s13, s10, 163840
    buffer_store_dwordx4 v[24:27], v39, s[44:47], s13 offen sc1
    s_waitcnt lgkmcnt(1)
    s_add_u32 s13, s10, 196608
    buffer_store_dwordx4 v[28:31], v39, s[44:47], s13 offen sc1
    s_waitcnt lgkmcnt(0)
    s_add_u32 s13, s10, 229376
    buffer_store_dwordx4 v[32:35], v39, s[44:47], s13 offen sc1
    s_load_dwordx2 s[72:73], s[0:1], 0
    s_load_dwordx4 s[76:79], s[0:1], 24
    v_mul_u32_u24 v150, 1280, v1
    s_sub_u32 s95, s2, 160
    s_lshr_b32 s95, s95, 3
    s_lshl_b32 s95, s95, 2
    s_add_u32 s95, s95, s4
    s_sub_u32 s95, s95, 8
    s_waitcnt lgkmcnt(0)
    s_add_u32 s68, s95, 0
    s_cmp_ge_u32 s68, 80
    s_cbranch_scc1 gated_mix__ssm_conv_s5__ssm_conv_s4__prompt_kernel_pfi99
    s_mul_i32 s69, s68, 3641
    s_lshr_b32 s69, s69, 16
    s_mul_i32 s70, s69, 18
    s_sub_u32 s70, s68, s70
    s_add_u32 s69, s69, 6
    s_lshl_b32 s69, s69, 7
    s_and_b32 s71, s2, 7
    s_cmp_lt_u32 s70, 8
    s_cselect_b32 s88, s72, s76
    s_cselect_b32 s89, s73, s77
    s_cmp_ge_u32 s70, 13
    s_cselect_b32 s88, s78, s88
    s_cselect_b32 s89, s79, s89
    s_mov_b32 s90, 819200
    s_cmp_lt_u32 s70, 8
    s_cselect_b32 s90, 2621440, s90
    s_mov_b32 s91, 0x20000
    s_lshr_b32 s92, s71, 1
    s_lshl_b32 s92, s92, 9
    s_lshl_b32 s68, s70, 6
    s_add_u32 s92, s92, s68
    s_and_b32 s71, s71, 1
    s_mul_i32 s71, s71, 320
    s_cmp_ge_u32 s70, 13
    s_cselect_b32 s68, 13, 8
    s_sub_u32 s68, s70, s68
    s_lshl_b32 s68, s68, 6
    s_add_u32 s71, s71, s68
    s_cmp_lt_u32 s70, 8
    s_cselect_b32 s92, s92, s71
    s_mul_i32 s92, s92, 1280
    s_add_u32 s92, s92, s69
    buffer_load_dword v151, v150, s[88:91], s92 offen
gated_mix__ssm_conv_s5__ssm_conv_s4__prompt_kernel_pfi99:
    s_add_u32 s68, s95, 40
    s_cmp_ge_u32 s68, 80
    s_cbranch_scc1 gated_mix__ssm_conv_s5__ssm_conv_s4__prompt_kernel_pfi100
    s_mul_i32 s69, s68, 3641
    s_lshr_b32 s69, s69, 16
    s_mul_i32 s70, s69, 18
    s_sub_u32 s70, s68, s70
    s_add_u32 s69, s69, 6
    s_lshl_b32 s69, s69, 7
    s_and_b32 s71, s2, 7
    s_cmp_lt_u32 s70, 8
    s_cselect_b32 s88, s72, s76
    s_cselect_b32 s89, s73, s77
    s_cmp_ge_u32 s70, 13
    s_cselect_b32 s88, s78, s88
    s_cselect_b32 s89, s79, s89
    s_mov_b32 s90, 819200
    s_cmp_lt_u32 s70, 8
    s_cselect_b32 s90, 2621440, s90
    s_mov_b32 s91, 0x20000
    s_lshr_b32 s92, s71, 1
    s_lshl_b32 s92, s92, 9
    s_lshl_b32 s68, s70, 6
    s_add_u32 s92, s92, s68
    s_and_b32 s71, s71, 1
    s_mul_i32 s71, s71, 320
    s_cmp_ge_u32 s70, 13
    s_cselect_b32 s68, 13, 8
    s_sub_u32 s68, s70, s68
    s_lshl_b32 s68, s68, 6
    s_add_u32 s71, s71, s68
    s_cmp_lt_u32 s70, 8
    s_cselect_b32 s92, s92, s71
    s_mul_i32 s92, s92, 1280
    s_add_u32 s92, s92, s69
    buffer_load_dword v151, v150, s[88:91], s92 offen
gated_mix__ssm_conv_s5__ssm_conv_s4__prompt_kernel_pfi100:
    s_waitcnt vmcnt(2)
    s_mov_b32 s18, 0x100000
gated_mix__ssm_conv_s5__ssm_conv_s4__prompt_kernel_tnp101:
    v_readfirstlane_b32 s14, v44
    s_nop 1
    s_cmp_lg_u32 s14, 0
    s_cbranch_scc1 gated_mix__ssm_conv_s5__ssm_conv_s4__prompt_kernel_tng102
    s_sleep 4
    buffer_load_dword v44, v43, s[48:51], 0 offen sc1
    s_waitcnt vmcnt(0)
    s_sub_u32 s18, s18, 1
    s_cmp_lg_u32 s18, 0
    s_cbranch_scc1 gated_mix__ssm_conv_s5__ssm_conv_s4__prompt_kernel_tnp101
gated_mix__ssm_conv_s5__ssm_conv_s4__prompt_kernel_tng102:
    s_mov_b32 s96, s14
    s_lshl_b32 s10, s7, 9
    s_lshr_b32 s11, s6, 3
    s_lshl_b32 s11, s11, 7
    s_add_u32 s10, s10, s11
    s_and_b32 s11, s6, 7
    s_lshl_b32 s11, s11, 2
    s_add_u32 s10, s10, s11
    s_add_u32 s10, s10, 10747904
    v_mov_b32 v44, s14
    s_mov_b64 exec, 1
    buffer_store_dword v44, v43, s[44:47], s10 offen sc1
    s_mov_b64 exec, -1
gated_mix__ssm_conv_s5__ssm_conv_s4__prompt_kernel_nt98:
    s_cmp_ge_u32 s97, 256
    s_cbranch_scc1 gated_mix__ssm_conv_s5__ssm_conv_s4__prompt_kernel_p2
    s_lshl_b32 s5, s97, 3
    s_load_dwordx2 s[8:9], s[0:1], 0
    s_load_dwordx2 s[24:25], s[0:1], 144
    s_load_dwordx2 s[30:31], s[0:1], 168
    v_lshlrev_b32 v3, 2, v1
    s_mul_i32 s13, s5, 1280
    s_load_dwordx2 s[28:29], s[0:1], 160
    s_waitcnt lgkmcnt(0)
    s_mov_b32 s32, s8
    s_mov_b32 s33, s9
    s_mov_b32 s34, 2621440
    s_mov_b32 s35, 0x20000
    s_mov_b32 s64, s24
    s_mov_b32 s65, s25
    s_mov_b32 s66, 1280
    s_mov_b32 s67, 0x20000
    s_mov_b32 s44, s30
    s_mov_b32 s45, s31
    s_mov_b32 s46, 14680064
    s_mov_b32 s47, 0x20000
    s_mov_b32 s48, s28
    s_mov_b32 s49, s29
    s_mov_b32 s50, 256
    s_mov_b32 s51, 0x20000
    buffer_load_dword v6, v3, s[64:67], 0 offen offset:0
    buffer_load_dword v7, v3, s[64:67], 0 offen offset:256
    buffer_load_dword v8, v3, s[64:67], 0 offen offset:512
    buffer_load_dword v9, v3, s[64:67], 0 offen offset:768
    buffer_load_dword v10, v3, s[64:67], 0 offen offset:1024
    buffer_load_dword v12, v3, s[32:35], s13 offen offset:0
    buffer_load_dword v13, v3, s[32:35], s13 offen offset:256
    buffer_load_dword v14, v3, s[32:35], s13 offen offset:512
    buffer_load_dword v15, v3, s[32:35], s13 offen offset:768
    buffer_load_dword v16, v3, s[32:35], s13 offen offset:1024
    s_add_u32 s13, s13, 1280
    buffer_load_dword v17, v3, s[32:35], s13 offen offset:0
    buffer_load_dword v18, v3, s[32:35], s13 offen offset:256
    buffer_load_dword v19, v3, s[32:35], s13 offen offset:512
    buffer_load_dword v20, v3, s[32:35], s13 offen offset:768
    buffer_load_dword v21, v3, s[32:35], s13 offen offset:1024
    s_add_u32 s13, s13, 1280
    buffer_load_dword v22, v3, s[32:35], s13 offen offset:0
    buffer_load_dword v23, v3, s[32:35], s13 offen offset:256
    buffer_load_dword v24, v3, s[32:35], s13 offen offset:512
    buffer_load_dword v25, v3, s[32:35], s13 offen offset:768
    buffer_load_dword v26, v3, s[32:35], s13 offen offset:1024
    s_add_u32 s13, s13, 1280
    buffer_load_dword v27, v3, s[32:35], s13 offen offset:0
    buffer_load_dword v28, v3, s[32:35], s13 offen offset:256
    buffer_load_dword v29, v3, s[32:35], s13 offen offset:512
    buffer_load_dword v30, v3, s[32:35], s13 offen offset:768
    buffer_load_dword v31, v3, s[32:35], s13 offen offset:1024
    s_add_u32 s13, s13, 1280
    buffer_load_dword v32, v3, s[32:35], s13 offen offset:0
    buffer_load_dword v33, v3, s[32:35], s13 offen offset:256
    buffer_load_dword v34, v3, s[32:35], s13 offen offset:512
    buffer_load_dword v35, v3, s[32:35], s13 offen offset:768
    buffer_load_dword v36, v3, s[32:35], s13 offen offset:1024
    s_add_u32 s13, s13, 1280
    buffer_load_dword v37, v3, s[32:35], s13 offen offset:0
    buffer_load_dword v38, v3, s[32:35], s13 offen offset:256
    buffer_load_dword v39, v3, s[32:35], s13 offen offset:512
    buffer_load_dword v40, v3, s[32:35], s13 offen offset:768
    buffer_load_dword v41, v3, s[32:35], s13 offen offset:1024
    s_add_u32 s13, s13, 1280
    buffer_load_dword v42, v3, s[32:35], s13 offen offset:0
    buffer_load_dword v43, v3, s[32:35], s13 offen offset:256
    buffer_load_dword v44, v3, s[32:35], s13 offen offset:512
    buffer_load_dword v45, v3, s[32:35], s13 offen offset:768
    buffer_load_dword v46, v3, s[32:35], s13 offen offset:1024
    s_add_u32 s13, s13, 1280
    buffer_load_dword v47, v3, s[32:35], s13 offen offset:0
    buffer_load_dword v48, v3, s[32:35], s13 offen offset:256
    buffer_load_dword v49, v3, s[32:35], s13 offen offset:512
    buffer_load_dword v50, v3, s[32:35], s13 offen offset:768
    buffer_load_dword v51, v3, s[32:35], s13 offen offset:1024
    s_add_u32 s13, s13, 1280
    s_waitcnt vmcnt(0)
    v_mov_b32 v52, 0
    v_dot2_f32_bf16 v52, v12, v6, v52
    v_dot2_f32_bf16 v52, v13, v7, v52
    v_dot2_f32_bf16 v52, v14, v8, v52
    v_dot2_f32_bf16 v52, v15, v9, v52
    v_dot2_f32_bf16 v52, v16, v10, v52
    v_mov_b32 v53, 0
    v_dot2_f32_bf16 v53, v17, v6, v53
    v_dot2_f32_bf16 v53, v18, v7, v53
    v_dot2_f32_bf16 v53, v19, v8, v53
    v_dot2_f32_bf16 v53, v20, v9, v53
    v_dot2_f32_bf16 v53, v21, v10, v53
    v_mov_b32 v54, 0
    v_dot2_f32_bf16 v54, v22, v6, v54
    v_dot2_f32_bf16 v54, v23, v7, v54
    v_dot2_f32_bf16 v54, v24, v8, v54
    v_dot2_f32_bf16 v54, v25, v9, v54
    v_dot2_f32_bf16 v54, v26, v10, v54
    v_mov_b32 v55, 0
    v_dot2_f32_bf16 v55, v27, v6, v55
    v_dot2_f32_bf16 v55, v28, v7, v55
    v_dot2_f32_bf16 v55, v29, v8, v55
    v_dot2_f32_bf16 v55, v30, v9, v55
    v_dot2_f32_bf16 v55, v31, v10, v55
    v_mov_b32 v56, 0
    v_dot2_f32_bf16 v56, v32, v6, v56
    v_dot2_f32_bf16 v56, v33, v7, v56
    v_dot2_f32_bf16 v56, v34, v8, v56
    v_dot2_f32_bf16 v56, v35, v9, v56
    v_dot2_f32_bf16 v56, v36, v10, v56
    v_mov_b32 v57, 0
    v_dot2_f32_bf16 v57, v37, v6, v57
    v_dot2_f32_bf16 v57, v38, v7, v57
    v_dot2_f32_bf16 v57, v39, v8, v57
    v_dot2_f32_bf16 v57, v40, v9, v57
    v_dot2_f32_bf16 v57, v41, v10, v57
    v_mov_b32 v58, 0
    v_dot2_f32_bf16 v58, v42, v6, v58
    v_dot2_f32_bf16 v58, v43, v7, v58
    v_dot2_f32_bf16 v58, v44, v8, v58
    v_dot2_f32_bf16 v58, v45, v9, v58
    v_dot2_f32_bf16 v58, v46, v10, v58
    v_mov_b32 v59, 0
    v_dot2_f32_bf16 v59, v47, v6, v59
    v_dot2_f32_bf16 v59, v48, v7, v59
    v_dot2_f32_bf16 v59, v49, v8, v59
    v_dot2_f32_bf16 v59, v50, v9, v59
    v_dot2_f32_bf16 v59, v51, v10, v59
    s_nop 1
    v_add_f32_dpp v52, v52, v52 row_ror:8 row_mask:0xf bank_mask:0xf
    v_add_f32_dpp v53, v53, v53 row_ror:8 row_mask:0xf bank_mask:0xf
    v_add_f32_dpp v54, v54, v54 row_ror:8 row_mask:0xf bank_mask:0xf
    v_add_f32_dpp v55, v55, v55 row_ror:8 row_mask:0xf bank_mask:0xf
    v_add_f32_dpp v56, v56, v56 row_ror:8 row_mask:0xf bank_mask:0xf
    v_add_f32_dpp v57, v57, v57 row_ror:8 row_mask:0xf bank_mask:0xf
    v_add_f32_dpp v58, v58, v58 row_ror:8 row_mask:0xf bank_mask:0xf
    v_add_f32_dpp v59, v59, v59 row_ror:8 row_mask:0xf bank_mask:0xf
    s_nop 1
    v_add_f32_dpp v52, v52, v52 row_ror:4 row_mask:0xf bank_mask:0xf
    v_add_f32_dpp v53, v53, v53 row_ror:4 row_mask:0xf bank_mask:0xf
    v_add_f32_dpp v54, v54, v54 row_ror:4 row_mask:0xf bank_mask:0xf
    v_add_f32_dpp v55, v55, v55 row_ror:4 row_mask:0xf bank_mask:0xf
    v_add_f32_dpp v56, v56, v56 row_ror:4 row_mask:0xf bank_mask:0xf
    v_add_f32_dpp v57, v57, v57 row_ror:4 row_mask:0xf bank_mask:0xf
    v_add_f32_dpp v58, v58, v58 row_ror:4 row_mask:0xf bank_mask:0xf
    v_add_f32_dpp v59, v59, v59 row_ror:4 row_mask:0xf bank_mask:0xf
    s_nop 1
    v_add_f32_dpp v52, v52, v52 row_ror:2 row_mask:0xf bank_mask:0xf
    v_add_f32_dpp v53, v53, v53 row_ror:2 row_mask:0xf bank_mask:0xf
    v_add_f32_dpp v54, v54, v54 row_ror:2 row_mask:0xf bank_mask:0xf
    v_add_f32_dpp v55, v55, v55 row_ror:2 row_mask:0xf bank_mask:0xf
    v_add_f32_dpp v56, v56, v56 row_ror:2 row_mask:0xf bank_mask:0xf
    v_add_f32_dpp v57, v57, v57 row_ror:2 row_mask:0xf bank_mask:0xf
    v_add_f32_dpp v58, v58, v58 row_ror:2 row_mask:0xf bank_mask:0xf
    v_add_f32_dpp v59, v59, v59 row_ror:2 row_mask:0xf bank_mask:0xf
    s_nop 1
    v_add_f32_dpp v52, v52, v52 row_ror:1 row_mask:0xf bank_mask:0xf
    v_add_f32_dpp v53, v53, v53 row_ror:1 row_mask:0xf bank_mask:0xf
    v_add_f32_dpp v54, v54, v54 row_ror:1 row_mask:0xf bank_mask:0xf
    v_add_f32_dpp v55, v55, v55 row_ror:1 row_mask:0xf bank_mask:0xf
    v_add_f32_dpp v56, v56, v56 row_ror:1 row_mask:0xf bank_mask:0xf
    v_add_f32_dpp v57, v57, v57 row_ror:1 row_mask:0xf bank_mask:0xf
    v_add_f32_dpp v58, v58, v58 row_ror:1 row_mask:0xf bank_mask:0xf
    v_add_f32_dpp v59, v59, v59 row_ror:1 row_mask:0xf bank_mask:0xf
    s_nop 1
    v_mov_b32 v60, 0
    v_readlane_b32 s68, v52, 0
    v_readlane_b32 s69, v52, 16
    v_readlane_b32 s70, v52, 32
    v_readlane_b32 s71, v52, 48
    s_nop 1
    v_mov_b32 v4, s68
    v_add_f32 v4, s69, v4
    v_add_f32 v4, s70, v4
    v_add_f32 v4, s71, v4
    v_cmp_eq_u32 vcc, 0, v1
    s_nop 1
    v_cndmask_b32 v60, v60, v4, vcc
    v_readlane_b32 s68, v53, 0
    v_readlane_b32 s69, v53, 16
    v_readlane_b32 s70, v53, 32
    v_readlane_b32 s71, v53, 48
    s_nop 1
    v_mov_b32 v4, s68
    v_add_f32 v4, s69, v4
    v_add_f32 v4, s70, v4
    v_add_f32 v4, s71, v4
    v_cmp_eq_u32 vcc, 1, v1
    s_nop 1
    v_cndmask_b32 v60, v60, v4, vcc
    v_readlane_b32 s68, v54, 0
    v_readlane_b32 s69, v54, 16
    v_readlane_b32 s70, v54, 32
    v_readlane_b32 s71, v54, 48
    s_nop 1
    v_mov_b32 v4, s68
    v_add_f32 v4, s69, v4
    v_add_f32 v4, s70, v4
    v_add_f32 v4, s71, v4
    v_cmp_eq_u32 vcc, 2, v1
    s_nop 1
    v_cndmask_b32 v60, v60, v4, vcc
    v_readlane_b32 s68, v55, 0
    v_readlane_b32 s69, v55, 16
    v_readlane_b32 s70, v55, 32
    v_readlane_b32 s71, v55, 48
    s_nop 1
    v_mov_b32 v4, s68
    v_add_f32 v4, s69, v4
    v_add_f32 v4, s70, v4
    v_add_f32 v4, s71, v4
    v_cmp_eq_u32 vcc, 3, v1
    s_nop 1
    v_cndmask_b32 v60, v60, v4, vcc
    v_readlane_b32 s68, v56, 0
    v_readlane_b32 s69, v56, 16
    v_readlane_b32 s70, v56, 32
    v_readlane_b32 s71, v56, 48
    s_nop 1
    v_mov_b32 v4, s68
    v_add_f32 v4, s69, v4
    v_add_f32 v4, s70, v4
    v_add_f32 v4, s71, v4
    v_cmp_eq_u32 vcc, 4, v1
    s_nop 1
    v_cndmask_b32 v60, v60, v4, vcc
    v_readlane_b32 s68, v57, 0
    v_readlane_b32 s69, v57, 16
    v_readlane_b32 s70, v57, 32
    v_readlane_b32 s71, v57, 48
    s_nop 1
    v_mov_b32 v4, s68
    v_add_f32 v4, s69, v4
    v_add_f32 v4, s70, v4
    v_add_f32 v4, s71, v4
    v_cmp_eq_u32 vcc, 5, v1
    s_nop 1
    v_cndmask_b32 v60, v60, v4, vcc
    v_readlane_b32 s68, v58, 0
    v_readlane_b32 s69, v58, 16
    v_readlane_b32 s70, v58, 32
    v_readlane_b32 s71, v58, 48
    s_nop 1
    v_mov_b32 v4, s68
    v_add_f32 v4, s69, v4
    v_add_f32 v4, s70, v4
    v_add_f32 v4, s71, v4
    v_cmp_eq_u32 vcc, 6, v1
    s_nop 1
    v_cndmask_b32 v60, v60, v4, vcc
    v_readlane_b32 s68, v59, 0
    v_readlane_b32 s69, v59, 16
    v_readlane_b32 s70, v59, 32
    v_readlane_b32 s71, v59, 48
    s_nop 1
    v_mov_b32 v4, s68
    v_add_f32 v4, s69, v4
    v_add_f32 v4, s70, v4
    v_add_f32 v4, s71, v4
    v_cmp_eq_u32 vcc, 7, v1
    s_nop 1
    v_cndmask_b32 v60, v60, v4, vcc
    v_cvt_pk_bf16_f32 v60, v60, v60
    v_lshlrev_b32 v60, 16, v60
    v_mul_f32 v60, 0xbfb8aa3b, v60
    v_exp_f32 v60, v60
    s_nop 0
    v_add_f32 v60, 1.0, v60
    v_rcp_f32 v60, v60
    s_nop 0
    v_cvt_pk_bf16_f32 v60, v60, v60
    v_lshlrev_b32 v60, 16, v60
    s_lshl_b32 s68, s5, 2
    s_add_u32 s68, s68, 10485760
    v_lshlrev_b32 v4, 2, v1
    s_mov_b64 exec, 0xff
    buffer_store_dword v60, v4, s[44:47], s68 offen sc1
    s_mov_b64 exec, -1
    v_mov_b32 v2, 0
gated_mix__ssm_conv_s5__ssm_conv_s4__prompt_kernel_gnp103:
    buffer_load_dword v5, v2, s[48:51], 0 offen sc1
    s_waitcnt vmcnt(0)
    v_readfirstlane_b32 s96, v5
    s_nop 1
    s_cmp_lg_u32 s96, 0
    s_cbranch_scc1 gated_mix__ssm_conv_s5__ssm_conv_s4__prompt_kernel_gng104
    s_cmp_eq_u32 s98, 0
    s_cbranch_scc1 gated_mix__ssm_conv_s5__ssm_conv_s4__prompt_kernel_gng104
    s_sub_u32 s98, s98, 1
    s_sleep 4
    s_branch gated_mix__ssm_conv_s5__ssm_conv_s4__prompt_kernel_gnp103
gated_mix__ssm_conv_s5__ssm_conv_s4__prompt_kernel_gng104:
    s_mov_b64 exec, 1
    s_lshr_b32 s68, s5, 6
    s_lshl_b32 s68, s68, 7
    s_lshr_b32 s69, s5, 3
    s_and_b32 s69, s69, 7
    s_lshl_b32 s69, s69, 2
    s_add_u32 s68, s68, s69
    s_add_u32 s68, s68, 10825728
    v_mov_b32 v4, 0
    v_mov_b32 v5, s96
    buffer_store_dword v5, v4, s[44:47], s68 offen sc1
    s_mov_b64 exec, -1
    s_branch gated_mix__ssm_conv_s5__ssm_conv_s4__prompt_kernel_p2
gated_mix__ssm_conv_s5__ssm_conv_s4__prompt_kernel_p2:
    s_mov_b32 s28, s4
    s_mov_b64 exec, -1
    s_setprio 0
    s_load_dwordx16 s[32:47], s[0:1], 0
    s_load_dwordx8 s[52:59], s[0:1], 144
    s_load_dwordx2 s[48:49], s[0:1], 64
    s_load_dwordx2 s[50:51], s[0:1], 136
    s_and_b32 s30, s2, 7
    s_lshr_b32 s31, s2, 3
    s_lshr_b32 s4, s30, 1
    s_lshl_b32 s4, s4, 3
    s_lshr_b32 s5, s31, 2
    s_add_u32 s4, s4, s5
    s_and_b32 s5, s30, 1
    s_lshl_b32 s5, s5, 2
    s_and_b32 s6, s31, 3
    s_add_u32 s5, s5, s6
    s_lshl_b32 s4, s4, 6
    s_mul_i32 s5, s5, 80
    s_waitcnt vmcnt(0) lgkmcnt(0)
    s_barrier
    s_cmp_ge_u32 s28, 8
    s_cbranch_scc1 gated_mix__ssm_conv_s5__ssm_conv_s4__prompt_kernel_prod105
    s_cmp_ge_u32 s28, 4
    s_cbranch_scc1 gated_mix__ssm_conv_s5__ssm_conv_s4__prompt_kernel_ew106
    s_setprio 1
    v_and_b32 v2, 15, v1
    v_lshrrev_b32 v3, 4, v1
    v_lshrrev_b32 v4, 1, v2
    v_xor_b32 v4, v4, v3
    v_lshlrev_b32 v4, 4, v4
    v_lshl_add_u32 v76, v2, 7, v4
    s_lshl_b32 s10, s28, 11
    v_add_u32 v77, s10, v76
    v_add_u32 v76, 8192, v76
    v_xor_b32 v78, 64, v76
    v_xor_b32 v79, 64, v77
    v_mov_b32 v8, 0
    v_mov_b32 v9, 0
    v_mov_b32 v10, 0
    v_mov_b32 v11, 0
    v_mov_b32 v12, 0
    v_mov_b32 v13, 0
    v_mov_b32 v14, 0
    v_mov_b32 v15, 0
    v_mov_b32 v16, 0
    v_mov_b32 v17, 0
    v_mov_b32 v18, 0
    v_mov_b32 v19, 0
    v_mov_b32 v20, 0
    v_mov_b32 v21, 0
    v_mov_b32 v22, 0
    v_mov_b32 v23, 0
    v_mov_b32 v24, 0
    v_mov_b32 v25, 0
    v_mov_b32 v26, 0
    v_mov_b32 v27, 0
    s_barrier
    s_barrier
    ds_read_b128 v[28:31], v77
    ds_read_b128 v[32:35], v76 offset:0
    ds_read_b128 v[36:39], v76 offset:2048
    ds_read_b128 v[40:43], v76 offset:4096
    ds_read_b128 v[44:47], v76 offset:6144
    ds_read_b128 v[48:51], v76 offset:8192
    ds_read_b128 v[52:55], v79
    ds_read_b128 v[56:59], v78 offset:0
    ds_read_b128 v[60:63], v78 offset:2048
    ds_read_b128 v[64:67], v78 offset:4096
    ds_read_b128 v[68:71], v78 offset:6144
    ds_read_b128 v[72:75], v78 offset:8192
    s_waitcnt lgkmcnt(6)
    v_mfma_f32_16x16x32_bf16 v[8:11], v[32:35], v[28:31], v[8:11]
    v_mfma_f32_16x16x32_bf16 v[12:15], v[36:39], v[28:31], v[12:15]
    v_mfma_f32_16x16x32_bf16 v[16:19], v[40:43], v[28:31], v[16:19]
    v_mfma_f32_16x16x32_bf16 v[20:23], v[44:47], v[28:31], v[20:23]
    v_mfma_f32_16x16x32_bf16 v[24:27], v[48:51], v[28:31], v[24:27]
    v_add_u32 v76, 0x4800, v76
    v_add_u32 v77, 0x4800, v77
    v_add_u32 v78, 0x4800, v78
    v_add_u32 v79, 0x4800, v79
    s_waitcnt lgkmcnt(0)
    s_barrier
    ds_read_b128 v[28:31], v77
    ds_read_b128 v[32:35], v76 offset:0
    ds_read_b128 v[36:39], v76 offset:2048
    ds_read_b128 v[40:43], v76 offset:4096
    ds_read_b128 v[44:47], v76 offset:6144
    ds_read_b128 v[48:51], v76 offset:8192
    v_mfma_f32_16x16x32_bf16 v[8:11], v[56:59], v[52:55], v[8:11]
    v_mfma_f32_16x16x32_bf16 v[12:15], v[60:63], v[52:55], v[12:15]
    v_mfma_f32_16x16x32_bf16 v[16:19], v[64:67], v[52:55], v[16:19]
    v_mfma_f32_16x16x32_bf16 v[20:23], v[68:71], v[52:55], v[20:23]
    v_mfma_f32_16x16x32_bf16 v[24:27], v[72:75], v[52:55], v[24:27]
    ds_read_b128 v[52:55], v79
    ds_read_b128 v[56:59], v78 offset:0
    ds_read_b128 v[60:63], v78 offset:2048
    ds_read_b128 v[64:67], v78 offset:4096
    ds_read_b128 v[68:71], v78 offset:6144
    ds_read_b128 v[72:75], v78 offset:8192
    s_waitcnt lgkmcnt(6)
    v_mfma_f32_16x16x32_bf16 v[8:11], v[32:35], v[28:31], v[8:11]
    v_mfma_f32_16x16x32_bf16 v[12:15], v[36:39], v[28:31], v[12:15]
    v_mfma_f32_16x16x32_bf16 v[16:19], v[40:43], v[28:31], v[16:19]
    v_mfma_f32_16x16x32_bf16 v[20:23], v[44:47], v[28:31], v[20:23]
    v_mfma_f32_16x16x32_bf16 v[24:27], v[48:51], v[28:31], v[24:27]
    v_add_u32 v76, 0x4800, v76
    v_add_u32 v77, 0x4800, v77
    v_add_u32 v78, 0x4800, v78
    v_add_u32 v79, 0x4800, v79
    s_waitcnt lgkmcnt(0)
    s_barrier
    ds_read_b128 v[28:31], v77
    ds_read_b128 v[32:35], v76 offset:0
    ds_read_b128 v[36:39], v76 offset:2048
    ds_read_b128 v[40:43], v76 offset:4096
    ds_read_b128 v[44:47], v76 offset:6144
    ds_read_b128 v[48:51], v76 offset:8192
    v_mfma_f32_16x16x32_bf16 v[8:11], v[56:59], v[52:55], v[8:11]
    v_mfma_f32_16x16x32_bf16 v[12:15], v[60:63], v[52:55], v[12:15]
    v_mfma_f32_16x16x32_bf16 v[16:19], v[64:67], v[52:55], v[16:19]
    v_mfma_f32_16x16x32_bf16 v[20:23], v[68:71], v[52:55], v[20:23]
    v_mfma_f32_16x16x32_bf16 v[24:27], v[72:75], v[52:55], v[24:27]
    ds_read_b128 v[52:55], v79
    ds_read_b128 v[56:59], v78 offset:0
    ds_read_b128 v[60:63], v78 offset:2048
    ds_read_b128 v[64:67], v78 offset:4096
    ds_read_b128 v[68:71], v78 offset:6144
    ds_read_b128 v[72:75], v78 offset:8192
    s_waitcnt lgkmcnt(6)
    v_mfma_f32_16x16x32_bf16 v[8:11], v[32:35], v[28:31], v[8:11]
    v_mfma_f32_16x16x32_bf16 v[12:15], v[36:39], v[28:31], v[12:15]
    v_mfma_f32_16x16x32_bf16 v[16:19], v[40:43], v[28:31], v[16:19]
    v_mfma_f32_16x16x32_bf16 v[20:23], v[44:47], v[28:31], v[20:23]
    v_mfma_f32_16x16x32_bf16 v[24:27], v[48:51], v[28:31], v[24:27]
    v_add_u32 v76, 0x4800, v76
    v_add_u32 v77, 0x4800, v77
    v_add_u32 v78, 0x4800, v78
    v_add_u32 v79, 0x4800, v79
    s_waitcnt lgkmcnt(0)
    s_barrier
    ds_read_b128 v[28:31], v77
    ds_read_b128 v[32:35], v76 offset:0
    ds_read_b128 v[36:39], v76 offset:2048
    ds_read_b128 v[40:43], v76 offset:4096
    ds_read_b128 v[44:47], v76 offset:6144
    ds_read_b128 v[48:51], v76 offset:8192
    v_mfma_f32_16x16x32_bf16 v[8:11], v[56:59], v[52:55], v[8:11]
    v_mfma_f32_16x16x32_bf16 v[12:15], v[60:63], v[52:55], v[12:15]
    v_mfma_f32_16x16x32_bf16 v[16:19], v[64:67], v[52:55], v[16:19]
    v_mfma_f32_16x16x32_bf16 v[20:23], v[68:71], v[52:55], v[20:23]
    v_mfma_f32_16x16x32_bf16 v[24:27], v[72:75], v[52:55], v[24:27]
    ds_read_b128 v[52:55], v79
    ds_read_b128 v[56:59], v78 offset:0
    ds_read_b128 v[60:63], v78 offset:2048
    ds_read_b128 v[64:67], v78 offset:4096
    ds_read_b128 v[68:71], v78 offset:6144
    ds_read_b128 v[72:75], v78 offset:8192
    s_waitcnt lgkmcnt(6)
    v_mfma_f32_16x16x32_bf16 v[8:11], v[32:35], v[28:31], v[8:11]
    v_mfma_f32_16x16x32_bf16 v[12:15], v[36:39], v[28:31], v[12:15]
    v_mfma_f32_16x16x32_bf16 v[16:19], v[40:43], v[28:31], v[16:19]
    v_mfma_f32_16x16x32_bf16 v[20:23], v[44:47], v[28:31], v[20:23]
    v_mfma_f32_16x16x32_bf16 v[24:27], v[48:51], v[28:31], v[24:27]
    v_add_u32 v76, 0x4800, v76
    v_add_u32 v77, 0x4800, v77
    v_add_u32 v78, 0x4800, v78
    v_add_u32 v79, 0x4800, v79
    s_waitcnt lgkmcnt(0)
    s_barrier
    ds_read_b128 v[28:31], v77
    ds_read_b128 v[32:35], v76 offset:0
    ds_read_b128 v[36:39], v76 offset:2048
    ds_read_b128 v[40:43], v76 offset:4096
    ds_read_b128 v[44:47], v76 offset:6144
    ds_read_b128 v[48:51], v76 offset:8192
    v_mfma_f32_16x16x32_bf16 v[8:11], v[56:59], v[52:55], v[8:11]
    v_mfma_f32_16x16x32_bf16 v[12:15], v[60:63], v[52:55], v[12:15]
    v_mfma_f32_16x16x32_bf16 v[16:19], v[64:67], v[52:55], v[16:19]
    v_mfma_f32_16x16x32_bf16 v[20:23], v[68:71], v[52:55], v[20:23]
    v_mfma_f32_16x16x32_bf16 v[24:27], v[72:75], v[52:55], v[24:27]
    ds_read_b128 v[52:55], v79
    ds_read_b128 v[56:59], v78 offset:0
    ds_read_b128 v[60:63], v78 offset:2048
    ds_read_b128 v[64:67], v78 offset:4096
    ds_read_b128 v[68:71], v78 offset:6144
    ds_read_b128 v[72:75], v78 offset:8192
    s_waitcnt lgkmcnt(6)
    v_mfma_f32_16x16x32_bf16 v[8:11], v[32:35], v[28:31], v[8:11]
    v_mfma_f32_16x16x32_bf16 v[12:15], v[36:39], v[28:31], v[12:15]
    v_mfma_f32_16x16x32_bf16 v[16:19], v[40:43], v[28:31], v[16:19]
    v_mfma_f32_16x16x32_bf16 v[20:23], v[44:47], v[28:31], v[20:23]
    v_mfma_f32_16x16x32_bf16 v[24:27], v[48:51], v[28:31], v[24:27]
    v_add_u32 v76, 0x4800, v76
    v_add_u32 v77, 0x4800, v77
    v_add_u32 v78, 0x4800, v78
    v_add_u32 v79, 0x4800, v79
    s_waitcnt lgkmcnt(0)
    s_barrier
    ds_read_b128 v[28:31], v77
    ds_read_b128 v[32:35], v76 offset:0
    ds_read_b128 v[36:39], v76 offset:2048
    ds_read_b128 v[40:43], v76 offset:4096
    ds_read_b128 v[44:47], v76 offset:6144
    ds_read_b128 v[48:51], v76 offset:8192
    v_mfma_f32_16x16x32_bf16 v[8:11], v[56:59], v[52:55], v[8:11]
    v_mfma_f32_16x16x32_bf16 v[12:15], v[60:63], v[52:55], v[12:15]
    v_mfma_f32_16x16x32_bf16 v[16:19], v[64:67], v[52:55], v[16:19]
    v_mfma_f32_16x16x32_bf16 v[20:23], v[68:71], v[52:55], v[20:23]
    v_mfma_f32_16x16x32_bf16 v[24:27], v[72:75], v[52:55], v[24:27]
    ds_read_b128 v[52:55], v79
    ds_read_b128 v[56:59], v78 offset:0
    ds_read_b128 v[60:63], v78 offset:2048
    ds_read_b128 v[64:67], v78 offset:4096
    ds_read_b128 v[68:71], v78 offset:6144
    ds_read_b128 v[72:75], v78 offset:8192
    s_waitcnt lgkmcnt(6)
    v_mfma_f32_16x16x32_bf16 v[8:11], v[32:35], v[28:31], v[8:11]
    v_mfma_f32_16x16x32_bf16 v[12:15], v[36:39], v[28:31], v[12:15]
    v_mfma_f32_16x16x32_bf16 v[16:19], v[40:43], v[28:31], v[16:19]
    v_mfma_f32_16x16x32_bf16 v[20:23], v[44:47], v[28:31], v[20:23]
    v_mfma_f32_16x16x32_bf16 v[24:27], v[48:51], v[28:31], v[24:27]
    v_add_u32 v76, 0x4800, v76
    v_add_u32 v77, 0x4800, v77
    v_add_u32 v78, 0x4800, v78
    v_add_u32 v79, 0x4800, v79
    s_waitcnt lgkmcnt(0)
    s_barrier
    ds_read_b128 v[28:31], v77
    ds_read_b128 v[32:35], v76 offset:0
    ds_read_b128 v[36:39], v76 offset:2048
    ds_read_b128 v[40:43], v76 offset:4096
    ds_read_b128 v[44:47], v76 offset:6144
    ds_read_b128 v[48:51], v76 offset:8192
    v_mfma_f32_16x16x32_bf16 v[8:11], v[56:59], v[52:55], v[8:11]
    v_mfma_f32_16x16x32_bf16 v[12:15], v[60:63], v[52:55], v[12:15]
    v_mfma_f32_16x16x32_bf16 v[16:19], v[64:67], v[52:55], v[16:19]
    v_mfma_f32_16x16x32_bf16 v[20:23], v[68:71], v[52:55], v[20:23]
    v_mfma_f32_16x16x32_bf16 v[24:27], v[72:75], v[52:55], v[24:27]
    ds_read_b128 v[52:55], v79
    ds_read_b128 v[56:59], v78 offset:0
    ds_read_b128 v[60:63], v78 offset:2048
    ds_read_b128 v[64:67], v78 offset:4096
    ds_read_b128 v[68:71], v78 offset:6144
    ds_read_b128 v[72:75], v78 offset:8192
    s_waitcnt lgkmcnt(6)
    v_mfma_f32_16x16x32_bf16 v[8:11], v[32:35], v[28:31], v[8:11]
    v_mfma_f32_16x16x32_bf16 v[12:15], v[36:39], v[28:31], v[12:15]
    v_mfma_f32_16x16x32_bf16 v[16:19], v[40:43], v[28:31], v[16:19]
    v_mfma_f32_16x16x32_bf16 v[20:23], v[44:47], v[28:31], v[20:23]
    v_mfma_f32_16x16x32_bf16 v[24:27], v[48:51], v[28:31], v[24:27]
    v_add_u32 v76, 0xfffe5000, v76
    v_add_u32 v77, 0xfffe5000, v77
    v_add_u32 v78, 0xfffe5000, v78
    v_add_u32 v79, 0xfffe5000, v79
    s_waitcnt lgkmcnt(0)
    s_barrier
    ds_read_b128 v[28:31], v77
    ds_read_b128 v[32:35], v76 offset:0
    ds_read_b128 v[36:39], v76 offset:2048
    ds_read_b128 v[40:43], v76 offset:4096
    ds_read_b128 v[44:47], v76 offset:6144
    ds_read_b128 v[48:51], v76 offset:8192
    v_mfma_f32_16x16x32_bf16 v[8:11], v[56:59], v[52:55], v[8:11]
    v_mfma_f32_16x16x32_bf16 v[12:15], v[60:63], v[52:55], v[12:15]
    v_mfma_f32_16x16x32_bf16 v[16:19], v[64:67], v[52:55], v[16:19]
    v_mfma_f32_16x16x32_bf16 v[20:23], v[68:71], v[52:55], v[20:23]
    v_mfma_f32_16x16x32_bf16 v[24:27], v[72:75], v[52:55], v[24:27]
    ds_read_b128 v[52:55], v79
    ds_read_b128 v[56:59], v78 offset:0
    ds_read_b128 v[60:63], v78 offset:2048
    ds_read_b128 v[64:67], v78 offset:4096
    ds_read_b128 v[68:71], v78 offset:6144
    ds_read_b128 v[72:75], v78 offset:8192
    s_waitcnt lgkmcnt(6)
    v_mfma_f32_16x16x32_bf16 v[8:11], v[32:35], v[28:31], v[8:11]
    v_mfma_f32_16x16x32_bf16 v[12:15], v[36:39], v[28:31], v[12:15]
    v_mfma_f32_16x16x32_bf16 v[16:19], v[40:43], v[28:31], v[16:19]
    v_mfma_f32_16x16x32_bf16 v[20:23], v[44:47], v[28:31], v[20:23]
    v_mfma_f32_16x16x32_bf16 v[24:27], v[48:51], v[28:31], v[24:27]
    v_add_u32 v76, 0x4800, v76
    v_add_u32 v77, 0x4800, v77
    v_add_u32 v78, 0x4800, v78
    v_add_u32 v79, 0x4800, v79
    s_waitcnt lgkmcnt(0)
    s_barrier
    ds_read_b128 v[28:31], v77
    ds_read_b128 v[32:35], v76 offset:0
    ds_read_b128 v[36:39], v76 offset:2048
    ds_read_b128 v[40:43], v76 offset:4096
    ds_read_b128 v[44:47], v76 offset:6144
    ds_read_b128 v[48:51], v76 offset:8192
    v_mfma_f32_16x16x32_bf16 v[8:11], v[56:59], v[52:55], v[8:11]
    v_mfma_f32_16x16x32_bf16 v[12:15], v[60:63], v[52:55], v[12:15]
    v_mfma_f32_16x16x32_bf16 v[16:19], v[64:67], v[52:55], v[16:19]
    v_mfma_f32_16x16x32_bf16 v[20:23], v[68:71], v[52:55], v[20:23]
    v_mfma_f32_16x16x32_bf16 v[24:27], v[72:75], v[52:55], v[24:27]
    ds_read_b128 v[52:55], v79
    ds_read_b128 v[56:59], v78 offset:0
    ds_read_b128 v[60:63], v78 offset:2048
    ds_read_b128 v[64:67], v78 offset:4096
    ds_read_b128 v[68:71], v78 offset:6144
    ds_read_b128 v[72:75], v78 offset:8192
    s_waitcnt lgkmcnt(6)
    v_mfma_f32_16x16x32_bf16 v[8:11], v[32:35], v[28:31], v[8:11]
    v_mfma_f32_16x16x32_bf16 v[12:15], v[36:39], v[28:31], v[12:15]
    v_mfma_f32_16x16x32_bf16 v[16:19], v[40:43], v[28:31], v[16:19]
    v_mfma_f32_16x16x32_bf16 v[20:23], v[44:47], v[28:31], v[20:23]
    v_mfma_f32_16x16x32_bf16 v[24:27], v[48:51], v[28:31], v[24:27]
    v_add_u32 v76, 0x4800, v76
    v_add_u32 v77, 0x4800, v77
    v_add_u32 v78, 0x4800, v78
    v_add_u32 v79, 0x4800, v79
    s_waitcnt lgkmcnt(0)
    s_barrier
    ds_read_b128 v[28:31], v77
    ds_read_b128 v[32:35], v76 offset:0
    ds_read_b128 v[36:39], v76 offset:2048
    ds_read_b128 v[40:43], v76 offset:4096
    ds_read_b128 v[44:47], v76 offset:6144
    ds_read_b128 v[48:51], v76 offset:8192
    v_mfma_f32_16x16x32_bf16 v[8:11], v[56:59], v[52:55], v[8:11]
    v_mfma_f32_16x16x32_bf16 v[12:15], v[60:63], v[52:55], v[12:15]
    v_mfma_f32_16x16x32_bf16 v[16:19], v[64:67], v[52:55], v[16:19]
    v_mfma_f32_16x16x32_bf16 v[20:23], v[68:71], v[52:55], v[20:23]
    v_mfma_f32_16x16x32_bf16 v[24:27], v[72:75], v[52:55], v[24:27]
    ds_read_b128 v[52:55], v79
    ds_read_b128 v[56:59], v78 offset:0
    ds_read_b128 v[60:63], v78 offset:2048
    ds_read_b128 v[64:67], v78 offset:4096
    ds_read_b128 v[68:71], v78 offset:6144
    ds_read_b128 v[72:75], v78 offset:8192
    s_waitcnt lgkmcnt(6)
    v_mfma_f32_16x16x32_bf16 v[8:11], v[32:35], v[28:31], v[8:11]
    v_mfma_f32_16x16x32_bf16 v[12:15], v[36:39], v[28:31], v[12:15]
    v_mfma_f32_16x16x32_bf16 v[16:19], v[40:43], v[28:31], v[16:19]
    v_mfma_f32_16x16x32_bf16 v[20:23], v[44:47], v[28:31], v[20:23]
    v_mfma_f32_16x16x32_bf16 v[24:27], v[48:51], v[28:31], v[24:27]
    v_add_u32 v76, 0x4800, v76
    v_add_u32 v77, 0x4800, v77
    v_add_u32 v78, 0x4800, v78
    v_add_u32 v79, 0x4800, v79
    s_waitcnt lgkmcnt(0)
    s_barrier
    ds_read_b128 v[28:31], v77
    ds_read_b128 v[32:35], v76 offset:0
    ds_read_b128 v[36:39], v76 offset:2048
    ds_read_b128 v[40:43], v76 offset:4096
    ds_read_b128 v[44:47], v76 offset:6144
    ds_read_b128 v[48:51], v76 offset:8192
    v_mfma_f32_16x16x32_bf16 v[8:11], v[56:59], v[52:55], v[8:11]
    v_mfma_f32_16x16x32_bf16 v[12:15], v[60:63], v[52:55], v[12:15]
    v_mfma_f32_16x16x32_bf16 v[16:19], v[64:67], v[52:55], v[16:19]
    v_mfma_f32_16x16x32_bf16 v[20:23], v[68:71], v[52:55], v[20:23]
    v_mfma_f32_16x16x32_bf16 v[24:27], v[72:75], v[52:55], v[24:27]
    ds_read_b128 v[52:55], v79
    ds_read_b128 v[56:59], v78 offset:0
    ds_read_b128 v[60:63], v78 offset:2048
    ds_read_b128 v[64:67], v78 offset:4096
    ds_read_b128 v[68:71], v78 offset:6144
    ds_read_b128 v[72:75], v78 offset:8192
    s_waitcnt lgkmcnt(6)
    v_mfma_f32_16x16x32_bf16 v[8:11], v[32:35], v[28:31], v[8:11]
    v_mfma_f32_16x16x32_bf16 v[12:15], v[36:39], v[28:31], v[12:15]
    v_mfma_f32_16x16x32_bf16 v[16:19], v[40:43], v[28:31], v[16:19]
    v_mfma_f32_16x16x32_bf16 v[20:23], v[44:47], v[28:31], v[20:23]
    v_mfma_f32_16x16x32_bf16 v[24:27], v[48:51], v[28:31], v[24:27]
    v_add_u32 v76, 0x4800, v76
    v_add_u32 v77, 0x4800, v77
    v_add_u32 v78, 0x4800, v78
    v_add_u32 v79, 0x4800, v79
    s_waitcnt lgkmcnt(0)
    s_barrier
    ds_read_b128 v[28:31], v77
    ds_read_b128 v[32:35], v76 offset:0
    ds_read_b128 v[36:39], v76 offset:2048
    ds_read_b128 v[40:43], v76 offset:4096
    ds_read_b128 v[44:47], v76 offset:6144
    ds_read_b128 v[48:51], v76 offset:8192
    v_mfma_f32_16x16x32_bf16 v[8:11], v[56:59], v[52:55], v[8:11]
    v_mfma_f32_16x16x32_bf16 v[12:15], v[60:63], v[52:55], v[12:15]
    v_mfma_f32_16x16x32_bf16 v[16:19], v[64:67], v[52:55], v[16:19]
    v_mfma_f32_16x16x32_bf16 v[20:23], v[68:71], v[52:55], v[20:23]
    v_mfma_f32_16x16x32_bf16 v[24:27], v[72:75], v[52:55], v[24:27]
    ds_read_b128 v[52:55], v79
    ds_read_b128 v[56:59], v78 offset:0
    ds_read_b128 v[60:63], v78 offset:2048
    ds_read_b128 v[64:67], v78 offset:4096
    ds_read_b128 v[68:71], v78 offset:6144
    ds_read_b128 v[72:75], v78 offset:8192
    s_waitcnt lgkmcnt(6)
    v_mfma_f32_16x16x32_bf16 v[8:11], v[32:35], v[28:31], v[8:11]
    v_mfma_f32_16x16x32_bf16 v[12:15], v[36:39], v[28:31], v[12:15]
    v_mfma_f32_16x16x32_bf16 v[16:19], v[40:43], v[28:31], v[16:19]
    v_mfma_f32_16x16x32_bf16 v[20:23], v[44:47], v[28:31], v[20:23]
    v_mfma_f32_16x16x32_bf16 v[24:27], v[48:51], v[28:31], v[24:27]
    v_add_u32 v76, 0x4800, v76
    v_add_u32 v77, 0x4800, v77
    v_add_u32 v78, 0x4800, v78
    v_add_u32 v79, 0x4800, v79
    s_waitcnt lgkmcnt(0)
    s_barrier
    ds_read_b128 v[28:31], v77
    ds_read_b128 v[32:35], v76 offset:0
    ds_read_b128 v[36:39], v76 offset:2048
    ds_read_b128 v[40:43], v76 offset:4096
    ds_read_b128 v[44:47], v76 offset:6144
    ds_read_b128 v[48:51], v76 offset:8192
    v_mfma_f32_16x16x32_bf16 v[8:11], v[56:59], v[52:55], v[8:11]
    v_mfma_f32_16x16x32_bf16 v[12:15], v[60:63], v[52:55], v[12:15]
    v_mfma_f32_16x16x32_bf16 v[16:19], v[64:67], v[52:55], v[16:19]
    v_mfma_f32_16x16x32_bf16 v[20:23], v[68:71], v[52:55], v[20:23]
    v_mfma_f32_16x16x32_bf16 v[24:27], v[72:75], v[52:55], v[24:27]
    ds_read_b128 v[52:55], v79
    ds_read_b128 v[56:59], v78 offset:0
    ds_read_b128 v[60:63], v78 offset:2048
    ds_read_b128 v[64:67], v78 offset:4096
    ds_read_b128 v[68:71], v78 offset:6144
    ds_read_b128 v[72:75], v78 offset:8192
    s_waitcnt lgkmcnt(6)
    v_mfma_f32_16x16x32_bf16 v[8:11], v[32:35], v[28:31], v[8:11]
    v_mfma_f32_16x16x32_bf16 v[12:15], v[36:39], v[28:31], v[12:15]
    v_mfma_f32_16x16x32_bf16 v[16:19], v[40:43], v[28:31], v[16:19]
    v_mfma_f32_16x16x32_bf16 v[20:23], v[44:47], v[28:31], v[20:23]
    v_mfma_f32_16x16x32_bf16 v[24:27], v[48:51], v[28:31], v[24:27]
    v_add_u32 v76, 0x4800, v76
    v_add_u32 v77, 0x4800, v77
    v_add_u32 v78, 0x4800, v78
    v_add_u32 v79, 0x4800, v79
    s_waitcnt lgkmcnt(0)
    s_barrier
    ds_read_b128 v[28:31], v77
    ds_read_b128 v[32:35], v76 offset:0
    ds_read_b128 v[36:39], v76 offset:2048
    ds_read_b128 v[40:43], v76 offset:4096
    ds_read_b128 v[44:47], v76 offset:6144
    ds_read_b128 v[48:51], v76 offset:8192
    v_mfma_f32_16x16x32_bf16 v[8:11], v[56:59], v[52:55], v[8:11]
    v_mfma_f32_16x16x32_bf16 v[12:15], v[60:63], v[52:55], v[12:15]
    v_mfma_f32_16x16x32_bf16 v[16:19], v[64:67], v[52:55], v[16:19]
    v_mfma_f32_16x16x32_bf16 v[20:23], v[68:71], v[52:55], v[20:23]
    v_mfma_f32_16x16x32_bf16 v[24:27], v[72:75], v[52:55], v[24:27]
    ds_read_b128 v[52:55], v79
    ds_read_b128 v[56:59], v78 offset:0
    ds_read_b128 v[60:63], v78 offset:2048
    ds_read_b128 v[64:67], v78 offset:4096
    ds_read_b128 v[68:71], v78 offset:6144
    ds_read_b128 v[72:75], v78 offset:8192
    s_waitcnt lgkmcnt(6)
    v_mfma_f32_16x16x32_bf16 v[8:11], v[32:35], v[28:31], v[8:11]
    v_mfma_f32_16x16x32_bf16 v[12:15], v[36:39], v[28:31], v[12:15]
    v_mfma_f32_16x16x32_bf16 v[16:19], v[40:43], v[28:31], v[16:19]
    v_mfma_f32_16x16x32_bf16 v[20:23], v[44:47], v[28:31], v[20:23]
    v_mfma_f32_16x16x32_bf16 v[24:27], v[48:51], v[28:31], v[24:27]
    v_add_u32 v76, 0xfffe5000, v76
    v_add_u32 v77, 0xfffe5000, v77
    v_add_u32 v78, 0xfffe5000, v78
    v_add_u32 v79, 0xfffe5000, v79
    s_waitcnt lgkmcnt(0)
    s_barrier
    ds_read_b128 v[28:31], v77
    ds_read_b128 v[32:35], v76 offset:0
    ds_read_b128 v[36:39], v76 offset:2048
    ds_read_b128 v[40:43], v76 offset:4096
    ds_read_b128 v[44:47], v76 offset:6144
    ds_read_b128 v[48:51], v76 offset:8192
    v_mfma_f32_16x16x32_bf16 v[8:11], v[56:59], v[52:55], v[8:11]
    v_mfma_f32_16x16x32_bf16 v[12:15], v[60:63], v[52:55], v[12:15]
    v_mfma_f32_16x16x32_bf16 v[16:19], v[64:67], v[52:55], v[16:19]
    v_mfma_f32_16x16x32_bf16 v[20:23], v[68:71], v[52:55], v[20:23]
    v_mfma_f32_16x16x32_bf16 v[24:27], v[72:75], v[52:55], v[24:27]
    ds_read_b128 v[52:55], v79
    ds_read_b128 v[56:59], v78 offset:0
    ds_read_b128 v[60:63], v78 offset:2048
    ds_read_b128 v[64:67], v78 offset:4096
    ds_read_b128 v[68:71], v78 offset:6144
    ds_read_b128 v[72:75], v78 offset:8192
    s_waitcnt lgkmcnt(6)
    v_mfma_f32_16x16x32_bf16 v[8:11], v[32:35], v[28:31], v[8:11]
    v_mfma_f32_16x16x32_bf16 v[12:15], v[36:39], v[28:31], v[12:15]
    v_mfma_f32_16x16x32_bf16 v[16:19], v[40:43], v[28:31], v[16:19]
    v_mfma_f32_16x16x32_bf16 v[20:23], v[44:47], v[28:31], v[20:23]
    v_mfma_f32_16x16x32_bf16 v[24:27], v[48:51], v[28:31], v[24:27]
    v_add_u32 v76, 0x4800, v76
    v_add_u32 v77, 0x4800, v77
    v_add_u32 v78, 0x4800, v78
    v_add_u32 v79, 0x4800, v79
    s_waitcnt lgkmcnt(0)
    s_barrier
    ds_read_b128 v[28:31], v77
    ds_read_b128 v[32:35], v76 offset:0
    ds_read_b128 v[36:39], v76 offset:2048
    ds_read_b128 v[40:43], v76 offset:4096
    ds_read_b128 v[44:47], v76 offset:6144
    ds_read_b128 v[48:51], v76 offset:8192
    v_mfma_f32_16x16x32_bf16 v[8:11], v[56:59], v[52:55], v[8:11]
    v_mfma_f32_16x16x32_bf16 v[12:15], v[60:63], v[52:55], v[12:15]
    v_mfma_f32_16x16x32_bf16 v[16:19], v[64:67], v[52:55], v[16:19]
    v_mfma_f32_16x16x32_bf16 v[20:23], v[68:71], v[52:55], v[20:23]
    v_mfma_f32_16x16x32_bf16 v[24:27], v[72:75], v[52:55], v[24:27]
    ds_read_b128 v[52:55], v79
    ds_read_b128 v[56:59], v78 offset:0
    ds_read_b128 v[60:63], v78 offset:2048
    ds_read_b128 v[64:67], v78 offset:4096
    ds_read_b128 v[68:71], v78 offset:6144
    ds_read_b128 v[72:75], v78 offset:8192
    s_waitcnt lgkmcnt(6)
    v_mfma_f32_16x16x32_bf16 v[8:11], v[32:35], v[28:31], v[8:11]
    v_mfma_f32_16x16x32_bf16 v[12:15], v[36:39], v[28:31], v[12:15]
    v_mfma_f32_16x16x32_bf16 v[16:19], v[40:43], v[28:31], v[16:19]
    v_mfma_f32_16x16x32_bf16 v[20:23], v[44:47], v[28:31], v[20:23]
    v_mfma_f32_16x16x32_bf16 v[24:27], v[48:51], v[28:31], v[24:27]
    v_add_u32 v76, 0x4800, v76
    v_add_u32 v77, 0x4800, v77
    v_add_u32 v78, 0x4800, v78
    v_add_u32 v79, 0x4800, v79
    s_waitcnt lgkmcnt(0)
    s_barrier
    ds_read_b128 v[28:31], v77
    ds_read_b128 v[32:35], v76 offset:0
    ds_read_b128 v[36:39], v76 offset:2048
    ds_read_b128 v[40:43], v76 offset:4096
    ds_read_b128 v[44:47], v76 offset:6144
    ds_read_b128 v[48:51], v76 offset:8192
    v_mfma_f32_16x16x32_bf16 v[8:11], v[56:59], v[52:55], v[8:11]
    v_mfma_f32_16x16x32_bf16 v[12:15], v[60:63], v[52:55], v[12:15]
    v_mfma_f32_16x16x32_bf16 v[16:19], v[64:67], v[52:55], v[16:19]
    v_mfma_f32_16x16x32_bf16 v[20:23], v[68:71], v[52:55], v[20:23]
    v_mfma_f32_16x16x32_bf16 v[24:27], v[72:75], v[52:55], v[24:27]
    ds_read_b128 v[52:55], v79
    ds_read_b128 v[56:59], v78 offset:0
    ds_read_b128 v[60:63], v78 offset:2048
    ds_read_b128 v[64:67], v78 offset:4096
    ds_read_b128 v[68:71], v78 offset:6144
    ds_read_b128 v[72:75], v78 offset:8192
    s_waitcnt lgkmcnt(6)
    v_mfma_f32_16x16x32_bf16 v[8:11], v[32:35], v[28:31], v[8:11]
    v_mfma_f32_16x16x32_bf16 v[12:15], v[36:39], v[28:31], v[12:15]
    v_mfma_f32_16x16x32_bf16 v[16:19], v[40:43], v[28:31], v[16:19]
    v_mfma_f32_16x16x32_bf16 v[20:23], v[44:47], v[28:31], v[20:23]
    v_mfma_f32_16x16x32_bf16 v[24:27], v[48:51], v[28:31], v[24:27]
    v_add_u32 v76, 0x4800, v76
    v_add_u32 v77, 0x4800, v77
    v_add_u32 v78, 0x4800, v78
    v_add_u32 v79, 0x4800, v79
    s_waitcnt lgkmcnt(0)
    s_barrier
    ds_read_b128 v[28:31], v77
    ds_read_b128 v[32:35], v76 offset:0
    ds_read_b128 v[36:39], v76 offset:2048
    ds_read_b128 v[40:43], v76 offset:4096
    ds_read_b128 v[44:47], v76 offset:6144
    ds_read_b128 v[48:51], v76 offset:8192
    v_mfma_f32_16x16x32_bf16 v[8:11], v[56:59], v[52:55], v[8:11]
    v_mfma_f32_16x16x32_bf16 v[12:15], v[60:63], v[52:55], v[12:15]
    v_mfma_f32_16x16x32_bf16 v[16:19], v[64:67], v[52:55], v[16:19]
    v_mfma_f32_16x16x32_bf16 v[20:23], v[68:71], v[52:55], v[20:23]
    v_mfma_f32_16x16x32_bf16 v[24:27], v[72:75], v[52:55], v[24:27]
    ds_read_b128 v[52:55], v79
    ds_read_b128 v[56:59], v78 offset:0
    ds_read_b128 v[60:63], v78 offset:2048
    ds_read_b128 v[64:67], v78 offset:4096
    ds_read_b128 v[68:71], v78 offset:6144
    ds_read_b128 v[72:75], v78 offset:8192
    s_waitcnt lgkmcnt(6)
    v_mfma_f32_16x16x32_bf16 v[8:11], v[32:35], v[28:31], v[8:11]
    v_mfma_f32_16x16x32_bf16 v[12:15], v[36:39], v[28:31], v[12:15]
    v_mfma_f32_16x16x32_bf16 v[16:19], v[40:43], v[28:31], v[16:19]
    v_mfma_f32_16x16x32_bf16 v[20:23], v[44:47], v[28:31], v[20:23]
    v_mfma_f32_16x16x32_bf16 v[24:27], v[48:51], v[28:31], v[24:27]
    v_add_u32 v76, 0x4800, v76
    v_add_u32 v77, 0x4800, v77
    v_add_u32 v78, 0x4800, v78
    v_add_u32 v79, 0x4800, v79
    s_waitcnt lgkmcnt(0)
    s_barrier
    ds_read_b128 v[28:31], v77
    ds_read_b128 v[32:35], v76 offset:0
    ds_read_b128 v[36:39], v76 offset:2048
    ds_read_b128 v[40:43], v76 offset:4096
    ds_read_b128 v[44:47], v76 offset:6144
    ds_read_b128 v[48:51], v76 offset:8192
    v_mfma_f32_16x16x32_bf16 v[8:11], v[56:59], v[52:55], v[8:11]
    v_mfma_f32_16x16x32_bf16 v[12:15], v[60:63], v[52:55], v[12:15]
    v_mfma_f32_16x16x32_bf16 v[16:19], v[64:67], v[52:55], v[16:19]
    v_mfma_f32_16x16x32_bf16 v[20:23], v[68:71], v[52:55], v[20:23]
    v_mfma_f32_16x16x32_bf16 v[24:27], v[72:75], v[52:55], v[24:27]
    ds_read_b128 v[52:55], v79
    ds_read_b128 v[56:59], v78 offset:0
    ds_read_b128 v[60:63], v78 offset:2048
    ds_read_b128 v[64:67], v78 offset:4096
    ds_read_b128 v[68:71], v78 offset:6144
    ds_read_b128 v[72:75], v78 offset:8192
    s_waitcnt lgkmcnt(6)
    v_mfma_f32_16x16x32_bf16 v[8:11], v[32:35], v[28:31], v[8:11]
    v_mfma_f32_16x16x32_bf16 v[12:15], v[36:39], v[28:31], v[12:15]
    v_mfma_f32_16x16x32_bf16 v[16:19], v[40:43], v[28:31], v[16:19]
    v_mfma_f32_16x16x32_bf16 v[20:23], v[44:47], v[28:31], v[20:23]
    v_mfma_f32_16x16x32_bf16 v[24:27], v[48:51], v[28:31], v[24:27]
    v_add_u32 v76, 0x4800, v76
    v_add_u32 v77, 0x4800, v77
    v_add_u32 v78, 0x4800, v78
    v_add_u32 v79, 0x4800, v79
    s_waitcnt lgkmcnt(0)
    s_barrier
    ds_read_b128 v[28:31], v77
    ds_read_b128 v[32:35], v76 offset:0
    ds_read_b128 v[36:39], v76 offset:2048
    ds_read_b128 v[40:43], v76 offset:4096
    ds_read_b128 v[44:47], v76 offset:6144
    ds_read_b128 v[48:51], v76 offset:8192
    v_mfma_f32_16x16x32_bf16 v[8:11], v[56:59], v[52:55], v[8:11]
    v_mfma_f32_16x16x32_bf16 v[12:15], v[60:63], v[52:55], v[12:15]
    v_mfma_f32_16x16x32_bf16 v[16:19], v[64:67], v[52:55], v[16:19]
    v_mfma_f32_16x16x32_bf16 v[20:23], v[68:71], v[52:55], v[20:23]
    v_mfma_f32_16x16x32_bf16 v[24:27], v[72:75], v[52:55], v[24:27]
    ds_read_b128 v[52:55], v79
    ds_read_b128 v[56:59], v78 offset:0
    ds_read_b128 v[60:63], v78 offset:2048
    ds_read_b128 v[64:67], v78 offset:4096
    ds_read_b128 v[68:71], v78 offset:6144
    ds_read_b128 v[72:75], v78 offset:8192
    s_waitcnt lgkmcnt(6)
    v_mfma_f32_16x16x32_bf16 v[8:11], v[32:35], v[28:31], v[8:11]
    v_mfma_f32_16x16x32_bf16 v[12:15], v[36:39], v[28:31], v[12:15]
    v_mfma_f32_16x16x32_bf16 v[16:19], v[40:43], v[28:31], v[16:19]
    v_mfma_f32_16x16x32_bf16 v[20:23], v[44:47], v[28:31], v[20:23]
    v_mfma_f32_16x16x32_bf16 v[24:27], v[48:51], v[28:31], v[24:27]
    s_waitcnt lgkmcnt(0)
    v_mfma_f32_16x16x32_bf16 v[8:11], v[56:59], v[52:55], v[8:11]
    v_mfma_f32_16x16x32_bf16 v[12:15], v[60:63], v[52:55], v[12:15]
    v_mfma_f32_16x16x32_bf16 v[16:19], v[64:67], v[52:55], v[16:19]
    v_mfma_f32_16x16x32_bf16 v[20:23], v[68:71], v[52:55], v[20:23]
    v_mfma_f32_16x16x32_bf16 v[24:27], v[72:75], v[52:55], v[24:27]
    s_barrier
    s_lshl_b32 s10, s28, 4
    v_add_u32 v4, s10, v2
    v_mul_u32_u24 v4, 336, v4
    v_lshl_add_u32 v4, v3, 4, v4
    s_nop 4
    ds_write_b128 v4, v[8:11] offset:0
    ds_write_b128 v4, v[12:15] offset:64
    ds_write_b128 v4, v[16:19] offset:128
    ds_write_b128 v4, v[20:23] offset:192
    ds_write_b128 v4, v[24:27] offset:256
    s_waitcnt lgkmcnt(0)
    s_barrier
    s_branch gated_mix__ssm_conv_s5__ssm_conv_s4__prompt_kernel_end_c
gated_mix__ssm_conv_s5__ssm_conv_s4__prompt_kernel_prod105:
    s_setprio 2
    s_sub_u32 s29, s28, 8
    v_lshrrev_b32 v2, 4, v1
    s_and_b32 s6, s29, 1
    s_lshl_b32 s6, s6, 2
    v_add_u32 v2, s6, v2
    v_and_b32 v2, 7, v2
    v_and_b32 v3, 7, v1
    v_xor_b32 v2, v2, v3
    v_lshlrev_b32 v2, 4, v2
    v_lshrrev_b32 v3, 3, v1
    v_mul_u32_u24 v4, 1280, v3
    v_add_u32 v4, v2, v4
    v_mul_u32_u24 v3, 2560, v3
    v_add_u32 v2, v2, v3
    s_lshl_b32 s6, s29, 3
    s_add_u32 s20, s4, s6
    s_mul_i32 s20, s20, 2560
    s_add_u32 s21, s20, 81920
    s_add_u32 s22, s5, s6
    s_mul_i32 s22, s22, 1280
    s_add_u32 s23, s22, 40960
    s_add_u32 s24, s22, 81920
    s_lshl_b32 s7, s29, 10
    s_mov_b32 s26, 0
    s_mov_b32 s27, 0
    s_mov_b32 s16, s58
    s_mov_b32 s17, s59
    s_mov_b32 s18, 14680064
    s_mov_b32 s19, 0x20000
    s_mov_b32 s60, s42
    s_mov_b32 s61, s43
    s_mov_b32 s62, 819200
    s_mov_b32 s63, 0x20000
    s_mov_b32 s12, s44
    s_mov_b32 s13, s45
    s_mov_b32 s14, 819200
    s_mov_b32 s15, 0x20000
    s_cmp_ge_u32 s29, 2
    s_cbranch_scc1 gated_mix__ssm_conv_s5__ssm_conv_s4__prompt_kernel_p4107
    s_add_u32 m0, s7, 8192
    s_add_u32 s6, s22, 0
    buffer_load_dwordx4 v4, s[60:63], s6 offen lds
    s_add_u32 m0, s7, 12288
    s_add_u32 s6, s23, 0
    buffer_load_dwordx4 v4, s[60:63], s6 offen lds
    s_add_u32 m0, s7, 16384
    s_add_u32 s6, s24, 0
    buffer_load_dwordx4 v4, s[60:63], s6 offen lds
    s_add_u32 m0, s7, 26624
    s_add_u32 s6, s22, 0
    buffer_load_dwordx4 v4, s[12:15], s6 offen lds
    s_add_u32 m0, s7, 30720
    s_add_u32 s6, s23, 0
    buffer_load_dwordx4 v4, s[12:15], s6 offen lds
    s_add_u32 m0, s7, 34816
    s_add_u32 s6, s24, 0
    buffer_load_dwordx4 v4, s[12:15], s6 offen lds
    s_add_u32 m0, s7, 45056
    s_add_u32 s6, s22, 128
    buffer_load_dwordx4 v4, s[60:63], s6 offen lds
    s_add_u32 m0, s7, 49152
    s_add_u32 s6, s23, 128
    buffer_load_dwordx4 v4, s[60:63], s6 offen lds
    s_add_u32 m0, s7, 53248
    s_add_u32 s6, s24, 128
    buffer_load_dwordx4 v4, s[60:63], s6 offen lds
    s_add_u32 m0, s7, 63488
    s_add_u32 s6, s22, 128
    buffer_load_dwordx4 v4, s[12:15], s6 offen lds
    s_add_u32 m0, s7, 67584
    s_add_u32 s6, s23, 128
    buffer_load_dwordx4 v4, s[12:15], s6 offen lds
    s_add_u32 m0, s7, 71680
    s_add_u32 s6, s24, 128
    buffer_load_dwordx4 v4, s[12:15], s6 offen lds
    s_add_u32 m0, s7, 81920
    s_add_u32 s6, s22, 256
    buffer_load_dwordx4 v4, s[60:63], s6 offen lds
    s_add_u32 m0, s7, 86016
    s_add_u32 s6, s23, 256
    buffer_load_dwordx4 v4, s[60:63], s6 offen lds
    s_add_u32 m0, s7, 90112
    s_add_u32 s6, s24, 256
    buffer_load_dwordx4 v4, s[60:63], s6 offen lds
    s_add_u32 m0, s7, 100352
    s_add_u32 s6, s22, 256
    buffer_load_dwordx4 v4, s[12:15], s6 offen lds
    s_add_u32 m0, s7, 104448
    s_add_u32 s6, s23, 256
    buffer_load_dwordx4 v4, s[12:15], s6 offen lds
    s_add_u32 m0, s7, 108544
    s_add_u32 s6, s24, 256
    buffer_load_dwordx4 v4, s[12:15], s6 offen lds
    s_add_u32 m0, s7, 118784
    s_add_u32 s6, s22, 384
    buffer_load_dwordx4 v4, s[60:63], s6 offen lds
    s_add_u32 m0, s7, 122880
    s_add_u32 s6, s23, 384
    buffer_load_dwordx4 v4, s[60:63], s6 offen lds
    s_add_u32 m0, s7, 126976
    s_add_u32 s6, s24, 384
    buffer_load_dwordx4 v4, s[60:63], s6 offen lds
    s_cmp_lg_u32 s29, 0
    s_cbranch_scc1 gated_mix__ssm_conv_s5__ssm_conv_s4__prompt_kernel_np2108
    s_mov_b32 s84, s56
    s_mov_b32 s85, s57
    s_mov_b32 s86, 256
    s_mov_b32 s87, 0x20000
    s_lshr_b32 s30, s4, 7
    s_lshl_b32 s30, s30, 7
    s_add_u32 s30, s30, 10813440
    s_lshr_b32 s31, s4, 6
    s_lshl_b32 s31, s31, 7
    s_add_u32 s31, s31, 10825688
    v_lshlrev_b32 v5, 2, v1
    v_add_u32 v6, s30, v5
    v_add_u32 v7, s31, v5
    v_mov_b32 v8, s30
    v_cmp_gt_u32 vcc, 18, v1
    s_nop 1
    v_cndmask_b32 v7, v8, v7, vcc
    v_cmp_gt_u32 vcc, 10, v1
    s_nop 1
    v_cndmask_b32 v5, v7, v6, vcc
    s_lshl_b32 s30, s5, 3
    s_add_u32 s30, s30, 10817536
    v_lshlrev_b32 v6, 4, v1
    v_cmp_gt_u32 vcc, 40, v1
    v_mov_b32 v7, 0
    s_nop 0
    v_cndmask_b32 v6, v7, v6, vcc
    v_mov_b32 v7, 0
gated_mix__ssm_conv_s5__ssm_conv_s4__prompt_kernel_pl2109:
    buffer_load_dword v8, v7, s[84:87], 0 offen sc1
    buffer_load_dword v9, v5, s[16:19], 0 offen sc1
    buffer_load_dwordx4 v[12:15], v6, s[16:19], s30 offen sc1
    s_waitcnt vmcnt(0)
    v_cmp_eq_u32 s[30:31], v8, v9
    v_cmp_ne_u32 vcc, 0, v8
    s_and_b64 s[88:89], s[30:31], vcc
    v_cmp_eq_u32 vcc, v8, v12
    s_and_b64 s[88:89], s[88:89], vcc
    v_cmp_eq_u32 vcc, v8, v13
    s_and_b64 s[88:89], s[88:89], vcc
    v_cmp_eq_u32 vcc, v8, v14
    s_and_b64 s[88:89], s[88:89], vcc
    v_cmp_eq_u32 vcc, v8, v15
    s_and_b64 s[88:89], s[88:89], vcc
    s_lshl_b32 s30, s5, 3
    s_add_u32 s30, s30, 10817536
    s_cmp_eq_u64 s[88:89], -1
    s_cbranch_scc1 gated_mix__ssm_conv_s5__ssm_conv_s4__prompt_kernel_pd2110
    s_cmp_eq_u32 s98, 0
    s_cbranch_scc1 gated_mix__ssm_conv_s5__ssm_conv_s4__prompt_kernel_pd2110
    s_sub_u32 s98, s98, 1
    s_sleep 6
    s_branch gated_mix__ssm_conv_s5__ssm_conv_s4__prompt_kernel_pl2109
gated_mix__ssm_conv_s5__ssm_conv_s4__prompt_kernel_pd2110:
gated_mix__ssm_conv_s5__ssm_conv_s4__prompt_kernel_np2108:
    s_barrier
    s_add_u32 m0, s7, 0
    s_add_u32 s6, s20, 0
    buffer_load_dwordx4 v2, s[16:19], s6 offen sc1 lds
    s_add_u32 m0, s7, 4096
    s_add_u32 s6, s21, 0
    buffer_load_dwordx4 v2, s[16:19], s6 offen sc1 lds
    s_add_u32 m0, s7, 18432
    s_add_u32 s6, s20, 128
    buffer_load_dwordx4 v2, s[16:19], s6 offen sc1 lds
    s_add_u32 m0, s7, 22528
    s_add_u32 s6, s21, 128
    buffer_load_dwordx4 v2, s[16:19], s6 offen sc1 lds
    s_waitcnt vmcnt(2)
    s_barrier
    s_add_u32 m0, s7, 36864
    s_add_u32 s6, s20, 256
    buffer_load_dwordx4 v2, s[16:19], s6 offen sc1 lds
    s_add_u32 m0, s7, 40960
    s_add_u32 s6, s21, 256
    buffer_load_dwordx4 v2, s[16:19], s6 offen sc1 lds
    s_add_u32 m0, s7, 55296
    s_add_u32 s6, s20, 384
    buffer_load_dwordx4 v2, s[16:19], s6 offen sc1 lds
    s_add_u32 m0, s7, 59392
    s_add_u32 s6, s21, 384
    buffer_load_dwordx4 v2, s[16:19], s6 offen sc1 lds
    s_add_u32 m0, s7, 73728
    s_add_u32 s6, s20, 512
    buffer_load_dwordx4 v2, s[16:19], s6 offen sc1 lds
    s_add_u32 m0, s7, 77824
    s_add_u32 s6, s21, 512
    buffer_load_dwordx4 v2, s[16:19], s6 offen sc1 lds
    s_add_u32 m0, s7, 92160
    s_add_u32 s6, s20, 640
    buffer_load_dwordx4 v2, s[16:19], s6 offen sc1 lds
    s_add_u32 m0, s7, 96256
    s_add_u32 s6, s21, 640
    buffer_load_dwordx4 v2, s[16:19], s6 offen sc1 lds
    s_add_u32 m0, s7, 110592
    s_add_u32 s6, s20, 768
    buffer_load_dwordx4 v2, s[16:19], s6 offen sc1 lds
    s_add_u32 m0, s7, 114688
    s_add_u32 s6, s21, 768
    buffer_load_dwordx4 v2, s[16:19], s6 offen sc1 lds
    s_waitcnt vmcnt(10)
    s_barrier
    s_add_u32 m0, s7, 0
    s_add_u32 s6, s20, 896
    buffer_load_dwordx4 v2, s[16:19], s6 offen sc1 lds
    s_add_u32 m0, s7, 4096
    s_add_u32 s6, s21, 896
    buffer_load_dwordx4 v2, s[16:19], s6 offen sc1 lds
    s_add_u32 m0, s7, 8192
    s_add_u32 s6, s22, 384
    buffer_load_dwordx4 v4, s[12:15], s6 offen lds
    s_add_u32 m0, s7, 12288
    s_add_u32 s6, s23, 384
    buffer_load_dwordx4 v4, s[12:15], s6 offen lds
    s_add_u32 m0, s7, 16384
    s_add_u32 s6, s24, 384
    buffer_load_dwordx4 v4, s[12:15], s6 offen lds
    s_waitcnt vmcnt(13)
    s_barrier
    s_add_u32 m0, s7, 18432
    s_add_u32 s6, s20, 1024
    buffer_load_dwordx4 v2, s[16:19], s6 offen sc1 lds
    s_add_u32 m0, s7, 22528
    s_add_u32 s6, s21, 1024
    buffer_load_dwordx4 v2, s[16:19], s6 offen sc1 lds
    s_add_u32 m0, s7, 26624
    s_add_u32 s6, s22, 512
    buffer_load_dwordx4 v4, s[60:63], s6 offen lds
    s_add_u32 m0, s7, 30720
    s_add_u32 s6, s23, 512
    buffer_load_dwordx4 v4, s[60:63], s6 offen lds
    s_add_u32 m0, s7, 34816
    s_add_u32 s6, s24, 512
    buffer_load_dwordx4 v4, s[60:63], s6 offen lds
    s_waitcnt vmcnt(16)
    s_barrier
    s_add_u32 m0, s7, 36864
    s_add_u32 s6, s20, 1152
    buffer_load_dwordx4 v2, s[16:19], s6 offen sc1 lds
    s_add_u32 m0, s7, 40960
    s_add_u32 s6, s21, 1152
    buffer_load_dwordx4 v2, s[16:19], s6 offen sc1 lds
    s_add_u32 m0, s7, 45056
    s_add_u32 s6, s22, 512
    buffer_load_dwordx4 v4, s[12:15], s6 offen lds
    s_add_u32 m0, s7, 49152
    s_add_u32 s6, s23, 512
    buffer_load_dwordx4 v4, s[12:15], s6 offen lds
    s_add_u32 m0, s7, 53248
    s_add_u32 s6, s24, 512
    buffer_load_dwordx4 v4, s[12:15], s6 offen lds
    s_waitcnt vmcnt(19)
    s_barrier
    s_add_u32 m0, s7, 55296
    s_add_u32 s6, s20, 1280
    buffer_load_dwordx4 v2, s[16:19], s6 offen sc1 lds
    s_add_u32 m0, s7, 59392
    s_add_u32 s6, s21, 1280
    buffer_load_dwordx4 v2, s[16:19], s6 offen sc1 lds
    s_add_u32 m0, s7, 63488
    s_add_u32 s6, s22, 640
    buffer_load_dwordx4 v4, s[60:63], s6 offen lds
    s_add_u32 m0, s7, 67584
    s_add_u32 s6, s23, 640
    buffer_load_dwordx4 v4, s[60:63], s6 offen lds
    s_add_u32 m0, s7, 71680
    s_add_u32 s6, s24, 640
    buffer_load_dwordx4 v4, s[60:63], s6 offen lds
    s_waitcnt vmcnt(22)
    s_barrier
    s_add_u32 m0, s7, 73728
    s_add_u32 s6, s20, 1408
    buffer_load_dwordx4 v2, s[16:19], s6 offen sc1 lds
    s_add_u32 m0, s7, 77824
    s_add_u32 s6, s21, 1408
    buffer_load_dwordx4 v2, s[16:19], s6 offen sc1 lds
    s_add_u32 m0, s7, 81920
    s_add_u32 s6, s22, 640
    buffer_load_dwordx4 v4, s[12:15], s6 offen lds
    s_add_u32 m0, s7, 86016
    s_add_u32 s6, s23, 640
    buffer_load_dwordx4 v4, s[12:15], s6 offen lds
    s_add_u32 m0, s7, 90112
    s_add_u32 s6, s24, 640
    buffer_load_dwordx4 v4, s[12:15], s6 offen lds
    s_waitcnt vmcnt(25)
    s_barrier
    s_add_u32 m0, s7, 92160
    s_add_u32 s6, s20, 1536
    buffer_load_dwordx4 v2, s[16:19], s6 offen sc1 lds
    s_add_u32 m0, s7, 96256
    s_add_u32 s6, s21, 1536
    buffer_load_dwordx4 v2, s[16:19], s6 offen sc1 lds
    s_add_u32 m0, s7, 100352
    s_add_u32 s6, s22, 768
    buffer_load_dwordx4 v4, s[60:63], s6 offen lds
    s_add_u32 m0, s7, 104448
    s_add_u32 s6, s23, 768
    buffer_load_dwordx4 v4, s[60:63], s6 offen lds
    s_add_u32 m0, s7, 108544
    s_add_u32 s6, s24, 768
    buffer_load_dwordx4 v4, s[60:63], s6 offen lds
    s_waitcnt vmcnt(25)
    s_barrier
    s_add_u32 m0, s7, 110592
    s_add_u32 s6, s20, 1664
    buffer_load_dwordx4 v2, s[16:19], s6 offen sc1 lds
    s_add_u32 m0, s7, 114688
    s_add_u32 s6, s21, 1664
    buffer_load_dwordx4 v2, s[16:19], s6 offen sc1 lds
    s_add_u32 m0, s7, 118784
    s_add_u32 s6, s22, 768
    buffer_load_dwordx4 v4, s[12:15], s6 offen lds
    s_add_u32 m0, s7, 122880
    s_add_u32 s6, s23, 768
    buffer_load_dwordx4 v4, s[12:15], s6 offen lds
    s_add_u32 m0, s7, 126976
    s_add_u32 s6, s24, 768
    buffer_load_dwordx4 v4, s[12:15], s6 offen lds
    s_waitcnt vmcnt(25)
    s_barrier
    s_add_u32 m0, s7, 0
    s_add_u32 s6, s20, 1792
    buffer_load_dwordx4 v2, s[16:19], s6 offen sc1 lds
    s_add_u32 m0, s7, 4096
    s_add_u32 s6, s21, 1792
    buffer_load_dwordx4 v2, s[16:19], s6 offen sc1 lds
    s_add_u32 m0, s7, 8192
    s_add_u32 s6, s22, 896
    buffer_load_dwordx4 v4, s[60:63], s6 offen lds
    s_add_u32 m0, s7, 12288
    s_add_u32 s6, s23, 896
    buffer_load_dwordx4 v4, s[60:63], s6 offen lds
    s_add_u32 m0, s7, 16384
    s_add_u32 s6, s24, 896
    buffer_load_dwordx4 v4, s[60:63], s6 offen lds
    s_waitcnt vmcnt(25)
    s_barrier
    s_add_u32 m0, s7, 18432
    s_add_u32 s6, s20, 1920
    buffer_load_dwordx4 v2, s[16:19], s6 offen sc1 lds
    s_add_u32 m0, s7, 22528
    s_add_u32 s6, s21, 1920
    buffer_load_dwordx4 v2, s[16:19], s6 offen sc1 lds
    s_add_u32 m0, s7, 26624
    s_add_u32 s6, s22, 896
    buffer_load_dwordx4 v4, s[12:15], s6 offen lds
    s_add_u32 m0, s7, 30720
    s_add_u32 s6, s23, 896
    buffer_load_dwordx4 v4, s[12:15], s6 offen lds
    s_add_u32 m0, s7, 34816
    s_add_u32 s6, s24, 896
    buffer_load_dwordx4 v4, s[12:15], s6 offen lds
    s_waitcnt vmcnt(25)
    s_barrier
    s_add_u32 m0, s7, 36864
    s_add_u32 s6, s20, 2048
    buffer_load_dwordx4 v2, s[16:19], s6 offen sc1 lds
    s_add_u32 m0, s7, 40960
    s_add_u32 s6, s21, 2048
    buffer_load_dwordx4 v2, s[16:19], s6 offen sc1 lds
    s_add_u32 m0, s7, 45056
    s_add_u32 s6, s22, 1024
    buffer_load_dwordx4 v4, s[60:63], s6 offen lds
    s_add_u32 m0, s7, 49152
    s_add_u32 s6, s23, 1024
    buffer_load_dwordx4 v4, s[60:63], s6 offen lds
    s_add_u32 m0, s7, 53248
    s_add_u32 s6, s24, 1024
    buffer_load_dwordx4 v4, s[60:63], s6 offen lds
    s_waitcnt vmcnt(25)
    s_barrier
    s_add_u32 m0, s7, 55296
    s_add_u32 s6, s20, 2176
    buffer_load_dwordx4 v2, s[16:19], s6 offen sc1 lds
    s_add_u32 m0, s7, 59392
    s_add_u32 s6, s21, 2176
    buffer_load_dwordx4 v2, s[16:19], s6 offen sc1 lds
    s_add_u32 m0, s7, 63488
    s_add_u32 s6, s22, 1024
    buffer_load_dwordx4 v4, s[12:15], s6 offen lds
    s_add_u32 m0, s7, 67584
    s_add_u32 s6, s23, 1024
    buffer_load_dwordx4 v4, s[12:15], s6 offen lds
    s_add_u32 m0, s7, 71680
    s_add_u32 s6, s24, 1024
    buffer_load_dwordx4 v4, s[12:15], s6 offen lds
    s_waitcnt vmcnt(25)
    s_barrier
    s_add_u32 m0, s7, 73728
    s_add_u32 s6, s20, 2304
    buffer_load_dwordx4 v2, s[16:19], s6 offen sc1 lds
    s_add_u32 m0, s7, 77824
    s_add_u32 s6, s21, 2304
    buffer_load_dwordx4 v2, s[16:19], s6 offen sc1 lds
    s_add_u32 m0, s7, 81920
    s_add_u32 s6, s22, 1152
    buffer_load_dwordx4 v4, s[60:63], s6 offen lds
    s_add_u32 m0, s7, 86016
    s_add_u32 s6, s23, 1152
    buffer_load_dwordx4 v4, s[60:63], s6 offen lds
    s_add_u32 m0, s7, 90112
    s_add_u32 s6, s24, 1152
    buffer_load_dwordx4 v4, s[60:63], s6 offen lds
    s_waitcnt vmcnt(25)
    s_barrier
    s_add_u32 m0, s7, 92160
    s_add_u32 s6, s20, 2432
    buffer_load_dwordx4 v2, s[16:19], s6 offen sc1 lds
    s_add_u32 m0, s7, 96256
    s_add_u32 s6, s21, 2432
    buffer_load_dwordx4 v2, s[16:19], s6 offen sc1 lds
    s_add_u32 m0, s7, 100352
    s_add_u32 s6, s22, 1152
    buffer_load_dwordx4 v4, s[12:15], s6 offen lds
    s_add_u32 m0, s7, 104448
    s_add_u32 s6, s23, 1152
    buffer_load_dwordx4 v4, s[12:15], s6 offen lds
    s_add_u32 m0, s7, 108544
    s_add_u32 s6, s24, 1152
    buffer_load_dwordx4 v4, s[12:15], s6 offen lds
    s_waitcnt vmcnt(25)
    s_barrier
    s_waitcnt vmcnt(20)
    s_barrier
    s_waitcnt vmcnt(15)
    s_barrier
    s_waitcnt vmcnt(10)
    s_barrier
    s_waitcnt vmcnt(5)
    s_barrier
    s_waitcnt vmcnt(0)
    s_barrier
    s_barrier
    s_barrier
    s_branch gated_mix__ssm_conv_s5__ssm_conv_s4__prompt_kernel_end_c
gated_mix__ssm_conv_s5__ssm_conv_s4__prompt_kernel_p4107:
    s_add_u32 m0, s7, 8192
    s_add_u32 s6, s22, 0
    buffer_load_dwordx4 v4, s[60:63], s6 offen lds
    s_add_u32 m0, s7, 12288
    s_add_u32 s6, s23, 0
    buffer_load_dwordx4 v4, s[60:63], s6 offen lds
    s_add_u32 m0, s7, 26624
    s_add_u32 s6, s22, 0
    buffer_load_dwordx4 v4, s[12:15], s6 offen lds
    s_add_u32 m0, s7, 30720
    s_add_u32 s6, s23, 0
    buffer_load_dwordx4 v4, s[12:15], s6 offen lds
    s_add_u32 m0, s7, 45056
    s_add_u32 s6, s22, 128
    buffer_load_dwordx4 v4, s[60:63], s6 offen lds
    s_add_u32 m0, s7, 49152
    s_add_u32 s6, s23, 128
    buffer_load_dwordx4 v4, s[60:63], s6 offen lds
    s_add_u32 m0, s7, 63488
    s_add_u32 s6, s22, 128
    buffer_load_dwordx4 v4, s[12:15], s6 offen lds
    s_add_u32 m0, s7, 67584
    s_add_u32 s6, s23, 128
    buffer_load_dwordx4 v4, s[12:15], s6 offen lds
    s_add_u32 m0, s7, 81920
    s_add_u32 s6, s22, 256
    buffer_load_dwordx4 v4, s[60:63], s6 offen lds
    s_add_u32 m0, s7, 86016
    s_add_u32 s6, s23, 256
    buffer_load_dwordx4 v4, s[60:63], s6 offen lds
    s_add_u32 m0, s7, 100352
    s_add_u32 s6, s22, 256
    buffer_load_dwordx4 v4, s[12:15], s6 offen lds
    s_add_u32 m0, s7, 104448
    s_add_u32 s6, s23, 256
    buffer_load_dwordx4 v4, s[12:15], s6 offen lds
    s_add_u32 m0, s7, 118784
    s_add_u32 s6, s22, 384
    buffer_load_dwordx4 v4, s[60:63], s6 offen lds
    s_add_u32 m0, s7, 122880
    s_add_u32 s6, s23, 384
    buffer_load_dwordx4 v4, s[60:63], s6 offen lds
    s_barrier
    s_add_u32 m0, s7, 0
    s_add_u32 s6, s20, 0
    buffer_load_dwordx4 v2, s[16:19], s6 offen sc1 lds
    s_add_u32 m0, s7, 4096
    s_add_u32 s6, s21, 0
    buffer_load_dwordx4 v2, s[16:19], s6 offen sc1 lds
    s_add_u32 m0, s7, 18432
    s_add_u32 s6, s20, 128
    buffer_load_dwordx4 v2, s[16:19], s6 offen sc1 lds
    s_add_u32 m0, s7, 22528
    s_add_u32 s6, s21, 128
    buffer_load_dwordx4 v2, s[16:19], s6 offen sc1 lds
    s_waitcnt vmcnt(2)
    s_barrier
    s_add_u32 m0, s7, 36864
    s_add_u32 s6, s20, 256
    buffer_load_dwordx4 v2, s[16:19], s6 offen sc1 lds
    s_add_u32 m0, s7, 40960
    s_add_u32 s6, s21, 256
    buffer_load_dwordx4 v2, s[16:19], s6 offen sc1 lds
    s_add_u32 m0, s7, 55296
    s_add_u32 s6, s20, 384
    buffer_load_dwordx4 v2, s[16:19], s6 offen sc1 lds
    s_add_u32 m0, s7, 59392
    s_add_u32 s6, s21, 384
    buffer_load_dwordx4 v2, s[16:19], s6 offen sc1 lds
    s_add_u32 m0, s7, 73728
    s_add_u32 s6, s20, 512
    buffer_load_dwordx4 v2, s[16:19], s6 offen sc1 lds
    s_add_u32 m0, s7, 77824
    s_add_u32 s6, s21, 512
    buffer_load_dwordx4 v2, s[16:19], s6 offen sc1 lds
    s_add_u32 m0, s7, 92160
    s_add_u32 s6, s20, 640
    buffer_load_dwordx4 v2, s[16:19], s6 offen sc1 lds
    s_add_u32 m0, s7, 96256
    s_add_u32 s6, s21, 640
    buffer_load_dwordx4 v2, s[16:19], s6 offen sc1 lds
    s_add_u32 m0, s7, 110592
    s_add_u32 s6, s20, 768
    buffer_load_dwordx4 v2, s[16:19], s6 offen sc1 lds
    s_add_u32 m0, s7, 114688
    s_add_u32 s6, s21, 768
    buffer_load_dwordx4 v2, s[16:19], s6 offen sc1 lds
    s_waitcnt vmcnt(10)
    s_barrier
    s_add_u32 m0, s7, 0
    s_add_u32 s6, s20, 896
    buffer_load_dwordx4 v2, s[16:19], s6 offen sc1 lds
    s_add_u32 m0, s7, 4096
    s_add_u32 s6, s21, 896
    buffer_load_dwordx4 v2, s[16:19], s6 offen sc1 lds
    s_add_u32 m0, s7, 8192
    s_add_u32 s6, s22, 384
    buffer_load_dwordx4 v4, s[12:15], s6 offen lds
    s_add_u32 m0, s7, 12288
    s_add_u32 s6, s23, 384
    buffer_load_dwordx4 v4, s[12:15], s6 offen lds
    s_waitcnt vmcnt(12)
    s_barrier
    s_add_u32 m0, s7, 18432
    s_add_u32 s6, s20, 1024
    buffer_load_dwordx4 v2, s[16:19], s6 offen sc1 lds
    s_add_u32 m0, s7, 22528
    s_add_u32 s6, s21, 1024
    buffer_load_dwordx4 v2, s[16:19], s6 offen sc1 lds
    s_add_u32 m0, s7, 26624
    s_add_u32 s6, s22, 512
    buffer_load_dwordx4 v4, s[60:63], s6 offen lds
    s_add_u32 m0, s7, 30720
    s_add_u32 s6, s23, 512
    buffer_load_dwordx4 v4, s[60:63], s6 offen lds
    s_waitcnt vmcnt(14)
    s_barrier
    s_add_u32 m0, s7, 36864
    s_add_u32 s6, s20, 1152
    buffer_load_dwordx4 v2, s[16:19], s6 offen sc1 lds
    s_add_u32 m0, s7, 40960
    s_add_u32 s6, s21, 1152
    buffer_load_dwordx4 v2, s[16:19], s6 offen sc1 lds
    s_add_u32 m0, s7, 45056
    s_add_u32 s6, s22, 512
    buffer_load_dwordx4 v4, s[12:15], s6 offen lds
    s_add_u32 m0, s7, 49152
    s_add_u32 s6, s23, 512
    buffer_load_dwordx4 v4, s[12:15], s6 offen lds
    s_waitcnt vmcnt(16)
    s_barrier
    s_add_u32 m0, s7, 55296
    s_add_u32 s6, s20, 1280
    buffer_load_dwordx4 v2, s[16:19], s6 offen sc1 lds
    s_add_u32 m0, s7, 59392
    s_add_u32 s6, s21, 1280
    buffer_load_dwordx4 v2, s[16:19], s6 offen sc1 lds
    s_add_u32 m0, s7, 63488
    s_add_u32 s6, s22, 640
    buffer_load_dwordx4 v4, s[60:63], s6 offen lds
    s_add_u32 m0, s7, 67584
    s_add_u32 s6, s23, 640
    buffer_load_dwordx4 v4, s[60:63], s6 offen lds
    s_waitcnt vmcnt(18)
    s_barrier
    s_add_u32 m0, s7, 73728
    s_add_u32 s6, s20, 1408
    buffer_load_dwordx4 v2, s[16:19], s6 offen sc1 lds
    s_add_u32 m0, s7, 77824
    s_add_u32 s6, s21, 1408
    buffer_load_dwordx4 v2, s[16:19], s6 offen sc1 lds
    s_add_u32 m0, s7, 81920
    s_add_u32 s6, s22, 640
    buffer_load_dwordx4 v4, s[12:15], s6 offen lds
    s_add_u32 m0, s7, 86016
    s_add_u32 s6, s23, 640
    buffer_load_dwordx4 v4, s[12:15], s6 offen lds
    s_waitcnt vmcnt(20)
    s_barrier
    s_add_u32 m0, s7, 92160
    s_add_u32 s6, s20, 1536
    buffer_load_dwordx4 v2, s[16:19], s6 offen sc1 lds
    s_add_u32 m0, s7, 96256
    s_add_u32 s6, s21, 1536
    buffer_load_dwordx4 v2, s[16:19], s6 offen sc1 lds
    s_add_u32 m0, s7, 100352
    s_add_u32 s6, s22, 768
    buffer_load_dwordx4 v4, s[60:63], s6 offen lds
    s_add_u32 m0, s7, 104448
    s_add_u32 s6, s23, 768
    buffer_load_dwordx4 v4, s[60:63], s6 offen lds
    s_waitcnt vmcnt(20)
    s_barrier
    s_add_u32 m0, s7, 110592
    s_add_u32 s6, s20, 1664
    buffer_load_dwordx4 v2, s[16:19], s6 offen sc1 lds
    s_add_u32 m0, s7, 114688
    s_add_u32 s6, s21, 1664
    buffer_load_dwordx4 v2, s[16:19], s6 offen sc1 lds
    s_add_u32 m0, s7, 118784
    s_add_u32 s6, s22, 768
    buffer_load_dwordx4 v4, s[12:15], s6 offen lds
    s_add_u32 m0, s7, 122880
    s_add_u32 s6, s23, 768
    buffer_load_dwordx4 v4, s[12:15], s6 offen lds
    s_waitcnt vmcnt(20)
    s_barrier
    s_add_u32 m0, s7, 0
    s_add_u32 s6, s20, 1792
    buffer_load_dwordx4 v2, s[16:19], s6 offen sc1 lds
    s_add_u32 m0, s7, 4096
    s_add_u32 s6, s21, 1792
    buffer_load_dwordx4 v2, s[16:19], s6 offen sc1 lds
    s_add_u32 m0, s7, 8192
    s_add_u32 s6, s22, 896
    buffer_load_dwordx4 v4, s[60:63], s6 offen lds
    s_add_u32 m0, s7, 12288
    s_add_u32 s6, s23, 896
    buffer_load_dwordx4 v4, s[60:63], s6 offen lds
    s_waitcnt vmcnt(20)
    s_barrier
    s_add_u32 m0, s7, 18432
    s_add_u32 s6, s20, 1920
    buffer_load_dwordx4 v2, s[16:19], s6 offen sc1 lds
    s_add_u32 m0, s7, 22528
    s_add_u32 s6, s21, 1920
    buffer_load_dwordx4 v2, s[16:19], s6 offen sc1 lds
    s_add_u32 m0, s7, 26624
    s_add_u32 s6, s22, 896
    buffer_load_dwordx4 v4, s[12:15], s6 offen lds
    s_add_u32 m0, s7, 30720
    s_add_u32 s6, s23, 896
    buffer_load_dwordx4 v4, s[12:15], s6 offen lds
    s_waitcnt vmcnt(20)
    s_barrier
    s_add_u32 m0, s7, 36864
    s_add_u32 s6, s20, 2048
    buffer_load_dwordx4 v2, s[16:19], s6 offen sc1 lds
    s_add_u32 m0, s7, 40960
    s_add_u32 s6, s21, 2048
    buffer_load_dwordx4 v2, s[16:19], s6 offen sc1 lds
    s_add_u32 m0, s7, 45056
    s_add_u32 s6, s22, 1024
    buffer_load_dwordx4 v4, s[60:63], s6 offen lds
    s_add_u32 m0, s7, 49152
    s_add_u32 s6, s23, 1024
    buffer_load_dwordx4 v4, s[60:63], s6 offen lds
    s_waitcnt vmcnt(20)
    s_barrier
    s_add_u32 m0, s7, 55296
    s_add_u32 s6, s20, 2176
    buffer_load_dwordx4 v2, s[16:19], s6 offen sc1 lds
    s_add_u32 m0, s7, 59392
    s_add_u32 s6, s21, 2176
    buffer_load_dwordx4 v2, s[16:19], s6 offen sc1 lds
    s_add_u32 m0, s7, 63488
    s_add_u32 s6, s22, 1024
    buffer_load_dwordx4 v4, s[12:15], s6 offen lds
    s_add_u32 m0, s7, 67584
    s_add_u32 s6, s23, 1024
    buffer_load_dwordx4 v4, s[12:15], s6 offen lds
    s_waitcnt vmcnt(20)
    s_barrier
    s_add_u32 m0, s7, 73728
    s_add_u32 s6, s20, 2304
    buffer_load_dwordx4 v2, s[16:19], s6 offen sc1 lds
    s_add_u32 m0, s7, 77824
    s_add_u32 s6, s21, 2304
    buffer_load_dwordx4 v2, s[16:19], s6 offen sc1 lds
    s_add_u32 m0, s7, 81920
    s_add_u32 s6, s22, 1152
    buffer_load_dwordx4 v4, s[60:63], s6 offen lds
    s_add_u32 m0, s7, 86016
    s_add_u32 s6, s23, 1152
    buffer_load_dwordx4 v4, s[60:63], s6 offen lds
    s_waitcnt vmcnt(20)
    s_barrier
    s_add_u32 m0, s7, 92160
    s_add_u32 s6, s20, 2432
    buffer_load_dwordx4 v2, s[16:19], s6 offen sc1 lds
    s_add_u32 m0, s7, 96256
    s_add_u32 s6, s21, 2432
    buffer_load_dwordx4 v2, s[16:19], s6 offen sc1 lds
    s_add_u32 m0, s7, 100352
    s_add_u32 s6, s22, 1152
    buffer_load_dwordx4 v4, s[12:15], s6 offen lds
    s_add_u32 m0, s7, 104448
    s_add_u32 s6, s23, 1152
    buffer_load_dwordx4 v4, s[12:15], s6 offen lds
    s_waitcnt vmcnt(20)
    s_barrier
    s_waitcnt vmcnt(16)
    s_barrier
    s_waitcnt vmcnt(12)
    s_barrier
    s_waitcnt vmcnt(8)
    s_barrier
    s_waitcnt vmcnt(4)
    s_barrier
    s_waitcnt vmcnt(0)
    s_barrier
    s_barrier
    s_barrier
    s_branch gated_mix__ssm_conv_s5__ssm_conv_s4__prompt_kernel_end_c
gated_mix__ssm_conv_s5__ssm_conv_s4__prompt_kernel_ew106:
    s_sub_u32 s29, s28, 4
    s_lshl_b32 s7, s29, 10
    v_subrev_u32 v3, 256, v0
    v_add_u32 v4, 0, v3
    v_mul_u32_u24 v12, 3277, v4
    v_lshrrev_b32 v12, 16, v12
    v_mul_u32_u24 v5, 20, v12
    v_sub_u32 v18, v4, v5
    v_add_u32 v4, 256, v3
    v_mul_u32_u24 v13, 3277, v4
    v_lshrrev_b32 v13, 16, v13
    v_mul_u32_u24 v5, 20, v13
    v_sub_u32 v19, v4, v5
    v_add_u32 v4, 512, v3
    v_mul_u32_u24 v14, 3277, v4
    v_lshrrev_b32 v14, 16, v14
    v_mul_u32_u24 v5, 20, v14
    v_sub_u32 v20, v4, v5
    v_add_u32 v4, 768, v3
    v_mul_u32_u24 v15, 3277, v4
    v_lshrrev_b32 v15, 16, v15
    v_mul_u32_u24 v5, 20, v15
    v_sub_u32 v21, v4, v5
    v_add_u32 v4, 1024, v3
    v_mul_u32_u24 v16, 3277, v4
    v_lshrrev_b32 v16, 16, v16
    v_mul_u32_u24 v5, 20, v16
    v_sub_u32 v22, v4, v5
    s_lshl_b32 s30, s29, 6
    v_add_u32 v6, s30, v1
    v_mul_u32_u24 v7, 6554, v6
    v_lshrrev_b32 v7, 16, v7
    v_mul_u32_u24 v2, 10, v7
    v_sub_u32 v2, v6, v2
    v_mul_u32_u24 v7, 1280, v7
    v_lshl_add_u32 v8, v2, 4, v7
    v_add_u32 v6, s30, v1
    v_add_u32 v6, 256, v6
    v_mul_u32_u24 v7, 6554, v6
    v_lshrrev_b32 v7, 16, v7
    v_mul_u32_u24 v2, 10, v7
    v_sub_u32 v2, v6, v2
    v_mul_u32_u24 v7, 1280, v7
    v_lshl_add_u32 v9, v2, 4, v7
    v_add_u32 v6, s30, v1
    v_add_u32 v6, 512, v6
    v_mul_u32_u24 v7, 6554, v6
    v_lshrrev_b32 v7, 16, v7
    v_mul_u32_u24 v2, 10, v7
    v_sub_u32 v2, v6, v2
    v_mul_u32_u24 v7, 1280, v7
    v_lshl_add_u32 v10, v2, 4, v7
    s_mul_i32 s31, s4, 1280
    s_lshl_b32 s30, s5, 1
    s_add_u32 s31, s31, s30
    s_mov_b32 s16, s58
    s_mov_b32 s17, s59
    s_mov_b32 s18, 14680064
    s_mov_b32 s19, 0x20000
    s_mov_b32 s8, s32
    s_mov_b32 s9, s33
    s_mov_b32 s10, 2621440
    s_mov_b32 s11, 0x20000
    s_mov_b32 s12, s48
    s_mov_b32 s13, s49
    s_mov_b32 s14, 1280
    s_mov_b32 s15, 0x20000
    s_mov_b32 s20, s50
    s_mov_b32 s21, s51
    s_mov_b32 s22, 1280
    s_mov_b32 s23, 0x20000
    s_add_u32 m0, s7, 129024
    s_nop 0
    buffer_load_dwordx4 v8, s[8:11], s31 offen lds
    s_add_u32 m0, s7, 133120
    s_nop 0
    buffer_load_dwordx4 v9, s[8:11], s31 offen lds
    s_cmp_ge_u32 s29, 2
    s_cbranch_scc1 gated_mix__ssm_conv_s5__ssm_conv_s4__prompt_kernel_sk111
    s_add_u32 m0, s7, 137216
    s_nop 0
    buffer_load_dwordx4 v10, s[8:11], s31 offen lds
gated_mix__ssm_conv_s5__ssm_conv_s4__prompt_kernel_sk111:
    s_lshl_b32 s30, s5, 1
    v_lshlrev_b32 v6, 3, v18
    buffer_load_dwordx2 v[30:31], v6, s[12:15], s30 offen
    buffer_load_dwordx2 v[40:41], v6, s[20:23], s30 offen
    v_lshlrev_b32 v6, 3, v19
    buffer_load_dwordx2 v[32:33], v6, s[12:15], s30 offen
    buffer_load_dwordx2 v[42:43], v6, s[20:23], s30 offen
    v_lshlrev_b32 v6, 3, v20
    buffer_load_dwordx2 v[34:35], v6, s[12:15], s30 offen
    buffer_load_dwordx2 v[44:45], v6, s[20:23], s30 offen
    v_lshlrev_b32 v6, 3, v21
    buffer_load_dwordx2 v[36:37], v6, s[12:15], s30 offen
    buffer_load_dwordx2 v[46:47], v6, s[20:23], s30 offen
    v_lshlrev_b32 v6, 3, v22
    buffer_load_dwordx2 v[38:39], v6, s[12:15], s30 offen
    buffer_load_dwordx2 v[48:49], v6, s[20:23], s30 offen
    s_barrier
    s_lshl_b32 s30, s29, 3
    s_add_u32 s30, s30, s5
    s_add_u32 s30, s30, 0
    s_lshl_b32 s30, s30, 12
    s_lshl_b32 s6, s4, 1
    s_add_u32 s30, s30, s6
    s_add_u32 s30, s30, 7340032
    s_lshl_b32 s6, s29, 1
    s_add_u32 s6, s6, 0
    v_lshrrev_b32 v6, 5, v1
    v_add_u32 v6, s6, v6
    v_and_b32 v6, 7, v6
    v_and_b32 v7, 7, v1
    v_xor_b32 v7, v7, v6
    v_lshrrev_b32 v6, 3, v1
    v_lshlrev_b32 v6, 12, v6
    v_lshl_add_u32 v11, v7, 4, v6
    s_add_u32 m0, s7, 139264
    s_nop 0
    buffer_load_dwordx4 v11, s[16:19], s30 offen sc1 lds
    s_lshl_b32 s30, s29, 3
    s_add_u32 s30, s30, s5
    s_add_u32 s30, s30, 32
    s_lshl_b32 s30, s30, 12
    s_lshl_b32 s6, s4, 1
    s_add_u32 s30, s30, s6
    s_add_u32 s30, s30, 7340032
    s_lshl_b32 s6, s29, 1
    s_add_u32 s6, s6, 8
    v_lshrrev_b32 v6, 5, v1
    v_add_u32 v6, s6, v6
    v_and_b32 v6, 7, v6
    v_and_b32 v7, 7, v1
    v_xor_b32 v7, v7, v6
    v_lshrrev_b32 v6, 3, v1
    v_lshlrev_b32 v6, 12, v6
    v_lshl_add_u32 v11, v7, 4, v6
    s_add_u32 m0, s7, 143360
    s_nop 0
    buffer_load_dwordx4 v11, s[16:19], s30 offen sc1 lds
    s_cmp_ge_u32 s29, 2
    s_cbranch_scc1 gated_mix__ssm_conv_s5__ssm_conv_s4__prompt_kernel_sk112
    s_lshl_b32 s30, s29, 3
    s_add_u32 s30, s30, s5
    s_add_u32 s30, s30, 64
    s_lshl_b32 s30, s30, 12
    s_lshl_b32 s6, s4, 1
    s_add_u32 s30, s30, s6
    s_add_u32 s30, s30, 7340032
    s_lshl_b32 s6, s29, 1
    s_add_u32 s6, s6, 16
    v_lshrrev_b32 v6, 5, v1
    v_add_u32 v6, s6, v6
    v_and_b32 v6, 7, v6
    v_and_b32 v7, 7, v1
    v_xor_b32 v7, v7, v6
    v_lshrrev_b32 v6, 3, v1
    v_lshlrev_b32 v6, 12, v6
    v_lshl_add_u32 v11, v7, 4, v6
    s_add_u32 m0, s7, 147456
    s_nop 0
    buffer_load_dwordx4 v11, s[16:19], s30 offen sc1 lds
gated_mix__ssm_conv_s5__ssm_conv_s4__prompt_kernel_sk112:
    s_lshl_b32 s30, s4, 2
    s_add_u32 s30, s30, 10485760
    v_lshlrev_b32 v6, 2, v12
    buffer_load_dword v24, v6, s[16:19], s30 offen sc1
    v_lshlrev_b32 v6, 2, v13
    buffer_load_dword v25, v6, s[16:19], s30 offen sc1
    v_lshlrev_b32 v6, 2, v14
    buffer_load_dword v26, v6, s[16:19], s30 offen sc1
    v_lshlrev_b32 v6, 2, v15
    buffer_load_dword v27, v6, s[16:19], s30 offen sc1
    v_lshlrev_b32 v6, 2, v16
    buffer_load_dword v28, v6, s[16:19], s30 offen sc1
    s_barrier
    s_barrier
    s_barrier
    s_barrier
    s_barrier
    s_barrier
    s_barrier
    s_barrier
    s_waitcnt vmcnt(0)
    s_barrier
    v_mul_u32_u24 v6, 160, v12
    v_lshl_add_u32 v6, v18, 3, v6
    v_add_u32 v6, 129024, v6
    ds_read_b64 v[50:51], v6
    v_lshrrev_b32 v2, 3, v12
    v_and_b32 v3, 7, v18
    v_xor_b32 v2, v2, v3
    v_and_b32 v3, 7, v12
    v_lshlrev_b32 v3, 1, v3
    v_lshl_add_u32 v2, v2, 4, v3
    v_lshlrev_b32 v7, 9, v18
    v_add_u32 v7, v7, v2
    v_add_u32 v7, 139264, v7
    ds_read_u16 v60, v7 offset:0
    ds_read_u16 v61, v7 offset:128
    ds_read_u16 v62, v7 offset:256
    ds_read_u16 v63, v7 offset:384
    v_mul_u32_u24 v6, 160, v13
    v_lshl_add_u32 v6, v19, 3, v6
    v_add_u32 v6, 129024, v6
    ds_read_b64 v[52:53], v6
    v_lshrrev_b32 v2, 3, v13
    v_and_b32 v3, 7, v19
    v_xor_b32 v2, v2, v3
    v_and_b32 v3, 7, v13
    v_lshlrev_b32 v3, 1, v3
    v_lshl_add_u32 v2, v2, 4, v3
    v_lshlrev_b32 v7, 9, v19
    v_add_u32 v7, v7, v2
    v_add_u32 v7, 139264, v7
    ds_read_u16 v64, v7 offset:0
    ds_read_u16 v65, v7 offset:128
    ds_read_u16 v66, v7 offset:256
    ds_read_u16 v67, v7 offset:384
    v_mul_u32_u24 v6, 160, v14
    v_lshl_add_u32 v6, v20, 3, v6
    v_add_u32 v6, 129024, v6
    s_barrier
    ds_read_b64 v[54:55], v6
    v_lshrrev_b32 v2, 3, v14
    v_and_b32 v3, 7, v20
    v_xor_b32 v2, v2, v3
    v_and_b32 v3, 7, v14
    v_lshlrev_b32 v3, 1, v3
    v_lshl_add_u32 v2, v2, 4, v3
    v_lshlrev_b32 v7, 9, v20
    v_add_u32 v7, v7, v2
    v_add_u32 v7, 139264, v7
    ds_read_u16 v68, v7 offset:0
    ds_read_u16 v69, v7 offset:128
    ds_read_u16 v70, v7 offset:256
    ds_read_u16 v71, v7 offset:384
    s_waitcnt lgkmcnt(0)
    v_mul_u32_u24 v6, 160, v15
    v_lshl_add_u32 v6, v21, 3, v6
    v_add_u32 v6, 129024, v6
    ds_read_b64 v[56:57], v6
    v_lshrrev_b32 v2, 3, v15
    v_and_b32 v3, 7, v21
    v_xor_b32 v2, v2, v3
    v_and_b32 v3, 7, v15
    v_lshlrev_b32 v3, 1, v3
    v_lshl_add_u32 v2, v2, 4, v3
    v_lshlrev_b32 v7, 9, v21
    v_add_u32 v7, v7, v2
    v_add_u32 v7, 139264, v7
    ds_read_u16 v72, v7 offset:0
    ds_read_u16 v73, v7 offset:128
    ds_read_u16 v74, v7 offset:256
    ds_read_u16 v75, v7 offset:384
    v_mul_u32_u24 v6, 160, v16
    v_lshl_add_u32 v6, v22, 3, v6
    v_add_u32 v6, 129024, v6
    ds_read_b64 v[58:59], v6
    v_lshrrev_b32 v2, 3, v16
    s_barrier
    v_and_b32 v3, 7, v22
    v_xor_b32 v2, v2, v3
    v_and_b32 v3, 7, v16
    v_lshlrev_b32 v3, 1, v3
    v_lshl_add_u32 v2, v2, 4, v3
    v_lshlrev_b32 v7, 9, v22
    v_add_u32 v7, v7, v2
    v_add_u32 v7, 139264, v7
    ds_read_u16 v76, v7 offset:0
    ds_read_u16 v77, v7 offset:128
    ds_read_u16 v78, v7 offset:256
    ds_read_u16 v79, v7 offset:384
    s_waitcnt lgkmcnt(0)
    v_sub_f32 v10, 1.0, v24
    v_cvt_pk_bf16_f32 v10, v10, v10
    v_lshlrev_b32 v10, 16, v10
    v_lshlrev_b32 v2, 16, v50
    v_and_b32 v3, 0xffff0000, v50
    v_lshlrev_b32 v4, 16, v30
    v_and_b32 v5, 0xffff0000, v30
    v_lshlrev_b32 v6, 16, v40
    v_and_b32 v7, 0xffff0000, v40
    v_mul_f32 v4, v2, v4
    v_mul_f32 v5, v3, v5
    v_mul_f32 v6, v2, v6
    v_mul_f32 v7, v3, v7
    v_cvt_pk_bf16_f32 v8, v4, v5
    v_cvt_pk_bf16_f32 v9, v6, v7
    v_lshlrev_b32 v80, 16, v8
    v_and_b32 v81, 0xffff0000, v8
    v_lshlrev_b32 v6, 16, v9
    v_and_b32 v7, 0xffff0000, v9
    v_lshlrev_b32 v60, 16, v60
    v_lshlrev_b32 v61, 16, v61
    v_add_f32 v6, v6, v60
    v_add_f32 v7, v7, v61
    v_cvt_pk_bf16_f32 v9, v6, v7
    s_barrier
    v_lshlrev_b32 v6, 16, v9
    v_and_b32 v7, 0xffff0000, v9
    v_mul_f32 v6, v6, v10
    v_mul_f32 v7, v7, v10
    v_cvt_pk_bf16_f32 v9, v6, v7
    v_lshlrev_b32 v100, 16, v9
    v_and_b32 v101, 0xffff0000, v9
    v_lshlrev_b32 v2, 16, v51
    v_and_b32 v3, 0xffff0000, v51
    v_lshlrev_b32 v4, 16, v31
    v_and_b32 v5, 0xffff0000, v31
    v_lshlrev_b32 v6, 16, v41
    v_and_b32 v7, 0xffff0000, v41
    v_mul_f32 v4, v2, v4
    v_mul_f32 v5, v3, v5
    v_mul_f32 v6, v2, v6
    v_mul_f32 v7, v3, v7
    v_cvt_pk_bf16_f32 v8, v4, v5
    v_cvt_pk_bf16_f32 v9, v6, v7
    v_lshlrev_b32 v82, 16, v8
    v_and_b32 v83, 0xffff0000, v8
    v_lshlrev_b32 v6, 16, v9
    v_and_b32 v7, 0xffff0000, v9
    v_lshlrev_b32 v62, 16, v62
    v_lshlrev_b32 v63, 16, v63
    v_add_f32 v6, v6, v62
    v_add_f32 v7, v7, v63
    v_cvt_pk_bf16_f32 v9, v6, v7
    v_lshlrev_b32 v6, 16, v9
    v_and_b32 v7, 0xffff0000, v9
    v_mul_f32 v6, v6, v10
    v_mul_f32 v7, v7, v10
    v_cvt_pk_bf16_f32 v9, v6, v7
    v_lshlrev_b32 v102, 16, v9
    v_and_b32 v103, 0xffff0000, v9
    v_sub_f32 v10, 1.0, v25
    v_cvt_pk_bf16_f32 v10, v10, v10
    s_barrier
    v_lshlrev_b32 v10, 16, v10
    v_lshlrev_b32 v2, 16, v52
    v_and_b32 v3, 0xffff0000, v52
    v_lshlrev_b32 v4, 16, v32
    v_and_b32 v5, 0xffff0000, v32
    v_lshlrev_b32 v6, 16, v42
    v_and_b32 v7, 0xffff0000, v42
    v_mul_f32 v4, v2, v4
    v_mul_f32 v5, v3, v5
    v_mul_f32 v6, v2, v6
    v_mul_f32 v7, v3, v7
    v_cvt_pk_bf16_f32 v8, v4, v5
    v_cvt_pk_bf16_f32 v9, v6, v7
    v_lshlrev_b32 v84, 16, v8
    v_and_b32 v85, 0xffff0000, v8
    v_lshlrev_b32 v6, 16, v9
    v_and_b32 v7, 0xffff0000, v9
    v_lshlrev_b32 v64, 16, v64
    v_lshlrev_b32 v65, 16, v65
    v_add_f32 v6, v6, v64
    v_add_f32 v7, v7, v65
    v_cvt_pk_bf16_f32 v9, v6, v7
    v_lshlrev_b32 v6, 16, v9
    v_and_b32 v7, 0xffff0000, v9
    v_mul_f32 v6, v6, v10
    v_mul_f32 v7, v7, v10
    v_cvt_pk_bf16_f32 v9, v6, v7
    v_lshlrev_b32 v104, 16, v9
    v_and_b32 v105, 0xffff0000, v9
    v_lshlrev_b32 v2, 16, v53
    v_and_b32 v3, 0xffff0000, v53
    v_lshlrev_b32 v4, 16, v33
    v_and_b32 v5, 0xffff0000, v33
    v_lshlrev_b32 v6, 16, v43
    v_and_b32 v7, 0xffff0000, v43
    v_mul_f32 v4, v2, v4
    v_mul_f32 v5, v3, v5
    s_barrier
    v_mul_f32 v6, v2, v6
    v_mul_f32 v7, v3, v7
    v_cvt_pk_bf16_f32 v8, v4, v5
    v_cvt_pk_bf16_f32 v9, v6, v7
    v_lshlrev_b32 v86, 16, v8
    v_and_b32 v87, 0xffff0000, v8
    v_lshlrev_b32 v6, 16, v9
    v_and_b32 v7, 0xffff0000, v9
    v_lshlrev_b32 v66, 16, v66
    v_lshlrev_b32 v67, 16, v67
    v_add_f32 v6, v6, v66
    v_add_f32 v7, v7, v67
    v_cvt_pk_bf16_f32 v9, v6, v7
    v_lshlrev_b32 v6, 16, v9
    v_and_b32 v7, 0xffff0000, v9
    v_mul_f32 v6, v6, v10
    v_mul_f32 v7, v7, v10
    v_cvt_pk_bf16_f32 v9, v6, v7
    v_lshlrev_b32 v106, 16, v9
    v_and_b32 v107, 0xffff0000, v9
    v_sub_f32 v10, 1.0, v26
    v_cvt_pk_bf16_f32 v10, v10, v10
    v_lshlrev_b32 v10, 16, v10
    v_lshlrev_b32 v2, 16, v54
    v_and_b32 v3, 0xffff0000, v54
    v_lshlrev_b32 v4, 16, v34
    v_and_b32 v5, 0xffff0000, v34
    v_lshlrev_b32 v6, 16, v44
    v_and_b32 v7, 0xffff0000, v44
    v_mul_f32 v4, v2, v4
    v_mul_f32 v5, v3, v5
    v_mul_f32 v6, v2, v6
    v_mul_f32 v7, v3, v7
    v_cvt_pk_bf16_f32 v8, v4, v5
    v_cvt_pk_bf16_f32 v9, v6, v7
    v_lshlrev_b32 v88, 16, v8
    v_and_b32 v89, 0xffff0000, v8
    s_barrier
    v_lshlrev_b32 v6, 16, v9
    v_and_b32 v7, 0xffff0000, v9
    v_lshlrev_b32 v68, 16, v68
    v_lshlrev_b32 v69, 16, v69
    v_add_f32 v6, v6, v68
    v_add_f32 v7, v7, v69
    v_cvt_pk_bf16_f32 v9, v6, v7
    v_lshlrev_b32 v6, 16, v9
    v_and_b32 v7, 0xffff0000, v9
    v_mul_f32 v6, v6, v10
    v_mul_f32 v7, v7, v10
    v_cvt_pk_bf16_f32 v9, v6, v7
    v_lshlrev_b32 v108, 16, v9
    v_and_b32 v109, 0xffff0000, v9
    v_lshlrev_b32 v2, 16, v55
    v_and_b32 v3, 0xffff0000, v55
    v_lshlrev_b32 v4, 16, v35
    v_and_b32 v5, 0xffff0000, v35
    v_lshlrev_b32 v6, 16, v45
    v_and_b32 v7, 0xffff0000, v45
    v_mul_f32 v4, v2, v4
    v_mul_f32 v5, v3, v5
    v_mul_f32 v6, v2, v6
    v_mul_f32 v7, v3, v7
    v_cvt_pk_bf16_f32 v8, v4, v5
    v_cvt_pk_bf16_f32 v9, v6, v7
    v_lshlrev_b32 v90, 16, v8
    v_and_b32 v91, 0xffff0000, v8
    v_lshlrev_b32 v6, 16, v9
    v_and_b32 v7, 0xffff0000, v9
    v_lshlrev_b32 v70, 16, v70
    v_lshlrev_b32 v71, 16, v71
    v_add_f32 v6, v6, v70
    v_add_f32 v7, v7, v71
    v_cvt_pk_bf16_f32 v9, v6, v7
    v_lshlrev_b32 v6, 16, v9
    v_and_b32 v7, 0xffff0000, v9
    s_barrier
    v_mul_f32 v6, v6, v10
    v_mul_f32 v7, v7, v10
    v_cvt_pk_bf16_f32 v9, v6, v7
    v_lshlrev_b32 v110, 16, v9
    v_and_b32 v111, 0xffff0000, v9
    v_sub_f32 v10, 1.0, v27
    v_cvt_pk_bf16_f32 v10, v10, v10
    v_lshlrev_b32 v10, 16, v10
    v_lshlrev_b32 v2, 16, v56
    v_and_b32 v3, 0xffff0000, v56
    v_lshlrev_b32 v4, 16, v36
    v_and_b32 v5, 0xffff0000, v36
    v_lshlrev_b32 v6, 16, v46
    v_and_b32 v7, 0xffff0000, v46
    v_mul_f32 v4, v2, v4
    v_mul_f32 v5, v3, v5
    v_mul_f32 v6, v2, v6
    v_mul_f32 v7, v3, v7
    v_cvt_pk_bf16_f32 v8, v4, v5
    v_cvt_pk_bf16_f32 v9, v6, v7
    v_lshlrev_b32 v92, 16, v8
    v_and_b32 v93, 0xffff0000, v8
    v_lshlrev_b32 v6, 16, v9
    v_and_b32 v7, 0xffff0000, v9
    v_lshlrev_b32 v72, 16, v72
    v_lshlrev_b32 v73, 16, v73
    v_add_f32 v6, v6, v72
    v_add_f32 v7, v7, v73
    v_cvt_pk_bf16_f32 v9, v6, v7
    v_lshlrev_b32 v6, 16, v9
    v_and_b32 v7, 0xffff0000, v9
    v_mul_f32 v6, v6, v10
    v_mul_f32 v7, v7, v10
    v_cvt_pk_bf16_f32 v9, v6, v7
    v_lshlrev_b32 v112, 16, v9
    v_and_b32 v113, 0xffff0000, v9
    v_lshlrev_b32 v2, 16, v57
    s_barrier
    v_and_b32 v3, 0xffff0000, v57
    v_lshlrev_b32 v4, 16, v37
    v_and_b32 v5, 0xffff0000, v37
    v_lshlrev_b32 v6, 16, v47
    v_and_b32 v7, 0xffff0000, v47
    v_mul_f32 v4, v2, v4
    v_mul_f32 v5, v3, v5
    v_mul_f32 v6, v2, v6
    v_mul_f32 v7, v3, v7
    v_cvt_pk_bf16_f32 v8, v4, v5
    v_cvt_pk_bf16_f32 v9, v6, v7
    v_lshlrev_b32 v94, 16, v8
    v_and_b32 v95, 0xffff0000, v8
    v_lshlrev_b32 v6, 16, v9
    v_and_b32 v7, 0xffff0000, v9
    v_lshlrev_b32 v74, 16, v74
    v_lshlrev_b32 v75, 16, v75
    v_add_f32 v6, v6, v74
    v_add_f32 v7, v7, v75
    v_cvt_pk_bf16_f32 v9, v6, v7
    v_lshlrev_b32 v6, 16, v9
    v_and_b32 v7, 0xffff0000, v9
    v_mul_f32 v6, v6, v10
    v_mul_f32 v7, v7, v10
    v_cvt_pk_bf16_f32 v9, v6, v7
    v_lshlrev_b32 v114, 16, v9
    v_and_b32 v115, 0xffff0000, v9
    v_sub_f32 v10, 1.0, v28
    v_cvt_pk_bf16_f32 v10, v10, v10
    v_lshlrev_b32 v10, 16, v10
    v_lshlrev_b32 v2, 16, v58
    v_and_b32 v3, 0xffff0000, v58
    v_lshlrev_b32 v4, 16, v38
    v_and_b32 v5, 0xffff0000, v38
    v_lshlrev_b32 v6, 16, v48
    v_and_b32 v7, 0xffff0000, v48
    v_mul_f32 v4, v2, v4
    s_barrier
    v_mul_f32 v5, v3, v5
    v_mul_f32 v6, v2, v6
    v_mul_f32 v7, v3, v7
    v_cvt_pk_bf16_f32 v8, v4, v5
    v_cvt_pk_bf16_f32 v9, v6, v7
    v_lshlrev_b32 v96, 16, v8
    v_and_b32 v97, 0xffff0000, v8
    v_lshlrev_b32 v6, 16, v9
    v_and_b32 v7, 0xffff0000, v9
    v_lshlrev_b32 v76, 16, v76
    v_lshlrev_b32 v77, 16, v77
    v_add_f32 v6, v6, v76
    v_add_f32 v7, v7, v77
    v_cvt_pk_bf16_f32 v9, v6, v7
    v_lshlrev_b32 v6, 16, v9
    v_and_b32 v7, 0xffff0000, v9
    v_mul_f32 v6, v6, v10
    v_mul_f32 v7, v7, v10
    v_cvt_pk_bf16_f32 v9, v6, v7
    v_lshlrev_b32 v116, 16, v9
    v_and_b32 v117, 0xffff0000, v9
    v_lshlrev_b32 v2, 16, v59
    v_and_b32 v3, 0xffff0000, v59
    v_lshlrev_b32 v4, 16, v39
    v_and_b32 v5, 0xffff0000, v39
    v_lshlrev_b32 v6, 16, v49
    v_and_b32 v7, 0xffff0000, v49
    v_mul_f32 v4, v2, v4
    v_mul_f32 v5, v3, v5
    v_mul_f32 v6, v2, v6
    v_mul_f32 v7, v3, v7
    v_cvt_pk_bf16_f32 v8, v4, v5
    v_cvt_pk_bf16_f32 v9, v6, v7
    v_lshlrev_b32 v98, 16, v8
    v_and_b32 v99, 0xffff0000, v8
    v_lshlrev_b32 v6, 16, v9
    v_and_b32 v7, 0xffff0000, v9
    s_barrier
    v_lshlrev_b32 v78, 16, v78
    v_lshlrev_b32 v79, 16, v79
    v_add_f32 v6, v6, v78
    v_add_f32 v7, v7, v79
    v_cvt_pk_bf16_f32 v9, v6, v7
    v_lshlrev_b32 v6, 16, v9
    v_and_b32 v7, 0xffff0000, v9
    v_mul_f32 v6, v6, v10
    v_mul_f32 v7, v7, v10
    v_cvt_pk_bf16_f32 v9, v6, v7
    v_lshlrev_b32 v118, 16, v9
    v_and_b32 v119, 0xffff0000, v9
    v_mul_u32_u24 v50, 336, v12
    v_lshl_add_u32 v50, v18, 4, v50
    v_mul_u32_u24 v60, 2560, v12
    v_lshl_add_u32 v60, v18, 4, v60
    v_mul_u32_u24 v51, 336, v13
    v_lshl_add_u32 v51, v19, 4, v51
    v_mul_u32_u24 v61, 2560, v13
    v_lshl_add_u32 v61, v19, 4, v61
    v_mul_u32_u24 v52, 336, v14
    v_lshl_add_u32 v52, v20, 4, v52
    v_mul_u32_u24 v62, 2560, v14
    v_lshl_add_u32 v62, v20, 4, v62
    v_mul_u32_u24 v53, 336, v15
    v_lshl_add_u32 v53, v21, 4, v53
    v_mul_u32_u24 v63, 2560, v15
    v_lshl_add_u32 v63, v21, 4, v63
    v_mul_u32_u24 v54, 336, v16
    v_lshl_add_u32 v54, v22, 4, v54
    v_mul_u32_u24 v64, 2560, v16
    v_lshl_add_u32 v64, v22, 4, v64
    s_barrier
    s_barrier
    s_mov_b32 s8, s54
    s_mov_b32 s9, s55
    s_mov_b32 s10, 5242880
    s_mov_b32 s11, 0x20000
    s_mul_i32 s6, s4, 2560
    s_lshl_b32 s30, s5, 2
    s_add_u32 s6, s6, s30
    s_barrier
    ds_read_b128 v[30:33], v50 offset:0
    ds_read_b128 v[34:37], v51 offset:0
    ds_read_b128 v[38:41], v52 offset:0
    ds_read_b128 v[42:45], v53 offset:0
    ds_read_b128 v[46:49], v54 offset:0
    s_waitcnt lgkmcnt(4)
    v_add_f32 v30, v30, v80
    v_add_f32 v31, v31, v81
    v_add_f32 v32, v32, v82
    v_add_f32 v33, v33, v83
    v_fma_f32 v30, v24, v30, v100
    v_fma_f32 v31, v24, v31, v101
    v_fma_f32 v32, v24, v32, v102
    v_fma_f32 v33, v24, v33, v103
    buffer_store_dwordx4 v[30:33], v60, s[8:11], s6 offen sc1
    s_waitcnt lgkmcnt(3)
    v_add_f32 v34, v34, v84
    v_add_f32 v35, v35, v85
    v_add_f32 v36, v36, v86
    v_add_f32 v37, v37, v87
    v_fma_f32 v34, v25, v34, v104
    v_fma_f32 v35, v25, v35, v105
    v_fma_f32 v36, v25, v36, v106
    v_fma_f32 v37, v25, v37, v107
    buffer_store_dwordx4 v[34:37], v61, s[8:11], s6 offen sc1
    s_waitcnt lgkmcnt(2)
    v_add_f32 v38, v38, v88
    v_add_f32 v39, v39, v89
    v_add_f32 v40, v40, v90
    v_add_f32 v41, v41, v91
    v_fma_f32 v38, v26, v38, v108
    v_fma_f32 v39, v26, v39, v109
    v_fma_f32 v40, v26, v40, v110
    v_fma_f32 v41, v26, v41, v111
    buffer_store_dwordx4 v[38:41], v62, s[8:11], s6 offen sc1
    s_waitcnt lgkmcnt(1)
    v_add_f32 v42, v42, v92
    v_add_f32 v43, v43, v93
    v_add_f32 v44, v44, v94
    v_add_f32 v45, v45, v95
    v_fma_f32 v42, v27, v42, v112
    v_fma_f32 v43, v27, v43, v113
    v_fma_f32 v44, v27, v44, v114
    v_fma_f32 v45, v27, v45, v115
    buffer_store_dwordx4 v[42:45], v63, s[8:11], s6 offen sc1
    s_waitcnt lgkmcnt(0)
    v_add_f32 v46, v46, v96
    v_add_f32 v47, v47, v97
    v_add_f32 v48, v48, v98
    v_add_f32 v49, v49, v99
    v_fma_f32 v46, v28, v46, v116
    v_fma_f32 v47, v28, v47, v117
    v_fma_f32 v48, v28, v48, v118
    v_fma_f32 v49, v28, v49, v119
    buffer_store_dwordx4 v[46:49], v64, s[8:11], s6 offen sc1
gated_mix__ssm_conv_s5__ssm_conv_s4__prompt_kernel_end_c:
gated_mix__ssm_conv_s5__ssm_conv_s4__prompt_kernel_end:
    s_endpgm
.section .rodata,"a"
.p2align 6
.amdhsa_kernel gated_mix__ssm_conv_s5__ssm_conv_s4__prompt_kernel
  .amdhsa_next_free_vgpr 168
  .amdhsa_next_free_sgpr 100
  .amdhsa_accum_offset 168
  .amdhsa_group_segment_fixed_size 0
  .amdhsa_kernarg_size 176
  .amdhsa_user_sgpr_count 2
  .amdhsa_user_sgpr_kernarg_segment_ptr 1
  .amdhsa_system_sgpr_workgroup_id_x 1
  .amdhsa_float_denorm_mode_32 3
.end_amdhsa_kernel
```
